```python
import torch

def _softmax(x, axis=-1):
    return torch.softmax(x, dim=axis)

def _gelu(x):
    return torch.nn.functional.gelu(x, approximate='tanh')

def _silu(x):
    return torch.nn.functional.silu(x)

def _sigmoid(x):
    return torch.sigmoid(x)

def _layernorm(x, axis=-1, eps=1e-05):
    m = x.mean(dim=axis, keepdim=True)
    v = x.var(dim=axis, keepdim=True, unbiased=False)
    return (x - m) / torch.sqrt(v + eps)

def _scatter_add(tgt, idx, src, axis=0):
    return tgt.clone().index_add_(axis, idx, src)

def _segment_sum(src, seg, n):
    out = torch.zeros((n,) + src.shape[1:], dtype=src.dtype)
    return out.index_add_(0, seg, src)

def _pad(x, pw):
    flat = tuple((v for pair in reversed(pw) for v in pair))
    return torch.nn.functional.pad(x, flat)
kernel_name = 'parallel_sum__memory_aug_recurrent_mem_tr__glu_gated_geglu__prompt'

def setup_inputs():

    _w = lambda a: (lambda t: t.to(torch.bfloat16) if t.is_floating_point() else t)(torch.as_tensor(a))

    def _A_setup():
        B, S, Dm = (1, 2048, 640)
        H, Dh = (32, 128)
        M, seg = (8, 32)
        seg = min(seg, S)
        S = S // seg * seg
        return {'x': _w((lambda *s: torch.randn(*s, dtype=torch.bfloat16) * 0.05)(B, S, Dm)), 'mem0': _w((lambda *s: torch.randn(*s, dtype=torch.bfloat16) * 0.2)(B, M, Dm)), 'Wq': _w((lambda *s: torch.randn(*s, dtype=torch.bfloat16) * 1.6)(Dm, H, Dh) * Dm ** (-0.5)), 'Wk': _w((lambda *s: torch.randn(*s, dtype=torch.bfloat16) * 1.6)(Dm, H, Dh) * Dm ** (-0.5)), 'Wv': _w((lambda *s: torch.randn(*s, dtype=torch.bfloat16) * 0.2)(Dm, H, Dh) * Dm ** (-0.5)), 'Wo': _w((lambda *s: torch.randn(*s, dtype=torch.bfloat16) * 0.2)(H, Dh, Dm) * (H * Dh) ** (-0.5)), 'seg_len': seg}
    _A_in = _A_setup()

    def _B_setup():
        B, S, Dm, Df = (1, 2048, 640, 1728)
        return {'x': _w((lambda *s: torch.randn(*s, dtype=torch.bfloat16) * 0.05)(B, S, Dm)), 'w_gate': _w((lambda *s: torch.randn(*s, dtype=torch.bfloat16) * 0.4)(Dm, Df) * Dm ** (-0.5)), 'w_up': _w((lambda *s: torch.randn(*s, dtype=torch.bfloat16) * 0.4)(Dm, Df) * Dm ** (-0.5)), 'w_down': _w((lambda *s: torch.randn(*s, dtype=torch.bfloat16) * 0.4)(Df, Dm) * Df ** (-0.5))}
    _B_in = _B_setup()
    return {'A_x': _A_in['x'], 'A_mem0': _A_in['mem0'], 'A_Wq': _A_in['Wq'], 'A_Wk': _A_in['Wk'], 'A_Wv': _A_in['Wv'], 'A_Wo': _A_in['Wo'], 'A_seg_len': _A_in['seg_len'], 'B_x': _B_in['x'], 'B_w_gate': _B_in['w_gate'], 'B_w_up': _B_in['w_up'], 'B_w_down': _B_in['w_down']}

def reference(A_x, A_mem0, A_Wq, A_Wk, A_Wv, A_Wo, A_seg_len, B_x, B_w_gate, B_w_up, B_w_down):

    def _A_ref(x, mem0, Wq, Wk, Wv, Wo, seg_len):
        B, S, Dm = x.shape
        H, Dh = (Wq.shape[1], Wq.shape[2])
        M = mem0.shape[1]
        scale = Dh ** (-0.5)
        n_seg = S // seg_len
        L = M + seg_len
        idx = torch.arange(L)
        mask = (idx[:, None] < M) | (idx[:, None] >= idx[None, :])
        mem = mem0
        outs = []
        for s in range(n_seg):
            xs = x[:, s * seg_len:(s + 1) * seg_len, :].clone()
            h = torch.concatenate([mem, xs], axis=1)
            q = torch.einsum('btd,dhe->bhte', h, Wq)
            k = torch.einsum('btd,dhe->bhte', h, Wk)
            v = torch.einsum('btd,dhe->bhte', h, Wv)
            scores = torch.einsum('bhqe,bhke->bhqk', q, k) * scale
            scores = torch.where(mask[None, None], scores, -1000000000.0)
            p = _softmax(scores, axis=-1)
            o = torch.einsum('bhqk,bhke->bhqe', p, v)
            o = torch.einsum('bhte,hed->btd', o, Wo)
            mem = o[:, :M, :].clone()
            outs.append(o[:, M:, :])
        return torch.concatenate(outs, axis=1)

    def _B_ref(x, w_gate, w_up, w_down):
        g = torch.einsum('bsd,df->bsf', x, w_gate)
        u = torch.einsum('bsd,df->bsf', x, w_up)
        h = _gelu(g) * u
        return torch.einsum('bsf,fd->bsd', h, w_down)
    x = A_x
    xn = _layernorm(x, axis=-1)
    return x + _A_ref(xn, A_mem0, A_Wq, A_Wk, A_Wv, A_Wo, A_seg_len) + _B_ref(xn, B_w_gate, B_w_up, B_w_down)
```

```asm
; @launch kernel=prep_kernel grid=(2026,1,1) block=(256,1,1) lds=16384
; @launch kernel=main_kernel grid=(256,1,1) block=(256,1,1) lds=163840
.amdgcn_target "amdgcn-amd-amdhsa--gfx950"
.text
.globl prep_kernel
.p2align 8
.type prep_kernel,@function
prep_kernel:
    s_cmp_ge_u32 s2, 2026
    s_cbranch_scc0 prep_kernel_go
    s_endpgm
prep_kernel_go:
    s_load_dwordx2 s[4:5], s[0:1], 104
    s_mov_b32 s6, 268435456
    s_mov_b32 s7, 0x00020000
    v_lshrrev_b32 v1, 6, v0
    v_and_b32 v0, 63, v0
    v_readfirstlane_b32 s3, v1
    v_lshlrev_b32 v1, 4, v0
    v_lshrrev_b32 v2, 4, v0
    v_and_b32 v3, 15, v0
    s_lshl_b32 s20, s2, 2
    s_add_u32 s20, s20, s3
    s_cmp_lt_u32 s20, 512
    s_cbranch_scc1 pr_ln
    s_sub_u32 s20, s20, 512
    s_cmp_lt_u32 s20, 4
    s_cbranch_scc1 pr_m0
    s_sub_u32 s20, s20, 4
    s_cmp_lt_u32 s20, 1280
    s_cbranch_scc1 pk_k
    s_sub_u32 s20, s20, 1280
    s_cmp_lt_u32 s20, 1280
    s_cbranch_scc1 pk_v
    s_sub_u32 s20, s20, 1280
    s_cmp_lt_u32 s20, 1280
    s_cbranch_scc1 pk_q
    s_sub_u32 s20, s20, 1280
    s_cmp_lt_u32 s20, 1280
    s_cbranch_scc1 pk_o
    s_sub_u32 s20, s20, 1280
    s_cmp_lt_u32 s20, 256
    s_cbranch_scc1 pk_s
    s_sub_u32 s20, s20, 256
    s_cmp_lt_u32 s20, 540
    s_cbranch_scc1 pk_g
    s_sub_u32 s20, s20, 540
    s_cmp_lt_u32 s20, 540
    s_cbranch_scc1 pk_u
    s_sub_u32 s20, s20, 540
    s_cmp_lt_u32 s20, 540
    s_cbranch_scc1 pk_d
    s_sub_u32 s20, s20, 540
    s_cmp_lt_u32 s20, 592
    s_cbranch_scc1 pr_fill
    s_sub_u32 s20, s20, 592
    s_endpgm
pk_k:
    s_load_dwordx2 s[8:9], s[0:1], 24
    s_mov_b32 s10, 5242880
    s_mov_b32 s11, 0x00020000
    s_mov_b32 s23, 67108865
    s_mul_hi_u32 s21, s20, s23
    s_mul_i32 s22, s21, 64
    s_sub_u32 s22, s20, s22
    s_mul_i32 s24, s21, 262144
    s_lshl_b32 s25, s22, 7
    s_add_u32 s24, s24, s25
    s_add_u32 s24, s24, 0
    v_mul_u32_u24 v4, 65536, v2
    v_lshl_add_u32 v4, v3, 3, v4
    s_waitcnt lgkmcnt(0)
    s_add_u32 s25, s24, 0
    buffer_load_dwordx2 v[16:17], v4, s[8:11], s25 offen nt
    s_add_u32 s25, s24, 8192
    buffer_load_dwordx2 v[18:19], v4, s[8:11], s25 offen nt
    s_add_u32 s25, s24, 16384
    buffer_load_dwordx2 v[20:21], v4, s[8:11], s25 offen nt
    s_add_u32 s25, s24, 24576
    buffer_load_dwordx2 v[22:23], v4, s[8:11], s25 offen nt
    s_add_u32 s25, s24, 32768
    buffer_load_dwordx2 v[24:25], v4, s[8:11], s25 offen nt
    s_add_u32 s25, s24, 40960
    buffer_load_dwordx2 v[26:27], v4, s[8:11], s25 offen nt
    s_add_u32 s25, s24, 49152
    buffer_load_dwordx2 v[28:29], v4, s[8:11], s25 offen nt
    s_add_u32 s25, s24, 57344
    buffer_load_dwordx2 v[30:31], v4, s[8:11], s25 offen nt
    s_mov_b32 s26, 1024
    s_lshl_b32 s29, s3, 12
    s_mul_i32 s27, s22, 81920
    s_lshl_b32 s28, s21, 10
    s_add_u32 s27, s27, s28
    s_add_u32 s27, s27, 8388608
    v_lshlrev_b32 v5, 8, v2
    v_lshrrev_b32 v6, 2, v3
    v_and_b32 v7, 3, v3
    v_mul_lo_u32 v6, v6, s26
    v_lshl_add_u32 v5, v7, 6, v5
    v_add_u32 v5, v5, v6
    v_add_u32 v5, s29, v5
    v_add_u32 v6, s29, v1
    s_mov_b32 s30, 0x05040100
    s_mov_b32 s31, 0x07060302
    s_waitcnt vmcnt(0)
    v_perm_b32 v32, v18, v16, s30
    v_perm_b32 v33, v22, v20, s30
    v_perm_b32 v34, v26, v24, s30
    v_perm_b32 v35, v30, v28, s30
    ds_write_b128 v5, v[32:35] offset:0
    v_perm_b32 v36, v18, v16, s31
    v_perm_b32 v37, v22, v20, s31
    v_perm_b32 v38, v26, v24, s31
    v_perm_b32 v39, v30, v28, s31
    ds_write_b128 v5, v[36:39] offset:16
    v_perm_b32 v40, v19, v17, s30
    v_perm_b32 v41, v23, v21, s30
    v_perm_b32 v42, v27, v25, s30
    v_perm_b32 v43, v31, v29, s30
    ds_write_b128 v5, v[40:43] offset:32
    v_perm_b32 v44, v19, v17, s31
    v_perm_b32 v45, v23, v21, s31
    v_perm_b32 v46, v27, v25, s31
    v_perm_b32 v47, v31, v29, s31
    ds_write_b128 v5, v[44:47] offset:48
    ds_read_b128 v[48:51], v6 offset:0
    ds_read_b128 v[52:55], v6 offset:1024
    ds_read_b128 v[56:59], v6 offset:2048
    ds_read_b128 v[60:63], v6 offset:3072
    s_waitcnt lgkmcnt(3)
    buffer_store_dwordx4 v[48:51], v1, s[4:7], s27 offen
    s_add_u32 s27, s27, 20480
    s_waitcnt lgkmcnt(2)
    buffer_store_dwordx4 v[52:55], v1, s[4:7], s27 offen
    s_add_u32 s27, s27, 20480
    s_waitcnt lgkmcnt(1)
    buffer_store_dwordx4 v[56:59], v1, s[4:7], s27 offen
    s_add_u32 s27, s27, 20480
    s_waitcnt lgkmcnt(0)
    buffer_store_dwordx4 v[60:63], v1, s[4:7], s27 offen
    s_add_u32 s27, s27, 20480
    s_endpgm
pk_v:
    s_load_dwordx2 s[8:9], s[0:1], 32
    s_mov_b32 s10, 5242880
    s_mov_b32 s11, 0x00020000
    s_mov_b32 s23, 67108865
    s_mul_hi_u32 s21, s20, s23
    s_mul_i32 s22, s21, 64
    s_sub_u32 s22, s20, s22
    s_mul_i32 s24, s21, 262144
    s_lshl_b32 s25, s22, 7
    s_add_u32 s24, s24, s25
    s_add_u32 s24, s24, 0
    v_mul_u32_u24 v4, 65536, v2
    v_lshl_add_u32 v4, v3, 3, v4
    s_waitcnt lgkmcnt(0)
    s_add_u32 s25, s24, 0
    buffer_load_dwordx2 v[16:17], v4, s[8:11], s25 offen nt
    s_add_u32 s25, s24, 8192
    buffer_load_dwordx2 v[18:19], v4, s[8:11], s25 offen nt
    s_add_u32 s25, s24, 16384
    buffer_load_dwordx2 v[20:21], v4, s[8:11], s25 offen nt
    s_add_u32 s25, s24, 24576
    buffer_load_dwordx2 v[22:23], v4, s[8:11], s25 offen nt
    s_add_u32 s25, s24, 32768
    buffer_load_dwordx2 v[24:25], v4, s[8:11], s25 offen nt
    s_add_u32 s25, s24, 40960
    buffer_load_dwordx2 v[26:27], v4, s[8:11], s25 offen nt
    s_add_u32 s25, s24, 49152
    buffer_load_dwordx2 v[28:29], v4, s[8:11], s25 offen nt
    s_add_u32 s25, s24, 57344
    buffer_load_dwordx2 v[30:31], v4, s[8:11], s25 offen nt
    s_mov_b32 s26, 1024
    s_lshl_b32 s29, s3, 12
    s_mul_i32 s27, s22, 81920
    s_lshl_b32 s28, s21, 10
    s_add_u32 s27, s27, s28
    s_add_u32 s27, s27, 13631488
    v_lshlrev_b32 v5, 8, v2
    v_lshrrev_b32 v6, 2, v3
    v_and_b32 v7, 3, v3
    v_mul_lo_u32 v6, v6, s26
    v_lshl_add_u32 v5, v7, 6, v5
    v_add_u32 v5, v5, v6
    v_add_u32 v5, s29, v5
    v_add_u32 v6, s29, v1
    s_mov_b32 s30, 0x05040100
    s_mov_b32 s31, 0x07060302
    s_waitcnt vmcnt(0)
    v_perm_b32 v32, v18, v16, s30
    v_perm_b32 v33, v22, v20, s30
    v_perm_b32 v34, v26, v24, s30
    v_perm_b32 v35, v30, v28, s30
    ds_write_b128 v5, v[32:35] offset:0
    v_perm_b32 v36, v18, v16, s31
    v_perm_b32 v37, v22, v20, s31
    v_perm_b32 v38, v26, v24, s31
    v_perm_b32 v39, v30, v28, s31
    ds_write_b128 v5, v[36:39] offset:16
    v_perm_b32 v40, v19, v17, s30
    v_perm_b32 v41, v23, v21, s30
    v_perm_b32 v42, v27, v25, s30
    v_perm_b32 v43, v31, v29, s30
    ds_write_b128 v5, v[40:43] offset:32
    v_perm_b32 v44, v19, v17, s31
    v_perm_b32 v45, v23, v21, s31
    v_perm_b32 v46, v27, v25, s31
    v_perm_b32 v47, v31, v29, s31
    ds_write_b128 v5, v[44:47] offset:48
    ds_read_b128 v[48:51], v6 offset:0
    ds_read_b128 v[52:55], v6 offset:1024
    ds_read_b128 v[56:59], v6 offset:2048
    ds_read_b128 v[60:63], v6 offset:3072
    s_waitcnt lgkmcnt(3)
    buffer_store_dwordx4 v[48:51], v1, s[4:7], s27 offen
    s_add_u32 s27, s27, 20480
    s_waitcnt lgkmcnt(2)
    buffer_store_dwordx4 v[52:55], v1, s[4:7], s27 offen
    s_add_u32 s27, s27, 20480
    s_waitcnt lgkmcnt(1)
    buffer_store_dwordx4 v[56:59], v1, s[4:7], s27 offen
    s_add_u32 s27, s27, 20480
    s_waitcnt lgkmcnt(0)
    buffer_store_dwordx4 v[60:63], v1, s[4:7], s27 offen
    s_add_u32 s27, s27, 20480
    s_endpgm
pk_q:
    s_load_dwordx2 s[8:9], s[0:1], 16
    s_mov_b32 s10, 5242880
    s_mov_b32 s11, 0x00020000
    s_mov_b32 s23, 67108865
    s_mul_hi_u32 s21, s20, s23
    s_mul_i32 s22, s21, 64
    s_sub_u32 s22, s20, s22
    s_mul_i32 s24, s21, 262144
    s_lshl_b32 s25, s22, 7
    s_add_u32 s24, s24, s25
    s_add_u32 s24, s24, 0
    v_mul_u32_u24 v4, 65536, v2
    v_lshl_add_u32 v4, v3, 3, v4
    s_waitcnt lgkmcnt(0)
    s_add_u32 s25, s24, 0
    buffer_load_dwordx2 v[16:17], v4, s[8:11], s25 offen nt
    s_add_u32 s25, s24, 8192
    buffer_load_dwordx2 v[18:19], v4, s[8:11], s25 offen nt
    s_add_u32 s25, s24, 16384
    buffer_load_dwordx2 v[20:21], v4, s[8:11], s25 offen nt
    s_add_u32 s25, s24, 24576
    buffer_load_dwordx2 v[22:23], v4, s[8:11], s25 offen nt
    s_add_u32 s25, s24, 32768
    buffer_load_dwordx2 v[24:25], v4, s[8:11], s25 offen nt
    s_add_u32 s25, s24, 40960
    buffer_load_dwordx2 v[26:27], v4, s[8:11], s25 offen nt
    s_add_u32 s25, s24, 49152
    buffer_load_dwordx2 v[28:29], v4, s[8:11], s25 offen nt
    s_add_u32 s25, s24, 57344
    buffer_load_dwordx2 v[30:31], v4, s[8:11], s25 offen nt
    s_mov_b32 s26, 1024
    s_lshl_b32 s29, s3, 12
    s_mul_i32 s27, s22, 81920
    s_lshl_b32 s28, s21, 10
    s_add_u32 s27, s27, s28
    s_add_u32 s27, s27, 3145728
    v_lshlrev_b32 v5, 8, v2
    v_lshrrev_b32 v6, 2, v3
    v_and_b32 v7, 3, v3
    v_mul_lo_u32 v6, v6, s26
    v_lshl_add_u32 v5, v7, 6, v5
    v_add_u32 v5, v5, v6
    v_add_u32 v5, s29, v5
    v_add_u32 v6, s29, v1
    s_mov_b32 s30, 0x05040100
    s_mov_b32 s31, 0x07060302
    s_waitcnt vmcnt(0)
    v_perm_b32 v32, v18, v16, s30
    v_perm_b32 v33, v22, v20, s30
    v_perm_b32 v34, v26, v24, s30
    v_perm_b32 v35, v30, v28, s30
    ds_write_b128 v5, v[32:35] offset:0
    v_perm_b32 v36, v18, v16, s31
    v_perm_b32 v37, v22, v20, s31
    v_perm_b32 v38, v26, v24, s31
    v_perm_b32 v39, v30, v28, s31
    ds_write_b128 v5, v[36:39] offset:16
    v_perm_b32 v40, v19, v17, s30
    v_perm_b32 v41, v23, v21, s30
    v_perm_b32 v42, v27, v25, s30
    v_perm_b32 v43, v31, v29, s30
    ds_write_b128 v5, v[40:43] offset:32
    v_perm_b32 v44, v19, v17, s31
    v_perm_b32 v45, v23, v21, s31
    v_perm_b32 v46, v27, v25, s31
    v_perm_b32 v47, v31, v29, s31
    ds_write_b128 v5, v[44:47] offset:48
    ds_read_b128 v[48:51], v6 offset:0
    ds_read_b128 v[52:55], v6 offset:1024
    ds_read_b128 v[56:59], v6 offset:2048
    ds_read_b128 v[60:63], v6 offset:3072
    s_waitcnt lgkmcnt(3)
    buffer_store_dwordx4 v[48:51], v1, s[4:7], s27 offen
    s_add_u32 s27, s27, 20480
    s_waitcnt lgkmcnt(2)
    buffer_store_dwordx4 v[52:55], v1, s[4:7], s27 offen
    s_add_u32 s27, s27, 20480
    s_waitcnt lgkmcnt(1)
    buffer_store_dwordx4 v[56:59], v1, s[4:7], s27 offen
    s_add_u32 s27, s27, 20480
    s_waitcnt lgkmcnt(0)
    buffer_store_dwordx4 v[60:63], v1, s[4:7], s27 offen
    s_add_u32 s27, s27, 20480
    s_endpgm
pk_o:
    s_load_dwordx2 s[8:9], s[0:1], 40
    s_mov_b32 s10, 5242880
    s_mov_b32 s11, 0x00020000
    s_mov_b32 s23, 429496730
    s_mul_hi_u32 s21, s20, s23
    s_mul_i32 s22, s21, 10
    s_sub_u32 s22, s20, s22
    s_mul_i32 s24, s21, 40960
    s_lshl_b32 s25, s22, 7
    s_add_u32 s24, s24, s25
    s_add_u32 s24, s24, 0
    v_mul_u32_u24 v4, 5120, v2
    v_lshl_add_u32 v4, v3, 3, v4
    s_waitcnt lgkmcnt(0)
    s_add_u32 s25, s24, 0
    buffer_load_dwordx2 v[16:17], v4, s[8:11], s25 offen nt
    s_add_u32 s25, s24, 1280
    buffer_load_dwordx2 v[18:19], v4, s[8:11], s25 offen nt
    s_add_u32 s25, s24, 2560
    buffer_load_dwordx2 v[20:21], v4, s[8:11], s25 offen nt
    s_add_u32 s25, s24, 3840
    buffer_load_dwordx2 v[22:23], v4, s[8:11], s25 offen nt
    s_add_u32 s25, s24, 20480
    buffer_load_dwordx2 v[24:25], v4, s[8:11], s25 offen nt
    s_add_u32 s25, s24, 21760
    buffer_load_dwordx2 v[26:27], v4, s[8:11], s25 offen nt
    s_add_u32 s25, s24, 23040
    buffer_load_dwordx2 v[28:29], v4, s[8:11], s25 offen nt
    s_add_u32 s25, s24, 24320
    buffer_load_dwordx2 v[30:31], v4, s[8:11], s25 offen nt
    s_mov_b32 s26, 1024
    s_lshl_b32 s29, s3, 12
    s_mul_i32 s27, s22, 745472
    s_lshl_b32 s28, s21, 10
    s_add_u32 s27, s27, s28
    s_add_u32 s27, s27, 24117248
    v_lshlrev_b32 v5, 8, v2
    v_lshrrev_b32 v6, 2, v3
    v_and_b32 v7, 3, v3
    v_lshl_add_u32 v5, v6, 6, v5
    v_lshrrev_b32 v6, 1, v7
    v_lshl_add_u32 v5, v6, 4, v5
    v_and_b32 v7, 1, v7
    v_lshlrev_b32 v7, 1, v7
    v_mul_lo_u32 v7, v7, s26
    v_add_u32 v5, v5, v7
    v_add_u32 v5, s29, v5
    v_add_u32 v6, s29, v1
    s_mov_b32 s30, 0x05040100
    s_mov_b32 s31, 0x07060302
    s_waitcnt vmcnt(0)
    v_perm_b32 v32, v18, v16, s30
    v_perm_b32 v33, v22, v20, s30
    v_perm_b32 v34, v26, v24, s30
    v_perm_b32 v35, v30, v28, s30
    ds_write_b128 v5, v[32:35] offset:0
    v_perm_b32 v36, v18, v16, s31
    v_perm_b32 v37, v22, v20, s31
    v_perm_b32 v38, v26, v24, s31
    v_perm_b32 v39, v30, v28, s31
    ds_write_b128 v5, v[36:39] offset:1024
    v_perm_b32 v40, v19, v17, s30
    v_perm_b32 v41, v23, v21, s30
    v_perm_b32 v42, v27, v25, s30
    v_perm_b32 v43, v31, v29, s30
    ds_write_b128 v5, v[40:43] offset:32
    v_perm_b32 v44, v19, v17, s31
    v_perm_b32 v45, v23, v21, s31
    v_perm_b32 v46, v27, v25, s31
    v_perm_b32 v47, v31, v29, s31
    ds_write_b128 v5, v[44:47] offset:1056
    ds_read_b128 v[48:51], v6 offset:0
    ds_read_b128 v[52:55], v6 offset:1024
    ds_read_b128 v[56:59], v6 offset:2048
    ds_read_b128 v[60:63], v6 offset:3072
    s_waitcnt lgkmcnt(3)
    buffer_store_dwordx4 v[48:51], v1, s[4:7], s27 offen
    s_add_u32 s27, s27, 186368
    s_waitcnt lgkmcnt(2)
    buffer_store_dwordx4 v[52:55], v1, s[4:7], s27 offen
    s_add_u32 s27, s27, 186368
    s_waitcnt lgkmcnt(1)
    buffer_store_dwordx4 v[56:59], v1, s[4:7], s27 offen
    s_add_u32 s27, s27, 186368
    s_waitcnt lgkmcnt(0)
    buffer_store_dwordx4 v[60:63], v1, s[4:7], s27 offen
    s_add_u32 s27, s27, 186368
    s_endpgm
pk_s:
    s_load_dwordx2 s[8:9], s[0:1], 40
    s_mov_b32 s10, 5242880
    s_mov_b32 s11, 0x00020000
    s_mov_b32 s23, 2147483649
    s_mul_hi_u32 s21, s20, s23
    s_mul_i32 s22, s21, 2
    s_sub_u32 s22, s20, s22
    s_mul_i32 s24, s21, 40960
    s_lshl_b32 s25, s22, 7
    s_add_u32 s24, s24, s25
    s_add_u32 s24, s24, 1024
    v_mul_u32_u24 v4, 5120, v2
    v_lshl_add_u32 v4, v3, 3, v4
    s_waitcnt lgkmcnt(0)
    s_add_u32 s25, s24, 0
    buffer_load_dwordx2 v[16:17], v4, s[8:11], s25 offen nt
    s_add_u32 s25, s24, 1280
    buffer_load_dwordx2 v[18:19], v4, s[8:11], s25 offen nt
    s_add_u32 s25, s24, 2560
    buffer_load_dwordx2 v[20:21], v4, s[8:11], s25 offen nt
    s_add_u32 s25, s24, 3840
    buffer_load_dwordx2 v[22:23], v4, s[8:11], s25 offen nt
    s_add_u32 s25, s24, 20480
    buffer_load_dwordx2 v[24:25], v4, s[8:11], s25 offen nt
    s_add_u32 s25, s24, 21760
    buffer_load_dwordx2 v[26:27], v4, s[8:11], s25 offen nt
    s_add_u32 s25, s24, 23040
    buffer_load_dwordx2 v[28:29], v4, s[8:11], s25 offen nt
    s_add_u32 s25, s24, 24320
    buffer_load_dwordx2 v[30:31], v4, s[8:11], s25 offen nt
    s_mov_b32 s26, 1024
    s_lshl_b32 s29, s3, 12
    s_mul_i32 s27, s22, 745472
    s_lshl_b32 s28, s21, 10
    s_add_u32 s27, s27, s28
    s_add_u32 s27, s27, 31571968
    v_lshlrev_b32 v5, 8, v2
    v_lshrrev_b32 v6, 2, v3
    v_and_b32 v7, 3, v3
    v_mul_lo_u32 v6, v6, s26
    v_lshl_add_u32 v5, v7, 5, v5
    v_add_u32 v5, v5, v6
    v_add_u32 v5, s29, v5
    v_add_u32 v6, s29, v1
    s_mov_b32 s30, 0x05040100
    s_mov_b32 s31, 0x07060302
    s_waitcnt vmcnt(0)
    v_perm_b32 v32, v18, v16, s30
    v_perm_b32 v33, v22, v20, s30
    v_perm_b32 v34, v26, v24, s30
    v_perm_b32 v35, v30, v28, s30
    ds_write_b128 v5, v[32:35] offset:0
    v_perm_b32 v36, v18, v16, s31
    v_perm_b32 v37, v22, v20, s31
    v_perm_b32 v38, v26, v24, s31
    v_perm_b32 v39, v30, v28, s31
    ds_write_b128 v5, v[36:39] offset:16
    v_perm_b32 v40, v19, v17, s30
    v_perm_b32 v41, v23, v21, s30
    v_perm_b32 v42, v27, v25, s30
    v_perm_b32 v43, v31, v29, s30
    ds_write_b128 v5, v[40:43] offset:128
    v_perm_b32 v44, v19, v17, s31
    v_perm_b32 v45, v23, v21, s31
    v_perm_b32 v46, v27, v25, s31
    v_perm_b32 v47, v31, v29, s31
    ds_write_b128 v5, v[44:47] offset:144
    ds_read_b128 v[48:51], v6 offset:0
    ds_read_b128 v[52:55], v6 offset:1024
    ds_read_b128 v[56:59], v6 offset:2048
    ds_read_b128 v[60:63], v6 offset:3072
    s_waitcnt lgkmcnt(3)
    buffer_store_dwordx4 v[48:51], v1, s[4:7], s27 offen
    s_add_u32 s27, s27, 186368
    s_waitcnt lgkmcnt(2)
    buffer_store_dwordx4 v[52:55], v1, s[4:7], s27 offen
    s_add_u32 s27, s27, 186368
    s_waitcnt lgkmcnt(1)
    buffer_store_dwordx4 v[56:59], v1, s[4:7], s27 offen
    s_add_u32 s27, s27, 186368
    s_waitcnt lgkmcnt(0)
    buffer_store_dwordx4 v[60:63], v1, s[4:7], s27 offen
    s_add_u32 s27, s27, 186368
    s_endpgm
pk_g:
    s_load_dwordx2 s[8:9], s[0:1], 64
    s_mov_b32 s10, 2211840
    s_mov_b32 s11, 0x00020000
    s_mov_b32 s23, 159072863
    s_mul_hi_u32 s21, s20, s23
    s_mul_i32 s22, s21, 27
    s_sub_u32 s22, s20, s22
    s_mul_i32 s24, s21, 110592
    s_lshl_b32 s25, s22, 7
    s_add_u32 s24, s24, s25
    s_add_u32 s24, s24, 0
    v_mul_u32_u24 v4, 27648, v2
    v_lshl_add_u32 v4, v3, 3, v4
    s_waitcnt lgkmcnt(0)
    s_add_u32 s25, s24, 0
    buffer_load_dwordx2 v[16:17], v4, s[8:11], s25 offen nt
    s_add_u32 s25, s24, 3456
    buffer_load_dwordx2 v[18:19], v4, s[8:11], s25 offen nt
    s_add_u32 s25, s24, 6912
    buffer_load_dwordx2 v[20:21], v4, s[8:11], s25 offen nt
    s_add_u32 s25, s24, 10368
    buffer_load_dwordx2 v[22:23], v4, s[8:11], s25 offen nt
    s_add_u32 s25, s24, 13824
    buffer_load_dwordx2 v[24:25], v4, s[8:11], s25 offen nt
    s_add_u32 s25, s24, 17280
    buffer_load_dwordx2 v[26:27], v4, s[8:11], s25 offen nt
    s_add_u32 s25, s24, 20736
    buffer_load_dwordx2 v[28:29], v4, s[8:11], s25 offen nt
    s_add_u32 s25, s24, 24192
    buffer_load_dwordx2 v[30:31], v4, s[8:11], s25 offen nt
    s_mov_b32 s26, 1024
    s_lshl_b32 s29, s3, 12
    s_mul_i32 s27, s22, 81920
    s_lshl_b32 s28, s21, 10
    s_add_u32 s27, s27, s28
    s_add_u32 s27, s27, 18874368
    v_lshlrev_b32 v5, 8, v2
    v_lshrrev_b32 v6, 2, v3
    v_and_b32 v7, 3, v3
    v_mul_lo_u32 v6, v6, s26
    v_lshl_add_u32 v5, v7, 6, v5
    v_add_u32 v5, v5, v6
    v_add_u32 v5, s29, v5
    v_add_u32 v6, s29, v1
    s_mov_b32 s30, 0x05040100
    s_mov_b32 s31, 0x07060302
    s_waitcnt vmcnt(0)
    v_perm_b32 v32, v18, v16, s30
    v_perm_b32 v33, v22, v20, s30
    v_perm_b32 v34, v26, v24, s30
    v_perm_b32 v35, v30, v28, s30
    ds_write_b128 v5, v[32:35] offset:0
    v_perm_b32 v36, v18, v16, s31
    v_perm_b32 v37, v22, v20, s31
    v_perm_b32 v38, v26, v24, s31
    v_perm_b32 v39, v30, v28, s31
    ds_write_b128 v5, v[36:39] offset:16
    v_perm_b32 v40, v19, v17, s30
    v_perm_b32 v41, v23, v21, s30
    v_perm_b32 v42, v27, v25, s30
    v_perm_b32 v43, v31, v29, s30
    ds_write_b128 v5, v[40:43] offset:32
    v_perm_b32 v44, v19, v17, s31
    v_perm_b32 v45, v23, v21, s31
    v_perm_b32 v46, v27, v25, s31
    v_perm_b32 v47, v31, v29, s31
    ds_write_b128 v5, v[44:47] offset:48
    ds_read_b128 v[48:51], v6 offset:0
    ds_read_b128 v[52:55], v6 offset:1024
    ds_read_b128 v[56:59], v6 offset:2048
    ds_read_b128 v[60:63], v6 offset:3072
    s_waitcnt lgkmcnt(3)
    buffer_store_dwordx4 v[48:51], v1, s[4:7], s27 offen
    s_add_u32 s27, s27, 20480
    s_waitcnt lgkmcnt(2)
    buffer_store_dwordx4 v[52:55], v1, s[4:7], s27 offen
    s_add_u32 s27, s27, 20480
    s_waitcnt lgkmcnt(1)
    buffer_store_dwordx4 v[56:59], v1, s[4:7], s27 offen
    s_add_u32 s27, s27, 20480
    s_waitcnt lgkmcnt(0)
    buffer_store_dwordx4 v[60:63], v1, s[4:7], s27 offen
    s_add_u32 s27, s27, 20480
    s_endpgm
pk_u:
    s_load_dwordx2 s[8:9], s[0:1], 72
    s_mov_b32 s10, 2211840
    s_mov_b32 s11, 0x00020000
    s_mov_b32 s23, 159072863
    s_mul_hi_u32 s21, s20, s23
    s_mul_i32 s22, s21, 27
    s_sub_u32 s22, s20, s22
    s_mul_i32 s24, s21, 110592
    s_lshl_b32 s25, s22, 7
    s_add_u32 s24, s24, s25
    s_add_u32 s24, s24, 0
    v_mul_u32_u24 v4, 27648, v2
    v_lshl_add_u32 v4, v3, 3, v4
    s_waitcnt lgkmcnt(0)
    s_add_u32 s25, s24, 0
    buffer_load_dwordx2 v[16:17], v4, s[8:11], s25 offen nt
    s_add_u32 s25, s24, 3456
    buffer_load_dwordx2 v[18:19], v4, s[8:11], s25 offen nt
    s_add_u32 s25, s24, 6912
    buffer_load_dwordx2 v[20:21], v4, s[8:11], s25 offen nt
    s_add_u32 s25, s24, 10368
    buffer_load_dwordx2 v[22:23], v4, s[8:11], s25 offen nt
    s_add_u32 s25, s24, 13824
    buffer_load_dwordx2 v[24:25], v4, s[8:11], s25 offen nt
    s_add_u32 s25, s24, 17280
    buffer_load_dwordx2 v[26:27], v4, s[8:11], s25 offen nt
    s_add_u32 s25, s24, 20736
    buffer_load_dwordx2 v[28:29], v4, s[8:11], s25 offen nt
    s_add_u32 s25, s24, 24192
    buffer_load_dwordx2 v[30:31], v4, s[8:11], s25 offen nt
    s_mov_b32 s26, 1024
    s_lshl_b32 s29, s3, 12
    s_mul_i32 s27, s22, 81920
    s_lshl_b32 s28, s21, 10
    s_add_u32 s27, s27, s28
    s_add_u32 s27, s27, 21495808
    v_lshlrev_b32 v5, 8, v2
    v_lshrrev_b32 v6, 2, v3
    v_and_b32 v7, 3, v3
    v_mul_lo_u32 v6, v6, s26
    v_lshl_add_u32 v5, v7, 6, v5
    v_add_u32 v5, v5, v6
    v_add_u32 v5, s29, v5
    v_add_u32 v6, s29, v1
    s_mov_b32 s30, 0x05040100
    s_mov_b32 s31, 0x07060302
    s_waitcnt vmcnt(0)
    v_perm_b32 v32, v18, v16, s30
    v_perm_b32 v33, v22, v20, s30
    v_perm_b32 v34, v26, v24, s30
    v_perm_b32 v35, v30, v28, s30
    ds_write_b128 v5, v[32:35] offset:0
    v_perm_b32 v36, v18, v16, s31
    v_perm_b32 v37, v22, v20, s31
    v_perm_b32 v38, v26, v24, s31
    v_perm_b32 v39, v30, v28, s31
    ds_write_b128 v5, v[36:39] offset:16
    v_perm_b32 v40, v19, v17, s30
    v_perm_b32 v41, v23, v21, s30
    v_perm_b32 v42, v27, v25, s30
    v_perm_b32 v43, v31, v29, s30
    ds_write_b128 v5, v[40:43] offset:32
    v_perm_b32 v44, v19, v17, s31
    v_perm_b32 v45, v23, v21, s31
    v_perm_b32 v46, v27, v25, s31
    v_perm_b32 v47, v31, v29, s31
    ds_write_b128 v5, v[44:47] offset:48
    ds_read_b128 v[48:51], v6 offset:0
    ds_read_b128 v[52:55], v6 offset:1024
    ds_read_b128 v[56:59], v6 offset:2048
    ds_read_b128 v[60:63], v6 offset:3072
    s_waitcnt lgkmcnt(3)
    buffer_store_dwordx4 v[48:51], v1, s[4:7], s27 offen
    s_add_u32 s27, s27, 20480
    s_waitcnt lgkmcnt(2)
    buffer_store_dwordx4 v[52:55], v1, s[4:7], s27 offen
    s_add_u32 s27, s27, 20480
    s_waitcnt lgkmcnt(1)
    buffer_store_dwordx4 v[56:59], v1, s[4:7], s27 offen
    s_add_u32 s27, s27, 20480
    s_waitcnt lgkmcnt(0)
    buffer_store_dwordx4 v[60:63], v1, s[4:7], s27 offen
    s_add_u32 s27, s27, 20480
    s_endpgm
pk_d:
    s_load_dwordx2 s[8:9], s[0:1], 80
    s_mov_b32 s10, 2211840
    s_mov_b32 s11, 0x00020000
    s_mov_b32 s23, 429496730
    s_mul_hi_u32 s21, s20, s23
    s_mul_i32 s22, s21, 10
    s_sub_u32 s22, s20, s22
    s_mul_i32 s24, s21, 40960
    s_lshl_b32 s25, s22, 7
    s_add_u32 s24, s24, s25
    s_add_u32 s24, s24, 0
    v_mul_u32_u24 v4, 5120, v2
    v_lshl_add_u32 v4, v3, 3, v4
    s_waitcnt lgkmcnt(0)
    s_add_u32 s25, s24, 0
    buffer_load_dwordx2 v[16:17], v4, s[8:11], s25 offen nt
    s_add_u32 s25, s24, 1280
    buffer_load_dwordx2 v[18:19], v4, s[8:11], s25 offen nt
    s_add_u32 s25, s24, 2560
    buffer_load_dwordx2 v[20:21], v4, s[8:11], s25 offen nt
    s_add_u32 s25, s24, 3840
    buffer_load_dwordx2 v[22:23], v4, s[8:11], s25 offen nt
    s_add_u32 s25, s24, 20480
    buffer_load_dwordx2 v[24:25], v4, s[8:11], s25 offen nt
    s_add_u32 s25, s24, 21760
    buffer_load_dwordx2 v[26:27], v4, s[8:11], s25 offen nt
    s_add_u32 s25, s24, 23040
    buffer_load_dwordx2 v[28:29], v4, s[8:11], s25 offen nt
    s_add_u32 s25, s24, 24320
    buffer_load_dwordx2 v[30:31], v4, s[8:11], s25 offen nt
    s_mov_b32 s26, 1024
    s_lshl_b32 s29, s3, 12
    s_mul_i32 s27, s22, 745472
    s_lshl_b32 s28, s21, 10
    s_add_u32 s27, s27, s28
    s_add_u32 s27, s27, 24248320
    v_lshlrev_b32 v5, 8, v2
    v_lshrrev_b32 v6, 2, v3
    v_and_b32 v7, 3, v3
    v_lshl_add_u32 v5, v6, 6, v5
    v_lshrrev_b32 v6, 1, v7
    v_lshl_add_u32 v5, v6, 4, v5
    v_and_b32 v7, 1, v7
    v_lshlrev_b32 v7, 1, v7
    v_mul_lo_u32 v7, v7, s26
    v_add_u32 v5, v5, v7
    v_add_u32 v5, s29, v5
    v_add_u32 v6, s29, v1
    s_mov_b32 s30, 0x05040100
    s_mov_b32 s31, 0x07060302
    s_waitcnt vmcnt(0)
    v_perm_b32 v32, v18, v16, s30
    v_perm_b32 v33, v22, v20, s30
    v_perm_b32 v34, v26, v24, s30
    v_perm_b32 v35, v30, v28, s30
    ds_write_b128 v5, v[32:35] offset:0
    v_perm_b32 v36, v18, v16, s31
    v_perm_b32 v37, v22, v20, s31
    v_perm_b32 v38, v26, v24, s31
    v_perm_b32 v39, v30, v28, s31
    ds_write_b128 v5, v[36:39] offset:1024
    v_perm_b32 v40, v19, v17, s30
    v_perm_b32 v41, v23, v21, s30
    v_perm_b32 v42, v27, v25, s30
    v_perm_b32 v43, v31, v29, s30
    ds_write_b128 v5, v[40:43] offset:32
    v_perm_b32 v44, v19, v17, s31
    v_perm_b32 v45, v23, v21, s31
    v_perm_b32 v46, v27, v25, s31
    v_perm_b32 v47, v31, v29, s31
    ds_write_b128 v5, v[44:47] offset:1056
    ds_read_b128 v[48:51], v6 offset:0
    ds_read_b128 v[52:55], v6 offset:1024
    ds_read_b128 v[56:59], v6 offset:2048
    ds_read_b128 v[60:63], v6 offset:3072
    s_waitcnt lgkmcnt(3)
    buffer_store_dwordx4 v[48:51], v1, s[4:7], s27 offen
    s_add_u32 s27, s27, 186368
    s_waitcnt lgkmcnt(2)
    buffer_store_dwordx4 v[52:55], v1, s[4:7], s27 offen
    s_add_u32 s27, s27, 186368
    s_waitcnt lgkmcnt(1)
    buffer_store_dwordx4 v[56:59], v1, s[4:7], s27 offen
    s_add_u32 s27, s27, 186368
    s_waitcnt lgkmcnt(0)
    buffer_store_dwordx4 v[60:63], v1, s[4:7], s27 offen
    s_add_u32 s27, s27, 186368
    s_endpgm
pr_fill:
    s_lshl_b32 s21, s20, 14
    s_mov_b32 s22, 121655296
    s_cmp_ge_u32 s20, 579
    s_cselect_b32 s22, 134103040, s22
    s_add_u32 s21, s21, s22
    v_mov_b32 v4, -1
    v_mov_b32 v5, -1
    v_mov_b32 v6, -1
    v_mov_b32 v7, -1
    s_waitcnt lgkmcnt(0)
    buffer_store_dwordx4 v[4:7], v1, s[4:7], s21 offen offset:0
    buffer_store_dwordx4 v[4:7], v1, s[4:7], s21 offen offset:1024
    buffer_store_dwordx4 v[4:7], v1, s[4:7], s21 offen offset:2048
    buffer_store_dwordx4 v[4:7], v1, s[4:7], s21 offen offset:3072
    s_add_u32 s21, s21, 4096
    buffer_store_dwordx4 v[4:7], v1, s[4:7], s21 offen offset:0
    buffer_store_dwordx4 v[4:7], v1, s[4:7], s21 offen offset:1024
    buffer_store_dwordx4 v[4:7], v1, s[4:7], s21 offen offset:2048
    buffer_store_dwordx4 v[4:7], v1, s[4:7], s21 offen offset:3072
    s_add_u32 s21, s21, 4096
    buffer_store_dwordx4 v[4:7], v1, s[4:7], s21 offen offset:0
    buffer_store_dwordx4 v[4:7], v1, s[4:7], s21 offen offset:1024
    buffer_store_dwordx4 v[4:7], v1, s[4:7], s21 offen offset:2048
    buffer_store_dwordx4 v[4:7], v1, s[4:7], s21 offen offset:3072
    s_add_u32 s21, s21, 4096
    buffer_store_dwordx4 v[4:7], v1, s[4:7], s21 offen offset:0
    buffer_store_dwordx4 v[4:7], v1, s[4:7], s21 offen offset:1024
    buffer_store_dwordx4 v[4:7], v1, s[4:7], s21 offen offset:2048
    buffer_store_dwordx4 v[4:7], v1, s[4:7], s21 offen offset:3072
    s_add_u32 s21, s21, 4096
    s_endpgm
pr_m0:
    s_cmp_eq_u32 s20, 0
    s_cbranch_scc1 pr_m1
    s_endpgm
pr_m1:
    s_load_dwordx2 s[8:9], s[0:1], 8
    s_mov_b32 s10, 10240
    s_mov_b32 s11, 0x00020000
    v_lshrrev_b32 v4, 1, v3
    v_mul_u32_u24 v4, 1280, v4
    v_lshl_add_u32 v4, v2, 5, v4
    v_and_b32 v5, 1, v3
    v_lshl_add_u32 v4, v5, 2, v4
    s_waitcnt lgkmcnt(0)
    buffer_load_dword v16, v4, s[8:11], 0 offen offset:0
    buffer_load_dword v17, v4, s[8:11], 0 offen offset:8
    buffer_load_dword v18, v4, s[8:11], 0 offen offset:16
    buffer_load_dword v19, v4, s[8:11], 0 offen offset:24
    buffer_load_dword v20, v4, s[8:11], 0 offen offset:128
    buffer_load_dword v21, v4, s[8:11], 0 offen offset:136
    buffer_load_dword v22, v4, s[8:11], 0 offen offset:144
    buffer_load_dword v23, v4, s[8:11], 0 offen offset:152
    buffer_load_dword v24, v4, s[8:11], 0 offen offset:256
    buffer_load_dword v25, v4, s[8:11], 0 offen offset:264
    buffer_load_dword v26, v4, s[8:11], 0 offen offset:272
    buffer_load_dword v27, v4, s[8:11], 0 offen offset:280
    buffer_load_dword v28, v4, s[8:11], 0 offen offset:384
    buffer_load_dword v29, v4, s[8:11], 0 offen offset:392
    buffer_load_dword v30, v4, s[8:11], 0 offen offset:400
    buffer_load_dword v31, v4, s[8:11], 0 offen offset:408
    buffer_load_dword v32, v4, s[8:11], 0 offen offset:512
    buffer_load_dword v33, v4, s[8:11], 0 offen offset:520
    buffer_load_dword v34, v4, s[8:11], 0 offen offset:528
    buffer_load_dword v35, v4, s[8:11], 0 offen offset:536
    buffer_load_dword v36, v4, s[8:11], 0 offen offset:640
    buffer_load_dword v37, v4, s[8:11], 0 offen offset:648
    buffer_load_dword v38, v4, s[8:11], 0 offen offset:656
    buffer_load_dword v39, v4, s[8:11], 0 offen offset:664
    buffer_load_dword v40, v4, s[8:11], 0 offen offset:768
    buffer_load_dword v41, v4, s[8:11], 0 offen offset:776
    buffer_load_dword v42, v4, s[8:11], 0 offen offset:784
    buffer_load_dword v43, v4, s[8:11], 0 offen offset:792
    buffer_load_dword v44, v4, s[8:11], 0 offen offset:896
    buffer_load_dword v45, v4, s[8:11], 0 offen offset:904
    buffer_load_dword v46, v4, s[8:11], 0 offen offset:912
    buffer_load_dword v47, v4, s[8:11], 0 offen offset:920
    buffer_load_dword v48, v4, s[8:11], 0 offen offset:1024
    buffer_load_dword v49, v4, s[8:11], 0 offen offset:1032
    buffer_load_dword v50, v4, s[8:11], 0 offen offset:1040
    buffer_load_dword v51, v4, s[8:11], 0 offen offset:1048
    buffer_load_dword v52, v4, s[8:11], 0 offen offset:1152
    buffer_load_dword v53, v4, s[8:11], 0 offen offset:1160
    buffer_load_dword v54, v4, s[8:11], 0 offen offset:1168
    buffer_load_dword v55, v4, s[8:11], 0 offen offset:1176
    s_waitcnt vmcnt(0)
    v_min_u32 v16, -2, v16
    v_min_u32 v17, -2, v17
    v_min_u32 v18, -2, v18
    v_min_u32 v19, -2, v19
    v_min_u32 v20, -2, v20
    v_min_u32 v21, -2, v21
    v_min_u32 v22, -2, v22
    v_min_u32 v23, -2, v23
    v_min_u32 v24, -2, v24
    v_min_u32 v25, -2, v25
    v_min_u32 v26, -2, v26
    v_min_u32 v27, -2, v27
    v_min_u32 v28, -2, v28
    v_min_u32 v29, -2, v29
    v_min_u32 v30, -2, v30
    v_min_u32 v31, -2, v31
    v_min_u32 v32, -2, v32
    v_min_u32 v33, -2, v33
    v_min_u32 v34, -2, v34
    v_min_u32 v35, -2, v35
    v_min_u32 v36, -2, v36
    v_min_u32 v37, -2, v37
    v_min_u32 v38, -2, v38
    v_min_u32 v39, -2, v39
    v_min_u32 v40, -2, v40
    v_min_u32 v41, -2, v41
    v_min_u32 v42, -2, v42
    v_min_u32 v43, -2, v43
    v_min_u32 v44, -2, v44
    v_min_u32 v45, -2, v45
    v_min_u32 v46, -2, v46
    v_min_u32 v47, -2, v47
    v_min_u32 v48, -2, v48
    v_min_u32 v49, -2, v49
    v_min_u32 v50, -2, v50
    v_min_u32 v51, -2, v51
    v_min_u32 v52, -2, v52
    v_min_u32 v53, -2, v53
    v_min_u32 v54, -2, v54
    v_min_u32 v55, -2, v55
    s_mov_b32 s21, 121634816
    buffer_store_dwordx4 v[16:19], v1, s[4:7], s21 offen
    s_mov_b32 s21, 121645056
    buffer_store_dwordx4 v[16:19], v1, s[4:7], s21 offen
    s_mov_b32 s21, 121635840
    buffer_store_dwordx4 v[20:23], v1, s[4:7], s21 offen
    s_mov_b32 s21, 121646080
    buffer_store_dwordx4 v[20:23], v1, s[4:7], s21 offen
    s_mov_b32 s21, 121636864
    buffer_store_dwordx4 v[24:27], v1, s[4:7], s21 offen
    s_mov_b32 s21, 121647104
    buffer_store_dwordx4 v[24:27], v1, s[4:7], s21 offen
    s_mov_b32 s21, 121637888
    buffer_store_dwordx4 v[28:31], v1, s[4:7], s21 offen
    s_mov_b32 s21, 121648128
    buffer_store_dwordx4 v[28:31], v1, s[4:7], s21 offen
    s_mov_b32 s21, 121639936
    buffer_store_dwordx4 v[32:35], v1, s[4:7], s21 offen
    s_mov_b32 s21, 121650176
    buffer_store_dwordx4 v[32:35], v1, s[4:7], s21 offen
    s_mov_b32 s21, 121640960
    buffer_store_dwordx4 v[36:39], v1, s[4:7], s21 offen
    s_mov_b32 s21, 121651200
    buffer_store_dwordx4 v[36:39], v1, s[4:7], s21 offen
    s_mov_b32 s21, 121641984
    buffer_store_dwordx4 v[40:43], v1, s[4:7], s21 offen
    s_mov_b32 s21, 121652224
    buffer_store_dwordx4 v[40:43], v1, s[4:7], s21 offen
    s_mov_b32 s21, 121643008
    buffer_store_dwordx4 v[44:47], v1, s[4:7], s21 offen
    s_mov_b32 s21, 121653248
    buffer_store_dwordx4 v[44:47], v1, s[4:7], s21 offen
    s_mov_b32 s21, 121638912
    buffer_store_dwordx4 v[48:51], v1, s[4:7], s21 offen
    s_mov_b32 s21, 121649152
    buffer_store_dwordx4 v[48:51], v1, s[4:7], s21 offen
    s_mov_b32 s21, 121644032
    buffer_store_dwordx4 v[52:55], v1, s[4:7], s21 offen
    s_mov_b32 s21, 121654272
    buffer_store_dwordx4 v[52:55], v1, s[4:7], s21 offen
    s_endpgm
pr_ln:
    s_load_dwordx2 s[8:9], s[0:1], 0
    s_mov_b32 s10, 2621440
    s_mov_b32 s11, 0x00020000
    v_mul_u32_u24 v4, 1280, v3
    v_lshl_add_u32 v4, v2, 4, v4
    s_lshr_b32 s23, s20, 2
    s_mul_i32 s23, s23, 20480
    s_mul_i32 s21, s3, 320
    s_add_u32 s23, s23, s21
    s_mul_i32 s21, s20, 5120
    s_lshl_b32 s24, s3, 2
    v_add_u32 v7, s24, v1
    s_mov_b32 s22, 0xffff0000
    s_waitcnt lgkmcnt(0)
    buffer_load_dwordx4 v[16:19], v4, s[8:11], s23 offen offset:0 nt
    buffer_load_dwordx4 v[20:23], v4, s[8:11], s23 offen offset:64 nt
    buffer_load_dwordx4 v[24:27], v4, s[8:11], s23 offen offset:128 nt
    buffer_load_dwordx4 v[28:31], v4, s[8:11], s23 offen offset:192 nt
    buffer_load_dwordx4 v[32:35], v4, s[8:11], s23 offen offset:256 nt
    v_mov_b32 v8, 0
    v_mov_b32 v9, 0
    s_waitcnt vmcnt(0)
    v_lshlrev_b32 v5, 16, v16
    v_and_b32 v6, s22, v16
    v_add_f32 v8, v8, v5
    v_add_f32 v9, v9, v6
    v_lshlrev_b32 v5, 16, v17
    v_and_b32 v6, s22, v17
    v_add_f32 v8, v8, v5
    v_add_f32 v9, v9, v6
    v_lshlrev_b32 v5, 16, v18
    v_and_b32 v6, s22, v18
    v_add_f32 v8, v8, v5
    v_add_f32 v9, v9, v6
    v_lshlrev_b32 v5, 16, v19
    v_and_b32 v6, s22, v19
    v_add_f32 v8, v8, v5
    v_add_f32 v9, v9, v6
    v_lshlrev_b32 v5, 16, v20
    v_and_b32 v6, s22, v20
    v_add_f32 v8, v8, v5
    v_add_f32 v9, v9, v6
    v_lshlrev_b32 v5, 16, v21
    v_and_b32 v6, s22, v21
    v_add_f32 v8, v8, v5
    v_add_f32 v9, v9, v6
    v_lshlrev_b32 v5, 16, v22
    v_and_b32 v6, s22, v22
    v_add_f32 v8, v8, v5
    v_add_f32 v9, v9, v6
    v_lshlrev_b32 v5, 16, v23
    v_and_b32 v6, s22, v23
    v_add_f32 v8, v8, v5
    v_add_f32 v9, v9, v6
    v_lshlrev_b32 v5, 16, v24
    v_and_b32 v6, s22, v24
    v_add_f32 v8, v8, v5
    v_add_f32 v9, v9, v6
    v_lshlrev_b32 v5, 16, v25
    v_and_b32 v6, s22, v25
    v_add_f32 v8, v8, v5
    v_add_f32 v9, v9, v6
    v_lshlrev_b32 v5, 16, v26
    v_and_b32 v6, s22, v26
    v_add_f32 v8, v8, v5
    v_add_f32 v9, v9, v6
    v_lshlrev_b32 v5, 16, v27
    v_and_b32 v6, s22, v27
    v_add_f32 v8, v8, v5
    v_add_f32 v9, v9, v6
    v_lshlrev_b32 v5, 16, v28
    v_and_b32 v6, s22, v28
    v_add_f32 v8, v8, v5
    v_add_f32 v9, v9, v6
    v_lshlrev_b32 v5, 16, v29
    v_and_b32 v6, s22, v29
    v_add_f32 v8, v8, v5
    v_add_f32 v9, v9, v6
    v_lshlrev_b32 v5, 16, v30
    v_and_b32 v6, s22, v30
    v_add_f32 v8, v8, v5
    v_add_f32 v9, v9, v6
    v_lshlrev_b32 v5, 16, v31
    v_and_b32 v6, s22, v31
    v_add_f32 v8, v8, v5
    v_add_f32 v9, v9, v6
    v_lshlrev_b32 v5, 16, v32
    v_and_b32 v6, s22, v32
    v_add_f32 v8, v8, v5
    v_add_f32 v9, v9, v6
    v_lshlrev_b32 v5, 16, v33
    v_and_b32 v6, s22, v33
    v_add_f32 v8, v8, v5
    v_add_f32 v9, v9, v6
    v_lshlrev_b32 v5, 16, v34
    v_and_b32 v6, s22, v34
    v_add_f32 v8, v8, v5
    v_add_f32 v9, v9, v6
    v_lshlrev_b32 v5, 16, v35
    v_and_b32 v6, s22, v35
    v_add_f32 v8, v8, v5
    v_add_f32 v9, v9, v6
    v_add_f32 v8, v8, v9
    ds_write_b32 v7, v8 offset:0
    s_waitcnt lgkmcnt(0)
    s_barrier
    ds_read_b128 v[12:15], v1 offset:0
    s_waitcnt lgkmcnt(0)
    v_add_f32 v12, v12, v13
    v_add_f32 v14, v14, v15
    v_add_f32 v8, v12, v14
    v_mov_b32 v9, v8
    s_nop 1
    v_permlane32_swap_b32 v9, v8
    s_nop 1
    v_add_f32 v8, v8, v9
    v_mov_b32 v9, v8
    s_nop 1
    v_permlane16_swap_b32 v9, v8
    s_nop 1
    v_add_f32 v8, v8, v9
    v_mul_f32 v8, 0x3acccccd, v8
    v_mov_b32 v10, 0
    v_mov_b32 v11, 0
    v_lshlrev_b32 v5, 16, v16
    v_and_b32 v6, s22, v16
    v_sub_f32 v5, v5, v8
    v_sub_f32 v6, v6, v8
    v_fmac_f32 v10, v5, v5
    v_fmac_f32 v11, v6, v6
    v_lshlrev_b32 v5, 16, v17
    v_and_b32 v6, s22, v17
    v_sub_f32 v5, v5, v8
    v_sub_f32 v6, v6, v8
    v_fmac_f32 v10, v5, v5
    v_fmac_f32 v11, v6, v6
    v_lshlrev_b32 v5, 16, v18
    v_and_b32 v6, s22, v18
    v_sub_f32 v5, v5, v8
    v_sub_f32 v6, v6, v8
    v_fmac_f32 v10, v5, v5
    v_fmac_f32 v11, v6, v6
    v_lshlrev_b32 v5, 16, v19
    v_and_b32 v6, s22, v19
    v_sub_f32 v5, v5, v8
    v_sub_f32 v6, v6, v8
    v_fmac_f32 v10, v5, v5
    v_fmac_f32 v11, v6, v6
    v_lshlrev_b32 v5, 16, v20
    v_and_b32 v6, s22, v20
    v_sub_f32 v5, v5, v8
    v_sub_f32 v6, v6, v8
    v_fmac_f32 v10, v5, v5
    v_fmac_f32 v11, v6, v6
    v_lshlrev_b32 v5, 16, v21
    v_and_b32 v6, s22, v21
    v_sub_f32 v5, v5, v8
    v_sub_f32 v6, v6, v8
    v_fmac_f32 v10, v5, v5
    v_fmac_f32 v11, v6, v6
    v_lshlrev_b32 v5, 16, v22
    v_and_b32 v6, s22, v22
    v_sub_f32 v5, v5, v8
    v_sub_f32 v6, v6, v8
    v_fmac_f32 v10, v5, v5
    v_fmac_f32 v11, v6, v6
    v_lshlrev_b32 v5, 16, v23
    v_and_b32 v6, s22, v23
    v_sub_f32 v5, v5, v8
    v_sub_f32 v6, v6, v8
    v_fmac_f32 v10, v5, v5
    v_fmac_f32 v11, v6, v6
    v_lshlrev_b32 v5, 16, v24
    v_and_b32 v6, s22, v24
    v_sub_f32 v5, v5, v8
    v_sub_f32 v6, v6, v8
    v_fmac_f32 v10, v5, v5
    v_fmac_f32 v11, v6, v6
    v_lshlrev_b32 v5, 16, v25
    v_and_b32 v6, s22, v25
    v_sub_f32 v5, v5, v8
    v_sub_f32 v6, v6, v8
    v_fmac_f32 v10, v5, v5
    v_fmac_f32 v11, v6, v6
    v_lshlrev_b32 v5, 16, v26
    v_and_b32 v6, s22, v26
    v_sub_f32 v5, v5, v8
    v_sub_f32 v6, v6, v8
    v_fmac_f32 v10, v5, v5
    v_fmac_f32 v11, v6, v6
    v_lshlrev_b32 v5, 16, v27
    v_and_b32 v6, s22, v27
    v_sub_f32 v5, v5, v8
    v_sub_f32 v6, v6, v8
    v_fmac_f32 v10, v5, v5
    v_fmac_f32 v11, v6, v6
    v_lshlrev_b32 v5, 16, v28
    v_and_b32 v6, s22, v28
    v_sub_f32 v5, v5, v8
    v_sub_f32 v6, v6, v8
    v_fmac_f32 v10, v5, v5
    v_fmac_f32 v11, v6, v6
    v_lshlrev_b32 v5, 16, v29
    v_and_b32 v6, s22, v29
    v_sub_f32 v5, v5, v8
    v_sub_f32 v6, v6, v8
    v_fmac_f32 v10, v5, v5
    v_fmac_f32 v11, v6, v6
    v_lshlrev_b32 v5, 16, v30
    v_and_b32 v6, s22, v30
    v_sub_f32 v5, v5, v8
    v_sub_f32 v6, v6, v8
    v_fmac_f32 v10, v5, v5
    v_fmac_f32 v11, v6, v6
    v_lshlrev_b32 v5, 16, v31
    v_and_b32 v6, s22, v31
    v_sub_f32 v5, v5, v8
    v_sub_f32 v6, v6, v8
    v_fmac_f32 v10, v5, v5
    v_fmac_f32 v11, v6, v6
    v_lshlrev_b32 v5, 16, v32
    v_and_b32 v6, s22, v32
    v_sub_f32 v5, v5, v8
    v_sub_f32 v6, v6, v8
    v_fmac_f32 v10, v5, v5
    v_fmac_f32 v11, v6, v6
    v_lshlrev_b32 v5, 16, v33
    v_and_b32 v6, s22, v33
    v_sub_f32 v5, v5, v8
    v_sub_f32 v6, v6, v8
    v_fmac_f32 v10, v5, v5
    v_fmac_f32 v11, v6, v6
    v_lshlrev_b32 v5, 16, v34
    v_and_b32 v6, s22, v34
    v_sub_f32 v5, v5, v8
    v_sub_f32 v6, v6, v8
    v_fmac_f32 v10, v5, v5
    v_fmac_f32 v11, v6, v6
    v_lshlrev_b32 v5, 16, v35
    v_and_b32 v6, s22, v35
    v_sub_f32 v5, v5, v8
    v_sub_f32 v6, v6, v8
    v_fmac_f32 v10, v5, v5
    v_fmac_f32 v11, v6, v6
    v_add_f32 v10, v10, v11
    ds_write_b32 v7, v10 offset:1024
    s_waitcnt lgkmcnt(0)
    s_barrier
    ds_read_b128 v[12:15], v1 offset:1024
    s_waitcnt lgkmcnt(0)
    v_add_f32 v12, v12, v13
    v_add_f32 v14, v14, v15
    v_add_f32 v10, v12, v14
    v_mov_b32 v9, v10
    s_nop 1
    v_permlane32_swap_b32 v9, v10
    s_nop 1
    v_add_f32 v10, v10, v9
    v_mov_b32 v9, v10
    s_nop 1
    v_permlane16_swap_b32 v9, v10
    s_nop 1
    v_add_f32 v10, v10, v9
    v_mul_f32 v10, 0x3acccccd, v10
    v_cvt_pk_bf16_f32 v8, v8, v10
    v_and_b32 v10, s22, v8
    v_lshlrev_b32 v8, 16, v8
    v_add_f32 v10, 0x3727c5ac, v10
    v_cvt_pk_bf16_f32 v10, v10, v10
    v_and_b32 v10, s22, v10
    v_sqrt_f32 v10, v10
    s_nop 0
    v_cvt_pk_bf16_f32 v10, v10, v10
    v_and_b32 v10, s22, v10
    v_rcp_f32 v10, v10
    s_nop 0
    v_lshlrev_b32 v5, 16, v16
    v_and_b32 v6, s22, v16
    v_sub_f32 v5, v5, v8
    v_sub_f32 v6, v6, v8
    v_cvt_pk_bf16_f32 v6, v5, v6
    v_lshlrev_b32 v5, 16, v6
    v_and_b32 v6, s22, v6
    v_mul_f32 v5, v5, v10
    v_mul_f32 v6, v6, v10
    v_cvt_pk_bf16_f32 v16, v5, v6
    v_lshlrev_b32 v5, 16, v17
    v_and_b32 v6, s22, v17
    v_sub_f32 v5, v5, v8
    v_sub_f32 v6, v6, v8
    v_cvt_pk_bf16_f32 v6, v5, v6
    v_lshlrev_b32 v5, 16, v6
    v_and_b32 v6, s22, v6
    v_mul_f32 v5, v5, v10
    v_mul_f32 v6, v6, v10
    v_cvt_pk_bf16_f32 v17, v5, v6
    v_lshlrev_b32 v5, 16, v18
    v_and_b32 v6, s22, v18
    v_sub_f32 v5, v5, v8
    v_sub_f32 v6, v6, v8
    v_cvt_pk_bf16_f32 v6, v5, v6
    v_lshlrev_b32 v5, 16, v6
    v_and_b32 v6, s22, v6
    v_mul_f32 v5, v5, v10
    v_mul_f32 v6, v6, v10
    v_cvt_pk_bf16_f32 v18, v5, v6
    v_lshlrev_b32 v5, 16, v19
    v_and_b32 v6, s22, v19
    v_sub_f32 v5, v5, v8
    v_sub_f32 v6, v6, v8
    v_cvt_pk_bf16_f32 v6, v5, v6
    v_lshlrev_b32 v5, 16, v6
    v_and_b32 v6, s22, v6
    v_mul_f32 v5, v5, v10
    v_mul_f32 v6, v6, v10
    v_cvt_pk_bf16_f32 v19, v5, v6
    buffer_store_dwordx4 v[16:19], v1, s[4:7], s21 offen offset:0
    v_lshlrev_b32 v5, 16, v20
    v_and_b32 v6, s22, v20
    v_sub_f32 v5, v5, v8
    v_sub_f32 v6, v6, v8
    v_cvt_pk_bf16_f32 v6, v5, v6
    v_lshlrev_b32 v5, 16, v6
    v_and_b32 v6, s22, v6
    v_mul_f32 v5, v5, v10
    v_mul_f32 v6, v6, v10
    v_cvt_pk_bf16_f32 v20, v5, v6
    v_lshlrev_b32 v5, 16, v21
    v_and_b32 v6, s22, v21
    v_sub_f32 v5, v5, v8
    v_sub_f32 v6, v6, v8
    v_cvt_pk_bf16_f32 v6, v5, v6
    v_lshlrev_b32 v5, 16, v6
    v_and_b32 v6, s22, v6
    v_mul_f32 v5, v5, v10
    v_mul_f32 v6, v6, v10
    v_cvt_pk_bf16_f32 v21, v5, v6
    v_lshlrev_b32 v5, 16, v22
    v_and_b32 v6, s22, v22
    v_sub_f32 v5, v5, v8
    v_sub_f32 v6, v6, v8
    v_cvt_pk_bf16_f32 v6, v5, v6
    v_lshlrev_b32 v5, 16, v6
    v_and_b32 v6, s22, v6
    v_mul_f32 v5, v5, v10
    v_mul_f32 v6, v6, v10
    v_cvt_pk_bf16_f32 v22, v5, v6
    v_lshlrev_b32 v5, 16, v23
    v_and_b32 v6, s22, v23
    v_sub_f32 v5, v5, v8
    v_sub_f32 v6, v6, v8
    v_cvt_pk_bf16_f32 v6, v5, v6
    v_lshlrev_b32 v5, 16, v6
    v_and_b32 v6, s22, v6
    v_mul_f32 v5, v5, v10
    v_mul_f32 v6, v6, v10
    v_cvt_pk_bf16_f32 v23, v5, v6
    buffer_store_dwordx4 v[20:23], v1, s[4:7], s21 offen offset:1024
    v_lshlrev_b32 v5, 16, v24
    v_and_b32 v6, s22, v24
    v_sub_f32 v5, v5, v8
    v_sub_f32 v6, v6, v8
    v_cvt_pk_bf16_f32 v6, v5, v6
    v_lshlrev_b32 v5, 16, v6
    v_and_b32 v6, s22, v6
    v_mul_f32 v5, v5, v10
    v_mul_f32 v6, v6, v10
    v_cvt_pk_bf16_f32 v24, v5, v6
    v_lshlrev_b32 v5, 16, v25
    v_and_b32 v6, s22, v25
    v_sub_f32 v5, v5, v8
    v_sub_f32 v6, v6, v8
    v_cvt_pk_bf16_f32 v6, v5, v6
    v_lshlrev_b32 v5, 16, v6
    v_and_b32 v6, s22, v6
    v_mul_f32 v5, v5, v10
    v_mul_f32 v6, v6, v10
    v_cvt_pk_bf16_f32 v25, v5, v6
    v_lshlrev_b32 v5, 16, v26
    v_and_b32 v6, s22, v26
    v_sub_f32 v5, v5, v8
    v_sub_f32 v6, v6, v8
    v_cvt_pk_bf16_f32 v6, v5, v6
    v_lshlrev_b32 v5, 16, v6
    v_and_b32 v6, s22, v6
    v_mul_f32 v5, v5, v10
    v_mul_f32 v6, v6, v10
    v_cvt_pk_bf16_f32 v26, v5, v6
    v_lshlrev_b32 v5, 16, v27
    v_and_b32 v6, s22, v27
    v_sub_f32 v5, v5, v8
    v_sub_f32 v6, v6, v8
    v_cvt_pk_bf16_f32 v6, v5, v6
    v_lshlrev_b32 v5, 16, v6
    v_and_b32 v6, s22, v6
    v_mul_f32 v5, v5, v10
    v_mul_f32 v6, v6, v10
    v_cvt_pk_bf16_f32 v27, v5, v6
    buffer_store_dwordx4 v[24:27], v1, s[4:7], s21 offen offset:2048
    v_lshlrev_b32 v5, 16, v28
    v_and_b32 v6, s22, v28
    v_sub_f32 v5, v5, v8
    v_sub_f32 v6, v6, v8
    v_cvt_pk_bf16_f32 v6, v5, v6
    v_lshlrev_b32 v5, 16, v6
    v_and_b32 v6, s22, v6
    v_mul_f32 v5, v5, v10
    v_mul_f32 v6, v6, v10
    v_cvt_pk_bf16_f32 v28, v5, v6
    v_lshlrev_b32 v5, 16, v29
    v_and_b32 v6, s22, v29
    v_sub_f32 v5, v5, v8
    v_sub_f32 v6, v6, v8
    v_cvt_pk_bf16_f32 v6, v5, v6
    v_lshlrev_b32 v5, 16, v6
    v_and_b32 v6, s22, v6
    v_mul_f32 v5, v5, v10
    v_mul_f32 v6, v6, v10
    v_cvt_pk_bf16_f32 v29, v5, v6
    v_lshlrev_b32 v5, 16, v30
    v_and_b32 v6, s22, v30
    v_sub_f32 v5, v5, v8
    v_sub_f32 v6, v6, v8
    v_cvt_pk_bf16_f32 v6, v5, v6
    v_lshlrev_b32 v5, 16, v6
    v_and_b32 v6, s22, v6
    v_mul_f32 v5, v5, v10
    v_mul_f32 v6, v6, v10
    v_cvt_pk_bf16_f32 v30, v5, v6
    v_lshlrev_b32 v5, 16, v31
    v_and_b32 v6, s22, v31
    v_sub_f32 v5, v5, v8
    v_sub_f32 v6, v6, v8
    v_cvt_pk_bf16_f32 v6, v5, v6
    v_lshlrev_b32 v5, 16, v6
    v_and_b32 v6, s22, v6
    v_mul_f32 v5, v5, v10
    v_mul_f32 v6, v6, v10
    v_cvt_pk_bf16_f32 v31, v5, v6
    buffer_store_dwordx4 v[28:31], v1, s[4:7], s21 offen offset:3072
    s_add_u32 s21, s21, 4096
    v_lshlrev_b32 v5, 16, v32
    v_and_b32 v6, s22, v32
    v_sub_f32 v5, v5, v8
    v_sub_f32 v6, v6, v8
    v_cvt_pk_bf16_f32 v6, v5, v6
    v_lshlrev_b32 v5, 16, v6
    v_and_b32 v6, s22, v6
    v_mul_f32 v5, v5, v10
    v_mul_f32 v6, v6, v10
    v_cvt_pk_bf16_f32 v32, v5, v6
    v_lshlrev_b32 v5, 16, v33
    v_and_b32 v6, s22, v33
    v_sub_f32 v5, v5, v8
    v_sub_f32 v6, v6, v8
    v_cvt_pk_bf16_f32 v6, v5, v6
    v_lshlrev_b32 v5, 16, v6
    v_and_b32 v6, s22, v6
    v_mul_f32 v5, v5, v10
    v_mul_f32 v6, v6, v10
    v_cvt_pk_bf16_f32 v33, v5, v6
    v_lshlrev_b32 v5, 16, v34
    v_and_b32 v6, s22, v34
    v_sub_f32 v5, v5, v8
    v_sub_f32 v6, v6, v8
    v_cvt_pk_bf16_f32 v6, v5, v6
    v_lshlrev_b32 v5, 16, v6
    v_and_b32 v6, s22, v6
    v_mul_f32 v5, v5, v10
    v_mul_f32 v6, v6, v10
    v_cvt_pk_bf16_f32 v34, v5, v6
    v_lshlrev_b32 v5, 16, v35
    v_and_b32 v6, s22, v35
    v_sub_f32 v5, v5, v8
    v_sub_f32 v6, v6, v8
    v_cvt_pk_bf16_f32 v6, v5, v6
    v_lshlrev_b32 v5, 16, v6
    v_and_b32 v6, s22, v6
    v_mul_f32 v5, v5, v10
    v_mul_f32 v6, v6, v10
    v_cvt_pk_bf16_f32 v35, v5, v6
    buffer_store_dwordx4 v[32:35], v1, s[4:7], s21 offen offset:0
    s_endpgm
.globl main_kernel
.p2align 8
.type main_kernel,@function
main_kernel:
    s_cmp_ge_u32 s2, 256
    s_cbranch_scc0 main_kernel_go
    s_endpgm
main_kernel_go:
    s_load_dwordx2 s[4:5], s[0:1], 104
    s_mov_b32 s6, 268435456
    s_mov_b32 s7, 0x00020000
    v_lshrrev_b32 v1, 6, v0
    v_and_b32 v0, 63, v0
    v_readfirstlane_b32 s3, v1
    v_lshlrev_b32 v1, 4, v0
    v_lshrrev_b32 v2, 4, v0
    v_and_b32 v3, 15, v0
    s_load_dwordx2 s[72:73], s[0:1], 96
    s_mov_b32 s74, 256
    s_mov_b32 s75, 0x00020000
    s_and_b32 s19, s2, 7
    s_cmp_ge_u32 s19, 2
    s_cbranch_scc0 ch_entry
    s_lshr_b32 s20, s2, 3
    s_sub_u32 s19, s19, 2
    s_lshl_b32 s19, s19, 5
    s_add_u32 s19, s19, s20
    s_waitcnt lgkmcnt(0)
    s_load_dwordx2 s[8:9], s[0:1], 0
    s_mov_b32 s10, 2621440
    s_mov_b32 s11, 0x00020000
    s_load_dwordx2 s[12:13], s[0:1], 88
    s_mov_b32 s14, 2621440
    s_mov_b32 s15, 0x00020000
    s_mov_b32 s17, s19
    s_waitcnt lgkmcnt(0)
wk_next:
    s_cmp_ge_u32 s19, 496
    s_cbranch_scc1 wk_p2
    s_cmp_lt_u32 s19, 256
    s_cbranch_scc1 wk_kv
    s_and_b32 s21, s19, 7
    s_bfe_u32 s20, s19, 0x50003
    s_mul_i32 s22, s21, 327680
    s_cmp_ge_u32 s19, 384
    s_cbranch_scc1 wk_gu
    s_mul_i32 s23, s20, 327680
    s_add_u32 s23, s23, 3145728
    s_add_u32 s24, s23, 163840
    s_mul_i32 s40, s3, 163840
    s_add_u32 s40, s40, s22
    s_cmp_eq_u32 s3, 2
    s_cselect_b32 s40, s23, s40
    s_cmp_eq_u32 s3, 3
    s_cselect_b32 s40, s24, s40
    s_mov_b32 s39, 81920
    s_cmp_ge_u32 s3, 2
    s_cselect_b32 s39, 81920, s39
    s_add_u32 s44, s40, s39
    s_add_u32 s41, s40, 20480
    s_add_u32 s45, s44, 20480
    s_add_u32 s42, s40, 40960
    s_add_u32 s46, s44, 40960
    s_add_u32 s43, s40, 61440
    s_add_u32 s47, s44, 61440
    s_branch wk_run
wk_gu:
    s_sub_u32 s20, s20, 16
    s_mul_i32 s23, s20, 163840
    s_add_u32 s23, s23, 18874368
    s_add_u32 s24, s23, 81920
    s_mul_i32 s40, s3, 163840
    s_add_u32 s40, s40, s22
    s_cmp_eq_u32 s3, 2
    s_cselect_b32 s40, s23, s40
    s_cmp_eq_u32 s3, 3
    s_cselect_b32 s40, s24, s40
    s_mov_b32 s39, 81920
    s_cmp_ge_u32 s3, 2
    s_cselect_b32 s39, 2621440, s39
    s_add_u32 s44, s40, s39
    s_add_u32 s41, s40, 20480
    s_add_u32 s45, s44, 20480
    s_add_u32 s42, s40, 40960
    s_add_u32 s46, s44, 40960
    s_add_u32 s43, s40, 61440
    s_add_u32 s47, s44, 61440
wk_run:
    s_mul_i32 s38, s3, 8192
    v_mov_b32 v4, v1
    s_lshr_b32 s36, s3, 1
    s_and_b32 s37, s3, 1
    s_add_u32 m0, s38, 0
    s_nop 0
    buffer_load_dwordx4 v4, s[4:7], s40 offen  lds
    s_add_u32 m0, s38, 1024
    s_nop 0
    buffer_load_dwordx4 v4, s[4:7], s41 offen  lds
    s_add_u32 m0, s38, 2048
    s_nop 0
    buffer_load_dwordx4 v4, s[4:7], s42 offen  lds
    s_add_u32 m0, s38, 3072
    s_nop 0
    buffer_load_dwordx4 v4, s[4:7], s43 offen  lds
    s_add_u32 m0, s38, 4096
    s_nop 0
    buffer_load_dwordx4 v4, s[4:7], s44 offen  lds
    s_add_u32 m0, s38, 5120
    s_nop 0
    buffer_load_dwordx4 v4, s[4:7], s45 offen  lds
    s_add_u32 m0, s38, 6144
    s_nop 0
    buffer_load_dwordx4 v4, s[4:7], s46 offen  lds
    s_add_u32 m0, s38, 7168
    s_nop 0
    buffer_load_dwordx4 v4, s[4:7], s47 offen  lds
    v_add_u32 v4, 1024, v4
    s_add_u32 m0, s38, 32768
    s_nop 0
    buffer_load_dwordx4 v4, s[4:7], s40 offen  lds
    s_add_u32 m0, s38, 33792
    s_nop 0
    buffer_load_dwordx4 v4, s[4:7], s41 offen  lds
    s_add_u32 m0, s38, 34816
    s_nop 0
    buffer_load_dwordx4 v4, s[4:7], s42 offen  lds
    s_add_u32 m0, s38, 35840
    s_nop 0
    buffer_load_dwordx4 v4, s[4:7], s43 offen  lds
    s_add_u32 m0, s38, 36864
    s_nop 0
    buffer_load_dwordx4 v4, s[4:7], s44 offen  lds
    s_add_u32 m0, s38, 37888
    s_nop 0
    buffer_load_dwordx4 v4, s[4:7], s45 offen  lds
    s_add_u32 m0, s38, 38912
    s_nop 0
    buffer_load_dwordx4 v4, s[4:7], s46 offen  lds
    s_add_u32 m0, s38, 39936
    s_nop 0
    buffer_load_dwordx4 v4, s[4:7], s47 offen  lds
    v_add_u32 v4, 1024, v4
    s_add_u32 m0, s38, 65536
    s_nop 0
    buffer_load_dwordx4 v4, s[4:7], s40 offen  lds
    s_add_u32 m0, s38, 66560
    s_nop 0
    buffer_load_dwordx4 v4, s[4:7], s41 offen  lds
    s_add_u32 m0, s38, 67584
    s_nop 0
    buffer_load_dwordx4 v4, s[4:7], s42 offen  lds
    s_add_u32 m0, s38, 68608
    s_nop 0
    buffer_load_dwordx4 v4, s[4:7], s43 offen  lds
    s_add_u32 m0, s38, 69632
    s_nop 0
    buffer_load_dwordx4 v4, s[4:7], s44 offen  lds
    s_add_u32 m0, s38, 70656
    s_nop 0
    buffer_load_dwordx4 v4, s[4:7], s45 offen  lds
    s_add_u32 m0, s38, 71680
    s_nop 0
    buffer_load_dwordx4 v4, s[4:7], s46 offen  lds
    s_add_u32 m0, s38, 72704
    s_nop 0
    buffer_load_dwordx4 v4, s[4:7], s47 offen  lds
    v_add_u32 v4, 1024, v4
    s_add_u32 m0, s38, 98304
    s_nop 0
    buffer_load_dwordx4 v4, s[4:7], s40 offen  lds
    s_add_u32 m0, s38, 99328
    s_nop 0
    buffer_load_dwordx4 v4, s[4:7], s41 offen  lds
    s_add_u32 m0, s38, 100352
    s_nop 0
    buffer_load_dwordx4 v4, s[4:7], s42 offen  lds
    s_add_u32 m0, s38, 101376
    s_nop 0
    buffer_load_dwordx4 v4, s[4:7], s43 offen  lds
    s_add_u32 m0, s38, 102400
    s_nop 0
    buffer_load_dwordx4 v4, s[4:7], s44 offen  lds
    s_add_u32 m0, s38, 103424
    s_nop 0
    buffer_load_dwordx4 v4, s[4:7], s45 offen  lds
    s_add_u32 m0, s38, 104448
    s_nop 0
    buffer_load_dwordx4 v4, s[4:7], s46 offen  lds
    s_add_u32 m0, s38, 105472
    s_nop 0
    buffer_load_dwordx4 v4, s[4:7], s47 offen  lds
    v_add_u32 v4, 1024, v4
    s_mul_i32 s39, s36, 8192
    v_add_u32 v5, s39, v1
    s_mul_i32 s39, s37, 8192
    s_add_u32 s39, s39, 16384
    v_add_u32 v6, s39, v1
    v_add_u32 v7, 65536, v5
    v_add_u32 v8, 65536, v6
    s_mov_b32 s35, 20
    v_accvgpr_write_b32 a0, 0
    v_accvgpr_write_b32 a1, 0
    v_accvgpr_write_b32 a2, 0
    v_accvgpr_write_b32 a3, 0
    v_accvgpr_write_b32 a4, 0
    v_accvgpr_write_b32 a5, 0
    v_accvgpr_write_b32 a6, 0
    v_accvgpr_write_b32 a7, 0
    v_accvgpr_write_b32 a8, 0
    v_accvgpr_write_b32 a9, 0
    v_accvgpr_write_b32 a10, 0
    v_accvgpr_write_b32 a11, 0
    v_accvgpr_write_b32 a12, 0
    v_accvgpr_write_b32 a13, 0
    v_accvgpr_write_b32 a14, 0
    v_accvgpr_write_b32 a15, 0
    v_accvgpr_write_b32 a16, 0
    v_accvgpr_write_b32 a17, 0
    v_accvgpr_write_b32 a18, 0
    v_accvgpr_write_b32 a19, 0
    v_accvgpr_write_b32 a20, 0
    v_accvgpr_write_b32 a21, 0
    v_accvgpr_write_b32 a22, 0
    v_accvgpr_write_b32 a23, 0
    v_accvgpr_write_b32 a24, 0
    v_accvgpr_write_b32 a25, 0
    v_accvgpr_write_b32 a26, 0
    v_accvgpr_write_b32 a27, 0
    v_accvgpr_write_b32 a28, 0
    v_accvgpr_write_b32 a29, 0
    v_accvgpr_write_b32 a30, 0
    v_accvgpr_write_b32 a31, 0
    v_accvgpr_write_b32 a32, 0
    v_accvgpr_write_b32 a33, 0
    v_accvgpr_write_b32 a34, 0
    v_accvgpr_write_b32 a35, 0
    v_accvgpr_write_b32 a36, 0
    v_accvgpr_write_b32 a37, 0
    v_accvgpr_write_b32 a38, 0
    v_accvgpr_write_b32 a39, 0
    v_accvgpr_write_b32 a40, 0
    v_accvgpr_write_b32 a41, 0
    v_accvgpr_write_b32 a42, 0
    v_accvgpr_write_b32 a43, 0
    v_accvgpr_write_b32 a44, 0
    v_accvgpr_write_b32 a45, 0
    v_accvgpr_write_b32 a46, 0
    v_accvgpr_write_b32 a47, 0
    v_accvgpr_write_b32 a48, 0
    v_accvgpr_write_b32 a49, 0
    v_accvgpr_write_b32 a50, 0
    v_accvgpr_write_b32 a51, 0
    v_accvgpr_write_b32 a52, 0
    v_accvgpr_write_b32 a53, 0
    v_accvgpr_write_b32 a54, 0
    v_accvgpr_write_b32 a55, 0
    v_accvgpr_write_b32 a56, 0
    v_accvgpr_write_b32 a57, 0
    v_accvgpr_write_b32 a58, 0
    v_accvgpr_write_b32 a59, 0
    v_accvgpr_write_b32 a60, 0
    v_accvgpr_write_b32 a61, 0
    v_accvgpr_write_b32 a62, 0
    v_accvgpr_write_b32 a63, 0
    v_accvgpr_write_b32 a64, 0
    v_accvgpr_write_b32 a65, 0
    v_accvgpr_write_b32 a66, 0
    v_accvgpr_write_b32 a67, 0
    v_accvgpr_write_b32 a68, 0
    v_accvgpr_write_b32 a69, 0
    v_accvgpr_write_b32 a70, 0
    v_accvgpr_write_b32 a71, 0
    v_accvgpr_write_b32 a72, 0
    v_accvgpr_write_b32 a73, 0
    v_accvgpr_write_b32 a74, 0
    v_accvgpr_write_b32 a75, 0
    v_accvgpr_write_b32 a76, 0
    v_accvgpr_write_b32 a77, 0
    v_accvgpr_write_b32 a78, 0
    v_accvgpr_write_b32 a79, 0
    v_accvgpr_write_b32 a80, 0
    v_accvgpr_write_b32 a81, 0
    v_accvgpr_write_b32 a82, 0
    v_accvgpr_write_b32 a83, 0
    v_accvgpr_write_b32 a84, 0
    v_accvgpr_write_b32 a85, 0
    v_accvgpr_write_b32 a86, 0
    v_accvgpr_write_b32 a87, 0
    v_accvgpr_write_b32 a88, 0
    v_accvgpr_write_b32 a89, 0
    v_accvgpr_write_b32 a90, 0
    v_accvgpr_write_b32 a91, 0
    v_accvgpr_write_b32 a92, 0
    v_accvgpr_write_b32 a93, 0
    v_accvgpr_write_b32 a94, 0
    v_accvgpr_write_b32 a95, 0
    v_accvgpr_write_b32 a96, 0
    v_accvgpr_write_b32 a97, 0
    v_accvgpr_write_b32 a98, 0
    v_accvgpr_write_b32 a99, 0
    v_accvgpr_write_b32 a100, 0
    v_accvgpr_write_b32 a101, 0
    v_accvgpr_write_b32 a102, 0
    v_accvgpr_write_b32 a103, 0
    v_accvgpr_write_b32 a104, 0
    v_accvgpr_write_b32 a105, 0
    v_accvgpr_write_b32 a106, 0
    v_accvgpr_write_b32 a107, 0
    v_accvgpr_write_b32 a108, 0
    v_accvgpr_write_b32 a109, 0
    v_accvgpr_write_b32 a110, 0
    v_accvgpr_write_b32 a111, 0
    v_accvgpr_write_b32 a112, 0
    v_accvgpr_write_b32 a113, 0
    v_accvgpr_write_b32 a114, 0
    v_accvgpr_write_b32 a115, 0
    v_accvgpr_write_b32 a116, 0
    v_accvgpr_write_b32 a117, 0
    v_accvgpr_write_b32 a118, 0
    v_accvgpr_write_b32 a119, 0
    v_accvgpr_write_b32 a120, 0
    v_accvgpr_write_b32 a121, 0
    v_accvgpr_write_b32 a122, 0
    v_accvgpr_write_b32 a123, 0
    v_accvgpr_write_b32 a124, 0
    v_accvgpr_write_b32 a125, 0
    v_accvgpr_write_b32 a126, 0
    v_accvgpr_write_b32 a127, 0
    v_accvgpr_write_b32 a128, 0
    v_accvgpr_write_b32 a129, 0
    v_accvgpr_write_b32 a130, 0
    v_accvgpr_write_b32 a131, 0
    v_accvgpr_write_b32 a132, 0
    v_accvgpr_write_b32 a133, 0
    v_accvgpr_write_b32 a134, 0
    v_accvgpr_write_b32 a135, 0
    v_accvgpr_write_b32 a136, 0
    v_accvgpr_write_b32 a137, 0
    v_accvgpr_write_b32 a138, 0
    v_accvgpr_write_b32 a139, 0
    v_accvgpr_write_b32 a140, 0
    v_accvgpr_write_b32 a141, 0
    v_accvgpr_write_b32 a142, 0
    v_accvgpr_write_b32 a143, 0
    v_accvgpr_write_b32 a144, 0
    v_accvgpr_write_b32 a145, 0
    v_accvgpr_write_b32 a146, 0
    v_accvgpr_write_b32 a147, 0
    v_accvgpr_write_b32 a148, 0
    v_accvgpr_write_b32 a149, 0
    v_accvgpr_write_b32 a150, 0
    v_accvgpr_write_b32 a151, 0
    v_accvgpr_write_b32 a152, 0
    v_accvgpr_write_b32 a153, 0
    v_accvgpr_write_b32 a154, 0
    v_accvgpr_write_b32 a155, 0
    v_accvgpr_write_b32 a156, 0
    v_accvgpr_write_b32 a157, 0
    v_accvgpr_write_b32 a158, 0
    v_accvgpr_write_b32 a159, 0
    v_accvgpr_write_b32 a160, 0
    v_accvgpr_write_b32 a161, 0
    v_accvgpr_write_b32 a162, 0
    v_accvgpr_write_b32 a163, 0
    v_accvgpr_write_b32 a164, 0
    v_accvgpr_write_b32 a165, 0
    v_accvgpr_write_b32 a166, 0
    v_accvgpr_write_b32 a167, 0
    v_accvgpr_write_b32 a168, 0
    v_accvgpr_write_b32 a169, 0
    v_accvgpr_write_b32 a170, 0
    v_accvgpr_write_b32 a171, 0
    v_accvgpr_write_b32 a172, 0
    v_accvgpr_write_b32 a173, 0
    v_accvgpr_write_b32 a174, 0
    v_accvgpr_write_b32 a175, 0
    v_accvgpr_write_b32 a176, 0
    v_accvgpr_write_b32 a177, 0
    v_accvgpr_write_b32 a178, 0
    v_accvgpr_write_b32 a179, 0
    v_accvgpr_write_b32 a180, 0
    v_accvgpr_write_b32 a181, 0
    v_accvgpr_write_b32 a182, 0
    v_accvgpr_write_b32 a183, 0
    v_accvgpr_write_b32 a184, 0
    v_accvgpr_write_b32 a185, 0
    v_accvgpr_write_b32 a186, 0
    v_accvgpr_write_b32 a187, 0
    v_accvgpr_write_b32 a188, 0
    v_accvgpr_write_b32 a189, 0
    v_accvgpr_write_b32 a190, 0
    v_accvgpr_write_b32 a191, 0
    v_accvgpr_write_b32 a192, 0
    v_accvgpr_write_b32 a193, 0
    v_accvgpr_write_b32 a194, 0
    v_accvgpr_write_b32 a195, 0
    v_accvgpr_write_b32 a196, 0
    v_accvgpr_write_b32 a197, 0
    v_accvgpr_write_b32 a198, 0
    v_accvgpr_write_b32 a199, 0
    v_accvgpr_write_b32 a200, 0
    v_accvgpr_write_b32 a201, 0
    v_accvgpr_write_b32 a202, 0
    v_accvgpr_write_b32 a203, 0
    v_accvgpr_write_b32 a204, 0
    v_accvgpr_write_b32 a205, 0
    v_accvgpr_write_b32 a206, 0
    v_accvgpr_write_b32 a207, 0
    v_accvgpr_write_b32 a208, 0
    v_accvgpr_write_b32 a209, 0
    v_accvgpr_write_b32 a210, 0
    v_accvgpr_write_b32 a211, 0
    v_accvgpr_write_b32 a212, 0
    v_accvgpr_write_b32 a213, 0
    v_accvgpr_write_b32 a214, 0
    v_accvgpr_write_b32 a215, 0
    v_accvgpr_write_b32 a216, 0
    v_accvgpr_write_b32 a217, 0
    v_accvgpr_write_b32 a218, 0
    v_accvgpr_write_b32 a219, 0
    v_accvgpr_write_b32 a220, 0
    v_accvgpr_write_b32 a221, 0
    v_accvgpr_write_b32 a222, 0
    v_accvgpr_write_b32 a223, 0
    v_accvgpr_write_b32 a224, 0
    v_accvgpr_write_b32 a225, 0
    v_accvgpr_write_b32 a226, 0
    v_accvgpr_write_b32 a227, 0
    v_accvgpr_write_b32 a228, 0
    v_accvgpr_write_b32 a229, 0
    v_accvgpr_write_b32 a230, 0
    v_accvgpr_write_b32 a231, 0
    v_accvgpr_write_b32 a232, 0
    v_accvgpr_write_b32 a233, 0
    v_accvgpr_write_b32 a234, 0
    v_accvgpr_write_b32 a235, 0
    v_accvgpr_write_b32 a236, 0
    v_accvgpr_write_b32 a237, 0
    v_accvgpr_write_b32 a238, 0
    v_accvgpr_write_b32 a239, 0
    v_accvgpr_write_b32 a240, 0
    v_accvgpr_write_b32 a241, 0
    v_accvgpr_write_b32 a242, 0
    v_accvgpr_write_b32 a243, 0
    v_accvgpr_write_b32 a244, 0
    v_accvgpr_write_b32 a245, 0
    v_accvgpr_write_b32 a246, 0
    v_accvgpr_write_b32 a247, 0
    v_accvgpr_write_b32 a248, 0
    v_accvgpr_write_b32 a249, 0
    v_accvgpr_write_b32 a250, 0
    v_accvgpr_write_b32 a251, 0
    v_accvgpr_write_b32 a252, 0
    v_accvgpr_write_b32 a253, 0
    v_accvgpr_write_b32 a254, 0
    v_accvgpr_write_b32 a255, 0
    s_waitcnt vmcnt(24)
    s_barrier
    ds_read_b128 v[16:19], v5 offset:0
    ds_read_b128 v[20:23], v5 offset:1024
    ds_read_b128 v[24:27], v5 offset:2048
    ds_read_b128 v[28:31], v5 offset:3072
    ds_read_b128 v[32:35], v5 offset:4096
    ds_read_b128 v[36:39], v5 offset:5120
    ds_read_b128 v[40:43], v5 offset:6144
    ds_read_b128 v[44:47], v5 offset:7168
    ds_read_b128 v[48:51], v6 offset:0
    ds_read_b128 v[52:55], v6 offset:1024
    ds_read_b128 v[56:59], v6 offset:2048
    ds_read_b128 v[60:63], v6 offset:3072
    ds_read_b128 v[64:67], v6 offset:4096
    ds_read_b128 v[68:71], v6 offset:5120
    ds_read_b128 v[72:75], v6 offset:6144
    ds_read_b128 v[76:79], v6 offset:7168
wk_loop:
    s_waitcnt vmcnt(16) lgkmcnt(0)
    s_barrier
    v_mfma_f32_16x16x32_bf16 a[0:3], v[48:51], v[16:19], a[0:3]
    ds_read_b128 v[80:83], v5 offset:32768
    v_mfma_f32_16x16x32_bf16 a[4:7], v[52:55], v[16:19], a[4:7]
    ds_read_b128 v[84:87], v5 offset:33792
    v_mfma_f32_16x16x32_bf16 a[8:11], v[56:59], v[16:19], a[8:11]
    v_mfma_f32_16x16x32_bf16 a[12:15], v[60:63], v[16:19], a[12:15]
    ds_read_b128 v[88:91], v5 offset:34816
    v_mfma_f32_16x16x32_bf16 a[16:19], v[64:67], v[16:19], a[16:19]
    v_mfma_f32_16x16x32_bf16 a[20:23], v[68:71], v[16:19], a[20:23]
    ds_read_b128 v[92:95], v5 offset:35840
    v_mfma_f32_16x16x32_bf16 a[24:27], v[72:75], v[16:19], a[24:27]
    ds_read_b128 v[96:99], v5 offset:36864
    v_mfma_f32_16x16x32_bf16 a[28:31], v[76:79], v[16:19], a[28:31]
    v_mfma_f32_16x16x32_bf16 a[32:35], v[48:51], v[20:23], a[32:35]
    ds_read_b128 v[100:103], v5 offset:37888
    v_mfma_f32_16x16x32_bf16 a[36:39], v[52:55], v[20:23], a[36:39]
    v_mfma_f32_16x16x32_bf16 a[40:43], v[56:59], v[20:23], a[40:43]
    ds_read_b128 v[104:107], v5 offset:38912
    v_mfma_f32_16x16x32_bf16 a[44:47], v[60:63], v[20:23], a[44:47]
    ds_read_b128 v[108:111], v5 offset:39936
    v_mfma_f32_16x16x32_bf16 a[48:51], v[64:67], v[20:23], a[48:51]
    v_mfma_f32_16x16x32_bf16 a[52:55], v[68:71], v[20:23], a[52:55]
    ds_read_b128 v[112:115], v6 offset:32768
    v_mfma_f32_16x16x32_bf16 a[56:59], v[72:75], v[20:23], a[56:59]
    v_mfma_f32_16x16x32_bf16 a[60:63], v[76:79], v[20:23], a[60:63]
    ds_read_b128 v[116:119], v6 offset:33792
    v_mfma_f32_16x16x32_bf16 a[64:67], v[48:51], v[24:27], a[64:67]
    v_mfma_f32_16x16x32_bf16 a[68:71], v[52:55], v[24:27], a[68:71]
    ds_read_b128 v[120:123], v6 offset:34816
    v_mfma_f32_16x16x32_bf16 a[72:75], v[56:59], v[24:27], a[72:75]
    ds_read_b128 v[124:127], v6 offset:35840
    v_mfma_f32_16x16x32_bf16 a[76:79], v[60:63], v[24:27], a[76:79]
    v_mfma_f32_16x16x32_bf16 a[80:83], v[64:67], v[24:27], a[80:83]
    ds_read_b128 v[128:131], v6 offset:36864
    v_mfma_f32_16x16x32_bf16 a[84:87], v[68:71], v[24:27], a[84:87]
    v_mfma_f32_16x16x32_bf16 a[88:91], v[72:75], v[24:27], a[88:91]
    ds_read_b128 v[132:135], v6 offset:37888
    v_mfma_f32_16x16x32_bf16 a[92:95], v[76:79], v[24:27], a[92:95]
    ds_read_b128 v[136:139], v6 offset:38912
    v_mfma_f32_16x16x32_bf16 a[96:99], v[48:51], v[28:31], a[96:99]
    v_mfma_f32_16x16x32_bf16 a[100:103], v[52:55], v[28:31], a[100:103]
    ds_read_b128 v[140:143], v6 offset:39936
    v_mfma_f32_16x16x32_bf16 a[104:107], v[56:59], v[28:31], a[104:107]
    v_mfma_f32_16x16x32_bf16 a[108:111], v[60:63], v[28:31], a[108:111]
    s_add_u32 m0, s38, 0
    s_nop 0
    buffer_load_dwordx4 v4, s[4:7], s40 offen  lds
    v_mfma_f32_16x16x32_bf16 a[112:115], v[64:67], v[28:31], a[112:115]
    v_mfma_f32_16x16x32_bf16 a[116:119], v[68:71], v[28:31], a[116:119]
    s_add_u32 m0, s38, 1024
    s_nop 0
    buffer_load_dwordx4 v4, s[4:7], s41 offen  lds
    v_mfma_f32_16x16x32_bf16 a[120:123], v[72:75], v[28:31], a[120:123]
    s_add_u32 m0, s38, 2048
    s_nop 0
    buffer_load_dwordx4 v4, s[4:7], s42 offen  lds
    v_mfma_f32_16x16x32_bf16 a[124:127], v[76:79], v[28:31], a[124:127]
    v_mfma_f32_16x16x32_bf16 a[128:131], v[48:51], v[32:35], a[128:131]
    s_add_u32 m0, s38, 3072
    s_nop 0
    buffer_load_dwordx4 v4, s[4:7], s43 offen  lds
    v_mfma_f32_16x16x32_bf16 a[132:135], v[52:55], v[32:35], a[132:135]
    v_mfma_f32_16x16x32_bf16 a[136:139], v[56:59], v[32:35], a[136:139]
    s_add_u32 m0, s38, 4096
    s_nop 0
    buffer_load_dwordx4 v4, s[4:7], s44 offen  lds
    v_mfma_f32_16x16x32_bf16 a[140:143], v[60:63], v[32:35], a[140:143]
    s_add_u32 m0, s38, 5120
    s_nop 0
    buffer_load_dwordx4 v4, s[4:7], s45 offen  lds
    v_mfma_f32_16x16x32_bf16 a[144:147], v[64:67], v[32:35], a[144:147]
    v_mfma_f32_16x16x32_bf16 a[148:151], v[68:71], v[32:35], a[148:151]
    s_add_u32 m0, s38, 6144
    s_nop 0
    buffer_load_dwordx4 v4, s[4:7], s46 offen  lds
    v_mfma_f32_16x16x32_bf16 a[152:155], v[72:75], v[32:35], a[152:155]
    v_mfma_f32_16x16x32_bf16 a[156:159], v[76:79], v[32:35], a[156:159]
    s_add_u32 m0, s38, 7168
    s_nop 0
    buffer_load_dwordx4 v4, s[4:7], s47 offen  lds
    v_mfma_f32_16x16x32_bf16 a[160:163], v[48:51], v[36:39], a[160:163]
    v_add_u32 v4, 1024, v4
    v_mfma_f32_16x16x32_bf16 a[164:167], v[52:55], v[36:39], a[164:167]
    v_mfma_f32_16x16x32_bf16 a[168:171], v[56:59], v[36:39], a[168:171]
    v_mfma_f32_16x16x32_bf16 a[172:175], v[60:63], v[36:39], a[172:175]
    v_mfma_f32_16x16x32_bf16 a[176:179], v[64:67], v[36:39], a[176:179]
    v_mfma_f32_16x16x32_bf16 a[180:183], v[68:71], v[36:39], a[180:183]
    v_mfma_f32_16x16x32_bf16 a[184:187], v[72:75], v[36:39], a[184:187]
    v_mfma_f32_16x16x32_bf16 a[188:191], v[76:79], v[36:39], a[188:191]
    v_mfma_f32_16x16x32_bf16 a[192:195], v[48:51], v[40:43], a[192:195]
    v_mfma_f32_16x16x32_bf16 a[196:199], v[52:55], v[40:43], a[196:199]
    v_mfma_f32_16x16x32_bf16 a[200:203], v[56:59], v[40:43], a[200:203]
    v_mfma_f32_16x16x32_bf16 a[204:207], v[60:63], v[40:43], a[204:207]
    v_mfma_f32_16x16x32_bf16 a[208:211], v[64:67], v[40:43], a[208:211]
    v_mfma_f32_16x16x32_bf16 a[212:215], v[68:71], v[40:43], a[212:215]
    v_mfma_f32_16x16x32_bf16 a[216:219], v[72:75], v[40:43], a[216:219]
    v_mfma_f32_16x16x32_bf16 a[220:223], v[76:79], v[40:43], a[220:223]
    v_mfma_f32_16x16x32_bf16 a[224:227], v[48:51], v[44:47], a[224:227]
    v_mfma_f32_16x16x32_bf16 a[228:231], v[52:55], v[44:47], a[228:231]
    v_mfma_f32_16x16x32_bf16 a[232:235], v[56:59], v[44:47], a[232:235]
    v_mfma_f32_16x16x32_bf16 a[236:239], v[60:63], v[44:47], a[236:239]
    v_mfma_f32_16x16x32_bf16 a[240:243], v[64:67], v[44:47], a[240:243]
    v_mfma_f32_16x16x32_bf16 a[244:247], v[68:71], v[44:47], a[244:247]
    v_mfma_f32_16x16x32_bf16 a[248:251], v[72:75], v[44:47], a[248:251]
    v_mfma_f32_16x16x32_bf16 a[252:255], v[76:79], v[44:47], a[252:255]
    s_waitcnt vmcnt(16) lgkmcnt(0)
    s_barrier
    v_mfma_f32_16x16x32_bf16 a[0:3], v[112:115], v[80:83], a[0:3]
    ds_read_b128 v[16:19], v7 offset:0
    v_mfma_f32_16x16x32_bf16 a[4:7], v[116:119], v[80:83], a[4:7]
    ds_read_b128 v[20:23], v7 offset:1024
    v_mfma_f32_16x16x32_bf16 a[8:11], v[120:123], v[80:83], a[8:11]
    v_mfma_f32_16x16x32_bf16 a[12:15], v[124:127], v[80:83], a[12:15]
    ds_read_b128 v[24:27], v7 offset:2048
    v_mfma_f32_16x16x32_bf16 a[16:19], v[128:131], v[80:83], a[16:19]
    v_mfma_f32_16x16x32_bf16 a[20:23], v[132:135], v[80:83], a[20:23]
    ds_read_b128 v[28:31], v7 offset:3072
    v_mfma_f32_16x16x32_bf16 a[24:27], v[136:139], v[80:83], a[24:27]
    ds_read_b128 v[32:35], v7 offset:4096
    v_mfma_f32_16x16x32_bf16 a[28:31], v[140:143], v[80:83], a[28:31]
    v_mfma_f32_16x16x32_bf16 a[32:35], v[112:115], v[84:87], a[32:35]
    ds_read_b128 v[36:39], v7 offset:5120
    v_mfma_f32_16x16x32_bf16 a[36:39], v[116:119], v[84:87], a[36:39]
    v_mfma_f32_16x16x32_bf16 a[40:43], v[120:123], v[84:87], a[40:43]
    ds_read_b128 v[40:43], v7 offset:6144
    v_mfma_f32_16x16x32_bf16 a[44:47], v[124:127], v[84:87], a[44:47]
    ds_read_b128 v[44:47], v7 offset:7168
    v_mfma_f32_16x16x32_bf16 a[48:51], v[128:131], v[84:87], a[48:51]
    v_mfma_f32_16x16x32_bf16 a[52:55], v[132:135], v[84:87], a[52:55]
    ds_read_b128 v[48:51], v8 offset:0
    v_mfma_f32_16x16x32_bf16 a[56:59], v[136:139], v[84:87], a[56:59]
    v_mfma_f32_16x16x32_bf16 a[60:63], v[140:143], v[84:87], a[60:63]
    ds_read_b128 v[52:55], v8 offset:1024
    v_mfma_f32_16x16x32_bf16 a[64:67], v[112:115], v[88:91], a[64:67]
    v_mfma_f32_16x16x32_bf16 a[68:71], v[116:119], v[88:91], a[68:71]
    ds_read_b128 v[56:59], v8 offset:2048
    v_mfma_f32_16x16x32_bf16 a[72:75], v[120:123], v[88:91], a[72:75]
    ds_read_b128 v[60:63], v8 offset:3072
    v_mfma_f32_16x16x32_bf16 a[76:79], v[124:127], v[88:91], a[76:79]
    v_mfma_f32_16x16x32_bf16 a[80:83], v[128:131], v[88:91], a[80:83]
    ds_read_b128 v[64:67], v8 offset:4096
    v_mfma_f32_16x16x32_bf16 a[84:87], v[132:135], v[88:91], a[84:87]
    v_mfma_f32_16x16x32_bf16 a[88:91], v[136:139], v[88:91], a[88:91]
    ds_read_b128 v[68:71], v8 offset:5120
    v_mfma_f32_16x16x32_bf16 a[92:95], v[140:143], v[88:91], a[92:95]
    ds_read_b128 v[72:75], v8 offset:6144
    v_mfma_f32_16x16x32_bf16 a[96:99], v[112:115], v[92:95], a[96:99]
    v_mfma_f32_16x16x32_bf16 a[100:103], v[116:119], v[92:95], a[100:103]
    ds_read_b128 v[76:79], v8 offset:7168
    v_mfma_f32_16x16x32_bf16 a[104:107], v[120:123], v[92:95], a[104:107]
    v_mfma_f32_16x16x32_bf16 a[108:111], v[124:127], v[92:95], a[108:111]
    s_add_u32 m0, s38, 32768
    s_nop 0
    buffer_load_dwordx4 v4, s[4:7], s40 offen  lds
    v_mfma_f32_16x16x32_bf16 a[112:115], v[128:131], v[92:95], a[112:115]
    v_mfma_f32_16x16x32_bf16 a[116:119], v[132:135], v[92:95], a[116:119]
    s_add_u32 m0, s38, 33792
    s_nop 0
    buffer_load_dwordx4 v4, s[4:7], s41 offen  lds
    v_mfma_f32_16x16x32_bf16 a[120:123], v[136:139], v[92:95], a[120:123]
    s_add_u32 m0, s38, 34816
    s_nop 0
    buffer_load_dwordx4 v4, s[4:7], s42 offen  lds
    v_mfma_f32_16x16x32_bf16 a[124:127], v[140:143], v[92:95], a[124:127]
    v_mfma_f32_16x16x32_bf16 a[128:131], v[112:115], v[96:99], a[128:131]
    s_add_u32 m0, s38, 35840
    s_nop 0
    buffer_load_dwordx4 v4, s[4:7], s43 offen  lds
    v_mfma_f32_16x16x32_bf16 a[132:135], v[116:119], v[96:99], a[132:135]
    v_mfma_f32_16x16x32_bf16 a[136:139], v[120:123], v[96:99], a[136:139]
    s_add_u32 m0, s38, 36864
    s_nop 0
    buffer_load_dwordx4 v4, s[4:7], s44 offen  lds
    v_mfma_f32_16x16x32_bf16 a[140:143], v[124:127], v[96:99], a[140:143]
    s_add_u32 m0, s38, 37888
    s_nop 0
    buffer_load_dwordx4 v4, s[4:7], s45 offen  lds
    v_mfma_f32_16x16x32_bf16 a[144:147], v[128:131], v[96:99], a[144:147]
    v_mfma_f32_16x16x32_bf16 a[148:151], v[132:135], v[96:99], a[148:151]
    s_add_u32 m0, s38, 38912
    s_nop 0
    buffer_load_dwordx4 v4, s[4:7], s46 offen  lds
    v_mfma_f32_16x16x32_bf16 a[152:155], v[136:139], v[96:99], a[152:155]
    v_mfma_f32_16x16x32_bf16 a[156:159], v[140:143], v[96:99], a[156:159]
    s_add_u32 m0, s38, 39936
    s_nop 0
    buffer_load_dwordx4 v4, s[4:7], s47 offen  lds
    v_mfma_f32_16x16x32_bf16 a[160:163], v[112:115], v[100:103], a[160:163]
    v_add_u32 v4, 1024, v4
    v_mfma_f32_16x16x32_bf16 a[164:167], v[116:119], v[100:103], a[164:167]
    v_mfma_f32_16x16x32_bf16 a[168:171], v[120:123], v[100:103], a[168:171]
    v_mfma_f32_16x16x32_bf16 a[172:175], v[124:127], v[100:103], a[172:175]
    v_mfma_f32_16x16x32_bf16 a[176:179], v[128:131], v[100:103], a[176:179]
    v_mfma_f32_16x16x32_bf16 a[180:183], v[132:135], v[100:103], a[180:183]
    v_mfma_f32_16x16x32_bf16 a[184:187], v[136:139], v[100:103], a[184:187]
    v_mfma_f32_16x16x32_bf16 a[188:191], v[140:143], v[100:103], a[188:191]
    v_mfma_f32_16x16x32_bf16 a[192:195], v[112:115], v[104:107], a[192:195]
    v_mfma_f32_16x16x32_bf16 a[196:199], v[116:119], v[104:107], a[196:199]
    v_mfma_f32_16x16x32_bf16 a[200:203], v[120:123], v[104:107], a[200:203]
    v_mfma_f32_16x16x32_bf16 a[204:207], v[124:127], v[104:107], a[204:207]
    v_mfma_f32_16x16x32_bf16 a[208:211], v[128:131], v[104:107], a[208:211]
    v_mfma_f32_16x16x32_bf16 a[212:215], v[132:135], v[104:107], a[212:215]
    v_mfma_f32_16x16x32_bf16 a[216:219], v[136:139], v[104:107], a[216:219]
    v_mfma_f32_16x16x32_bf16 a[220:223], v[140:143], v[104:107], a[220:223]
    v_mfma_f32_16x16x32_bf16 a[224:227], v[112:115], v[108:111], a[224:227]
    v_mfma_f32_16x16x32_bf16 a[228:231], v[116:119], v[108:111], a[228:231]
    v_mfma_f32_16x16x32_bf16 a[232:235], v[120:123], v[108:111], a[232:235]
    v_mfma_f32_16x16x32_bf16 a[236:239], v[124:127], v[108:111], a[236:239]
    v_mfma_f32_16x16x32_bf16 a[240:243], v[128:131], v[108:111], a[240:243]
    v_mfma_f32_16x16x32_bf16 a[244:247], v[132:135], v[108:111], a[244:247]
    v_mfma_f32_16x16x32_bf16 a[248:251], v[136:139], v[108:111], a[248:251]
    v_mfma_f32_16x16x32_bf16 a[252:255], v[140:143], v[108:111], a[252:255]
    s_sub_u32 s35, s35, 2
    s_cmp_eq_u32 s35, 0
    s_cbranch_scc1 wk_end
    s_waitcnt vmcnt(16) lgkmcnt(0)
    s_barrier
    v_mfma_f32_16x16x32_bf16 a[0:3], v[48:51], v[16:19], a[0:3]
    ds_read_b128 v[80:83], v7 offset:32768
    v_mfma_f32_16x16x32_bf16 a[4:7], v[52:55], v[16:19], a[4:7]
    ds_read_b128 v[84:87], v7 offset:33792
    v_mfma_f32_16x16x32_bf16 a[8:11], v[56:59], v[16:19], a[8:11]
    v_mfma_f32_16x16x32_bf16 a[12:15], v[60:63], v[16:19], a[12:15]
    ds_read_b128 v[88:91], v7 offset:34816
    v_mfma_f32_16x16x32_bf16 a[16:19], v[64:67], v[16:19], a[16:19]
    v_mfma_f32_16x16x32_bf16 a[20:23], v[68:71], v[16:19], a[20:23]
    ds_read_b128 v[92:95], v7 offset:35840
    v_mfma_f32_16x16x32_bf16 a[24:27], v[72:75], v[16:19], a[24:27]
    ds_read_b128 v[96:99], v7 offset:36864
    v_mfma_f32_16x16x32_bf16 a[28:31], v[76:79], v[16:19], a[28:31]
    v_mfma_f32_16x16x32_bf16 a[32:35], v[48:51], v[20:23], a[32:35]
    ds_read_b128 v[100:103], v7 offset:37888
    v_mfma_f32_16x16x32_bf16 a[36:39], v[52:55], v[20:23], a[36:39]
    v_mfma_f32_16x16x32_bf16 a[40:43], v[56:59], v[20:23], a[40:43]
    ds_read_b128 v[104:107], v7 offset:38912
    v_mfma_f32_16x16x32_bf16 a[44:47], v[60:63], v[20:23], a[44:47]
    ds_read_b128 v[108:111], v7 offset:39936
    v_mfma_f32_16x16x32_bf16 a[48:51], v[64:67], v[20:23], a[48:51]
    v_mfma_f32_16x16x32_bf16 a[52:55], v[68:71], v[20:23], a[52:55]
    ds_read_b128 v[112:115], v8 offset:32768
    v_mfma_f32_16x16x32_bf16 a[56:59], v[72:75], v[20:23], a[56:59]
    v_mfma_f32_16x16x32_bf16 a[60:63], v[76:79], v[20:23], a[60:63]
    ds_read_b128 v[116:119], v8 offset:33792
    v_mfma_f32_16x16x32_bf16 a[64:67], v[48:51], v[24:27], a[64:67]
    v_mfma_f32_16x16x32_bf16 a[68:71], v[52:55], v[24:27], a[68:71]
    ds_read_b128 v[120:123], v8 offset:34816
    v_mfma_f32_16x16x32_bf16 a[72:75], v[56:59], v[24:27], a[72:75]
    ds_read_b128 v[124:127], v8 offset:35840
    v_mfma_f32_16x16x32_bf16 a[76:79], v[60:63], v[24:27], a[76:79]
    v_mfma_f32_16x16x32_bf16 a[80:83], v[64:67], v[24:27], a[80:83]
    ds_read_b128 v[128:131], v8 offset:36864
    v_mfma_f32_16x16x32_bf16 a[84:87], v[68:71], v[24:27], a[84:87]
    v_mfma_f32_16x16x32_bf16 a[88:91], v[72:75], v[24:27], a[88:91]
    ds_read_b128 v[132:135], v8 offset:37888
    v_mfma_f32_16x16x32_bf16 a[92:95], v[76:79], v[24:27], a[92:95]
    ds_read_b128 v[136:139], v8 offset:38912
    v_mfma_f32_16x16x32_bf16 a[96:99], v[48:51], v[28:31], a[96:99]
    v_mfma_f32_16x16x32_bf16 a[100:103], v[52:55], v[28:31], a[100:103]
    ds_read_b128 v[140:143], v8 offset:39936
    v_mfma_f32_16x16x32_bf16 a[104:107], v[56:59], v[28:31], a[104:107]
    v_mfma_f32_16x16x32_bf16 a[108:111], v[60:63], v[28:31], a[108:111]
    s_add_u32 m0, s38, 65536
    s_nop 0
    buffer_load_dwordx4 v4, s[4:7], s40 offen  lds
    v_mfma_f32_16x16x32_bf16 a[112:115], v[64:67], v[28:31], a[112:115]
    v_mfma_f32_16x16x32_bf16 a[116:119], v[68:71], v[28:31], a[116:119]
    s_add_u32 m0, s38, 66560
    s_nop 0
    buffer_load_dwordx4 v4, s[4:7], s41 offen  lds
    v_mfma_f32_16x16x32_bf16 a[120:123], v[72:75], v[28:31], a[120:123]
    s_add_u32 m0, s38, 67584
    s_nop 0
    buffer_load_dwordx4 v4, s[4:7], s42 offen  lds
    v_mfma_f32_16x16x32_bf16 a[124:127], v[76:79], v[28:31], a[124:127]
    v_mfma_f32_16x16x32_bf16 a[128:131], v[48:51], v[32:35], a[128:131]
    s_add_u32 m0, s38, 68608
    s_nop 0
    buffer_load_dwordx4 v4, s[4:7], s43 offen  lds
    v_mfma_f32_16x16x32_bf16 a[132:135], v[52:55], v[32:35], a[132:135]
    v_mfma_f32_16x16x32_bf16 a[136:139], v[56:59], v[32:35], a[136:139]
    s_add_u32 m0, s38, 69632
    s_nop 0
    buffer_load_dwordx4 v4, s[4:7], s44 offen  lds
    v_mfma_f32_16x16x32_bf16 a[140:143], v[60:63], v[32:35], a[140:143]
    s_add_u32 m0, s38, 70656
    s_nop 0
    buffer_load_dwordx4 v4, s[4:7], s45 offen  lds
    v_mfma_f32_16x16x32_bf16 a[144:147], v[64:67], v[32:35], a[144:147]
    v_mfma_f32_16x16x32_bf16 a[148:151], v[68:71], v[32:35], a[148:151]
    s_add_u32 m0, s38, 71680
    s_nop 0
    buffer_load_dwordx4 v4, s[4:7], s46 offen  lds
    v_mfma_f32_16x16x32_bf16 a[152:155], v[72:75], v[32:35], a[152:155]
    v_mfma_f32_16x16x32_bf16 a[156:159], v[76:79], v[32:35], a[156:159]
    s_add_u32 m0, s38, 72704
    s_nop 0
    buffer_load_dwordx4 v4, s[4:7], s47 offen  lds
    v_mfma_f32_16x16x32_bf16 a[160:163], v[48:51], v[36:39], a[160:163]
    v_add_u32 v4, 1024, v4
    v_mfma_f32_16x16x32_bf16 a[164:167], v[52:55], v[36:39], a[164:167]
    v_mfma_f32_16x16x32_bf16 a[168:171], v[56:59], v[36:39], a[168:171]
    v_mfma_f32_16x16x32_bf16 a[172:175], v[60:63], v[36:39], a[172:175]
    v_mfma_f32_16x16x32_bf16 a[176:179], v[64:67], v[36:39], a[176:179]
    v_mfma_f32_16x16x32_bf16 a[180:183], v[68:71], v[36:39], a[180:183]
    v_mfma_f32_16x16x32_bf16 a[184:187], v[72:75], v[36:39], a[184:187]
    v_mfma_f32_16x16x32_bf16 a[188:191], v[76:79], v[36:39], a[188:191]
    v_mfma_f32_16x16x32_bf16 a[192:195], v[48:51], v[40:43], a[192:195]
    v_mfma_f32_16x16x32_bf16 a[196:199], v[52:55], v[40:43], a[196:199]
    v_mfma_f32_16x16x32_bf16 a[200:203], v[56:59], v[40:43], a[200:203]
    v_mfma_f32_16x16x32_bf16 a[204:207], v[60:63], v[40:43], a[204:207]
    v_mfma_f32_16x16x32_bf16 a[208:211], v[64:67], v[40:43], a[208:211]
    v_mfma_f32_16x16x32_bf16 a[212:215], v[68:71], v[40:43], a[212:215]
    v_mfma_f32_16x16x32_bf16 a[216:219], v[72:75], v[40:43], a[216:219]
    v_mfma_f32_16x16x32_bf16 a[220:223], v[76:79], v[40:43], a[220:223]
    v_mfma_f32_16x16x32_bf16 a[224:227], v[48:51], v[44:47], a[224:227]
    v_mfma_f32_16x16x32_bf16 a[228:231], v[52:55], v[44:47], a[228:231]
    v_mfma_f32_16x16x32_bf16 a[232:235], v[56:59], v[44:47], a[232:235]
    v_mfma_f32_16x16x32_bf16 a[236:239], v[60:63], v[44:47], a[236:239]
    v_mfma_f32_16x16x32_bf16 a[240:243], v[64:67], v[44:47], a[240:243]
    v_mfma_f32_16x16x32_bf16 a[244:247], v[68:71], v[44:47], a[244:247]
    v_mfma_f32_16x16x32_bf16 a[248:251], v[72:75], v[44:47], a[248:251]
    v_mfma_f32_16x16x32_bf16 a[252:255], v[76:79], v[44:47], a[252:255]
    s_waitcnt vmcnt(16) lgkmcnt(0)
    s_barrier
    v_mfma_f32_16x16x32_bf16 a[0:3], v[112:115], v[80:83], a[0:3]
    ds_read_b128 v[16:19], v5 offset:0
    v_mfma_f32_16x16x32_bf16 a[4:7], v[116:119], v[80:83], a[4:7]
    ds_read_b128 v[20:23], v5 offset:1024
    v_mfma_f32_16x16x32_bf16 a[8:11], v[120:123], v[80:83], a[8:11]
    v_mfma_f32_16x16x32_bf16 a[12:15], v[124:127], v[80:83], a[12:15]
    ds_read_b128 v[24:27], v5 offset:2048
    v_mfma_f32_16x16x32_bf16 a[16:19], v[128:131], v[80:83], a[16:19]
    v_mfma_f32_16x16x32_bf16 a[20:23], v[132:135], v[80:83], a[20:23]
    ds_read_b128 v[28:31], v5 offset:3072
    v_mfma_f32_16x16x32_bf16 a[24:27], v[136:139], v[80:83], a[24:27]
    ds_read_b128 v[32:35], v5 offset:4096
    v_mfma_f32_16x16x32_bf16 a[28:31], v[140:143], v[80:83], a[28:31]
    v_mfma_f32_16x16x32_bf16 a[32:35], v[112:115], v[84:87], a[32:35]
    ds_read_b128 v[36:39], v5 offset:5120
    v_mfma_f32_16x16x32_bf16 a[36:39], v[116:119], v[84:87], a[36:39]
    v_mfma_f32_16x16x32_bf16 a[40:43], v[120:123], v[84:87], a[40:43]
    ds_read_b128 v[40:43], v5 offset:6144
    v_mfma_f32_16x16x32_bf16 a[44:47], v[124:127], v[84:87], a[44:47]
    ds_read_b128 v[44:47], v5 offset:7168
    v_mfma_f32_16x16x32_bf16 a[48:51], v[128:131], v[84:87], a[48:51]
    v_mfma_f32_16x16x32_bf16 a[52:55], v[132:135], v[84:87], a[52:55]
    ds_read_b128 v[48:51], v6 offset:0
    v_mfma_f32_16x16x32_bf16 a[56:59], v[136:139], v[84:87], a[56:59]
    v_mfma_f32_16x16x32_bf16 a[60:63], v[140:143], v[84:87], a[60:63]
    ds_read_b128 v[52:55], v6 offset:1024
    v_mfma_f32_16x16x32_bf16 a[64:67], v[112:115], v[88:91], a[64:67]
    v_mfma_f32_16x16x32_bf16 a[68:71], v[116:119], v[88:91], a[68:71]
    ds_read_b128 v[56:59], v6 offset:2048
    v_mfma_f32_16x16x32_bf16 a[72:75], v[120:123], v[88:91], a[72:75]
    ds_read_b128 v[60:63], v6 offset:3072
    v_mfma_f32_16x16x32_bf16 a[76:79], v[124:127], v[88:91], a[76:79]
    v_mfma_f32_16x16x32_bf16 a[80:83], v[128:131], v[88:91], a[80:83]
    ds_read_b128 v[64:67], v6 offset:4096
    v_mfma_f32_16x16x32_bf16 a[84:87], v[132:135], v[88:91], a[84:87]
    v_mfma_f32_16x16x32_bf16 a[88:91], v[136:139], v[88:91], a[88:91]
    ds_read_b128 v[68:71], v6 offset:5120
    v_mfma_f32_16x16x32_bf16 a[92:95], v[140:143], v[88:91], a[92:95]
    ds_read_b128 v[72:75], v6 offset:6144
    v_mfma_f32_16x16x32_bf16 a[96:99], v[112:115], v[92:95], a[96:99]
    v_mfma_f32_16x16x32_bf16 a[100:103], v[116:119], v[92:95], a[100:103]
    ds_read_b128 v[76:79], v6 offset:7168
    v_mfma_f32_16x16x32_bf16 a[104:107], v[120:123], v[92:95], a[104:107]
    v_mfma_f32_16x16x32_bf16 a[108:111], v[124:127], v[92:95], a[108:111]
    s_add_u32 m0, s38, 98304
    s_nop 0
    buffer_load_dwordx4 v4, s[4:7], s40 offen  lds
    v_mfma_f32_16x16x32_bf16 a[112:115], v[128:131], v[92:95], a[112:115]
    v_mfma_f32_16x16x32_bf16 a[116:119], v[132:135], v[92:95], a[116:119]
    s_add_u32 m0, s38, 99328
    s_nop 0
    buffer_load_dwordx4 v4, s[4:7], s41 offen  lds
    v_mfma_f32_16x16x32_bf16 a[120:123], v[136:139], v[92:95], a[120:123]
    s_add_u32 m0, s38, 100352
    s_nop 0
    buffer_load_dwordx4 v4, s[4:7], s42 offen  lds
    v_mfma_f32_16x16x32_bf16 a[124:127], v[140:143], v[92:95], a[124:127]
    v_mfma_f32_16x16x32_bf16 a[128:131], v[112:115], v[96:99], a[128:131]
    s_add_u32 m0, s38, 101376
    s_nop 0
    buffer_load_dwordx4 v4, s[4:7], s43 offen  lds
    v_mfma_f32_16x16x32_bf16 a[132:135], v[116:119], v[96:99], a[132:135]
    v_mfma_f32_16x16x32_bf16 a[136:139], v[120:123], v[96:99], a[136:139]
    s_add_u32 m0, s38, 102400
    s_nop 0
    buffer_load_dwordx4 v4, s[4:7], s44 offen  lds
    v_mfma_f32_16x16x32_bf16 a[140:143], v[124:127], v[96:99], a[140:143]
    s_add_u32 m0, s38, 103424
    s_nop 0
    buffer_load_dwordx4 v4, s[4:7], s45 offen  lds
    v_mfma_f32_16x16x32_bf16 a[144:147], v[128:131], v[96:99], a[144:147]
    v_mfma_f32_16x16x32_bf16 a[148:151], v[132:135], v[96:99], a[148:151]
    s_add_u32 m0, s38, 104448
    s_nop 0
    buffer_load_dwordx4 v4, s[4:7], s46 offen  lds
    v_mfma_f32_16x16x32_bf16 a[152:155], v[136:139], v[96:99], a[152:155]
    v_mfma_f32_16x16x32_bf16 a[156:159], v[140:143], v[96:99], a[156:159]
    s_add_u32 m0, s38, 105472
    s_nop 0
    buffer_load_dwordx4 v4, s[4:7], s47 offen  lds
    v_mfma_f32_16x16x32_bf16 a[160:163], v[112:115], v[100:103], a[160:163]
    v_add_u32 v4, 1024, v4
    v_mfma_f32_16x16x32_bf16 a[164:167], v[116:119], v[100:103], a[164:167]
    v_mfma_f32_16x16x32_bf16 a[168:171], v[120:123], v[100:103], a[168:171]
    v_mfma_f32_16x16x32_bf16 a[172:175], v[124:127], v[100:103], a[172:175]
    v_mfma_f32_16x16x32_bf16 a[176:179], v[128:131], v[100:103], a[176:179]
    v_mfma_f32_16x16x32_bf16 a[180:183], v[132:135], v[100:103], a[180:183]
    v_mfma_f32_16x16x32_bf16 a[184:187], v[136:139], v[100:103], a[184:187]
    v_mfma_f32_16x16x32_bf16 a[188:191], v[140:143], v[100:103], a[188:191]
    v_mfma_f32_16x16x32_bf16 a[192:195], v[112:115], v[104:107], a[192:195]
    v_mfma_f32_16x16x32_bf16 a[196:199], v[116:119], v[104:107], a[196:199]
    v_mfma_f32_16x16x32_bf16 a[200:203], v[120:123], v[104:107], a[200:203]
    v_mfma_f32_16x16x32_bf16 a[204:207], v[124:127], v[104:107], a[204:207]
    v_mfma_f32_16x16x32_bf16 a[208:211], v[128:131], v[104:107], a[208:211]
    v_mfma_f32_16x16x32_bf16 a[212:215], v[132:135], v[104:107], a[212:215]
    v_mfma_f32_16x16x32_bf16 a[216:219], v[136:139], v[104:107], a[216:219]
    v_mfma_f32_16x16x32_bf16 a[220:223], v[140:143], v[104:107], a[220:223]
    v_mfma_f32_16x16x32_bf16 a[224:227], v[112:115], v[108:111], a[224:227]
    v_mfma_f32_16x16x32_bf16 a[228:231], v[116:119], v[108:111], a[228:231]
    v_mfma_f32_16x16x32_bf16 a[232:235], v[120:123], v[108:111], a[232:235]
    v_mfma_f32_16x16x32_bf16 a[236:239], v[124:127], v[108:111], a[236:239]
    v_mfma_f32_16x16x32_bf16 a[240:243], v[128:131], v[108:111], a[240:243]
    v_mfma_f32_16x16x32_bf16 a[244:247], v[132:135], v[108:111], a[244:247]
    v_mfma_f32_16x16x32_bf16 a[248:251], v[136:139], v[108:111], a[248:251]
    v_mfma_f32_16x16x32_bf16 a[252:255], v[140:143], v[108:111], a[252:255]
    s_sub_u32 s35, s35, 2
    s_cmp_eq_u32 s35, 0
    s_cbranch_scc0 wk_loop
wk_end:
    s_waitcnt vmcnt(0) lgkmcnt(0)
    s_barrier
    s_nop 7
    s_lshl_b32 s20, s20, 1
    s_add_u32 s20, s20, s37
    s_cmp_ge_u32 s19, 384
    s_cbranch_scc1 wk_egu
    s_lshl_b32 s30, s21, 21
    s_lshl_b32 s31, s36, 20
    s_add_u32 s30, s30, s31
    s_lshl_b32 s31, s20, 12
    s_add_u32 s30, s30, s31
    s_add_u32 s30, s30, 33554432
    v_accvgpr_read_b32 v16, a0
    v_accvgpr_read_b32 v17, a1
    v_accvgpr_read_b32 v18, a2
    v_accvgpr_read_b32 v19, a3
    v_accvgpr_read_b32 v20, a4
    v_accvgpr_read_b32 v21, a5
    v_accvgpr_read_b32 v22, a6
    v_accvgpr_read_b32 v23, a7
    v_cvt_pk_bf16_f32 v24, v16, v17
    v_cvt_pk_bf16_f32 v25, v18, v19
    v_cvt_pk_bf16_f32 v26, v20, v21
    v_cvt_pk_bf16_f32 v27, v22, v23
    buffer_store_dwordx4 v[24:27], v1, s[4:7], s30 offen offset:0 sc1
    v_accvgpr_read_b32 v28, a8
    v_accvgpr_read_b32 v29, a9
    v_accvgpr_read_b32 v30, a10
    v_accvgpr_read_b32 v31, a11
    v_accvgpr_read_b32 v32, a12
    v_accvgpr_read_b32 v33, a13
    v_accvgpr_read_b32 v34, a14
    v_accvgpr_read_b32 v35, a15
    v_cvt_pk_bf16_f32 v36, v28, v29
    v_cvt_pk_bf16_f32 v37, v30, v31
    v_cvt_pk_bf16_f32 v38, v32, v33
    v_cvt_pk_bf16_f32 v39, v34, v35
    buffer_store_dwordx4 v[36:39], v1, s[4:7], s30 offen offset:1024 sc1
    v_accvgpr_read_b32 v40, a16
    v_accvgpr_read_b32 v41, a17
    v_accvgpr_read_b32 v42, a18
    v_accvgpr_read_b32 v43, a19
    v_accvgpr_read_b32 v44, a20
    v_accvgpr_read_b32 v45, a21
    v_accvgpr_read_b32 v46, a22
    v_accvgpr_read_b32 v47, a23
    v_cvt_pk_bf16_f32 v48, v40, v41
    v_cvt_pk_bf16_f32 v49, v42, v43
    v_cvt_pk_bf16_f32 v50, v44, v45
    v_cvt_pk_bf16_f32 v51, v46, v47
    buffer_store_dwordx4 v[48:51], v1, s[4:7], s30 offen offset:2048 sc1
    v_accvgpr_read_b32 v52, a24
    v_accvgpr_read_b32 v53, a25
    v_accvgpr_read_b32 v54, a26
    v_accvgpr_read_b32 v55, a27
    v_accvgpr_read_b32 v56, a28
    v_accvgpr_read_b32 v57, a29
    v_accvgpr_read_b32 v58, a30
    v_accvgpr_read_b32 v59, a31
    v_cvt_pk_bf16_f32 v60, v52, v53
    v_cvt_pk_bf16_f32 v61, v54, v55
    v_cvt_pk_bf16_f32 v62, v56, v57
    v_cvt_pk_bf16_f32 v63, v58, v59
    buffer_store_dwordx4 v[60:63], v1, s[4:7], s30 offen offset:3072 sc1
    s_add_u32 s30, s30, 0x20000
    v_accvgpr_read_b32 v16, a32
    v_accvgpr_read_b32 v17, a33
    v_accvgpr_read_b32 v18, a34
    v_accvgpr_read_b32 v19, a35
    v_accvgpr_read_b32 v20, a36
    v_accvgpr_read_b32 v21, a37
    v_accvgpr_read_b32 v22, a38
    v_accvgpr_read_b32 v23, a39
    v_cvt_pk_bf16_f32 v24, v16, v17
    v_cvt_pk_bf16_f32 v25, v18, v19
    v_cvt_pk_bf16_f32 v26, v20, v21
    v_cvt_pk_bf16_f32 v27, v22, v23
    buffer_store_dwordx4 v[24:27], v1, s[4:7], s30 offen offset:0 sc1
    v_accvgpr_read_b32 v28, a40
    v_accvgpr_read_b32 v29, a41
    v_accvgpr_read_b32 v30, a42
    v_accvgpr_read_b32 v31, a43
    v_accvgpr_read_b32 v32, a44
    v_accvgpr_read_b32 v33, a45
    v_accvgpr_read_b32 v34, a46
    v_accvgpr_read_b32 v35, a47
    v_cvt_pk_bf16_f32 v36, v28, v29
    v_cvt_pk_bf16_f32 v37, v30, v31
    v_cvt_pk_bf16_f32 v38, v32, v33
    v_cvt_pk_bf16_f32 v39, v34, v35
    buffer_store_dwordx4 v[36:39], v1, s[4:7], s30 offen offset:1024 sc1
    v_accvgpr_read_b32 v40, a48
    v_accvgpr_read_b32 v41, a49
    v_accvgpr_read_b32 v42, a50
    v_accvgpr_read_b32 v43, a51
    v_accvgpr_read_b32 v44, a52
    v_accvgpr_read_b32 v45, a53
    v_accvgpr_read_b32 v46, a54
    v_accvgpr_read_b32 v47, a55
    v_cvt_pk_bf16_f32 v48, v40, v41
    v_cvt_pk_bf16_f32 v49, v42, v43
    v_cvt_pk_bf16_f32 v50, v44, v45
    v_cvt_pk_bf16_f32 v51, v46, v47
    buffer_store_dwordx4 v[48:51], v1, s[4:7], s30 offen offset:2048 sc1
    v_accvgpr_read_b32 v52, a56
    v_accvgpr_read_b32 v53, a57
    v_accvgpr_read_b32 v54, a58
    v_accvgpr_read_b32 v55, a59
    v_accvgpr_read_b32 v56, a60
    v_accvgpr_read_b32 v57, a61
    v_accvgpr_read_b32 v58, a62
    v_accvgpr_read_b32 v59, a63
    v_cvt_pk_bf16_f32 v60, v52, v53
    v_cvt_pk_bf16_f32 v61, v54, v55
    v_cvt_pk_bf16_f32 v62, v56, v57
    v_cvt_pk_bf16_f32 v63, v58, v59
    buffer_store_dwordx4 v[60:63], v1, s[4:7], s30 offen offset:3072 sc1
    s_add_u32 s30, s30, 0x20000
    v_accvgpr_read_b32 v16, a64
    v_accvgpr_read_b32 v17, a65
    v_accvgpr_read_b32 v18, a66
    v_accvgpr_read_b32 v19, a67
    v_accvgpr_read_b32 v20, a68
    v_accvgpr_read_b32 v21, a69
    v_accvgpr_read_b32 v22, a70
    v_accvgpr_read_b32 v23, a71
    v_cvt_pk_bf16_f32 v24, v16, v17
    v_cvt_pk_bf16_f32 v25, v18, v19
    v_cvt_pk_bf16_f32 v26, v20, v21
    v_cvt_pk_bf16_f32 v27, v22, v23
    buffer_store_dwordx4 v[24:27], v1, s[4:7], s30 offen offset:0 sc1
    v_accvgpr_read_b32 v28, a72
    v_accvgpr_read_b32 v29, a73
    v_accvgpr_read_b32 v30, a74
    v_accvgpr_read_b32 v31, a75
    v_accvgpr_read_b32 v32, a76
    v_accvgpr_read_b32 v33, a77
    v_accvgpr_read_b32 v34, a78
    v_accvgpr_read_b32 v35, a79
    v_cvt_pk_bf16_f32 v36, v28, v29
    v_cvt_pk_bf16_f32 v37, v30, v31
    v_cvt_pk_bf16_f32 v38, v32, v33
    v_cvt_pk_bf16_f32 v39, v34, v35
    buffer_store_dwordx4 v[36:39], v1, s[4:7], s30 offen offset:1024 sc1
    v_accvgpr_read_b32 v40, a80
    v_accvgpr_read_b32 v41, a81
    v_accvgpr_read_b32 v42, a82
    v_accvgpr_read_b32 v43, a83
    v_accvgpr_read_b32 v44, a84
    v_accvgpr_read_b32 v45, a85
    v_accvgpr_read_b32 v46, a86
    v_accvgpr_read_b32 v47, a87
    v_cvt_pk_bf16_f32 v48, v40, v41
    v_cvt_pk_bf16_f32 v49, v42, v43
    v_cvt_pk_bf16_f32 v50, v44, v45
    v_cvt_pk_bf16_f32 v51, v46, v47
    buffer_store_dwordx4 v[48:51], v1, s[4:7], s30 offen offset:2048 sc1
    v_accvgpr_read_b32 v52, a88
    v_accvgpr_read_b32 v53, a89
    v_accvgpr_read_b32 v54, a90
    v_accvgpr_read_b32 v55, a91
    v_accvgpr_read_b32 v56, a92
    v_accvgpr_read_b32 v57, a93
    v_accvgpr_read_b32 v58, a94
    v_accvgpr_read_b32 v59, a95
    v_cvt_pk_bf16_f32 v60, v52, v53
    v_cvt_pk_bf16_f32 v61, v54, v55
    v_cvt_pk_bf16_f32 v62, v56, v57
    v_cvt_pk_bf16_f32 v63, v58, v59
    buffer_store_dwordx4 v[60:63], v1, s[4:7], s30 offen offset:3072 sc1
    s_add_u32 s30, s30, 0x20000
    v_accvgpr_read_b32 v16, a96
    v_accvgpr_read_b32 v17, a97
    v_accvgpr_read_b32 v18, a98
    v_accvgpr_read_b32 v19, a99
    v_accvgpr_read_b32 v20, a100
    v_accvgpr_read_b32 v21, a101
    v_accvgpr_read_b32 v22, a102
    v_accvgpr_read_b32 v23, a103
    v_cvt_pk_bf16_f32 v24, v16, v17
    v_cvt_pk_bf16_f32 v25, v18, v19
    v_cvt_pk_bf16_f32 v26, v20, v21
    v_cvt_pk_bf16_f32 v27, v22, v23
    buffer_store_dwordx4 v[24:27], v1, s[4:7], s30 offen offset:0 sc1
    v_accvgpr_read_b32 v28, a104
    v_accvgpr_read_b32 v29, a105
    v_accvgpr_read_b32 v30, a106
    v_accvgpr_read_b32 v31, a107
    v_accvgpr_read_b32 v32, a108
    v_accvgpr_read_b32 v33, a109
    v_accvgpr_read_b32 v34, a110
    v_accvgpr_read_b32 v35, a111
    v_cvt_pk_bf16_f32 v36, v28, v29
    v_cvt_pk_bf16_f32 v37, v30, v31
    v_cvt_pk_bf16_f32 v38, v32, v33
    v_cvt_pk_bf16_f32 v39, v34, v35
    buffer_store_dwordx4 v[36:39], v1, s[4:7], s30 offen offset:1024 sc1
    v_accvgpr_read_b32 v40, a112
    v_accvgpr_read_b32 v41, a113
    v_accvgpr_read_b32 v42, a114
    v_accvgpr_read_b32 v43, a115
    v_accvgpr_read_b32 v44, a116
    v_accvgpr_read_b32 v45, a117
    v_accvgpr_read_b32 v46, a118
    v_accvgpr_read_b32 v47, a119
    v_cvt_pk_bf16_f32 v48, v40, v41
    v_cvt_pk_bf16_f32 v49, v42, v43
    v_cvt_pk_bf16_f32 v50, v44, v45
    v_cvt_pk_bf16_f32 v51, v46, v47
    buffer_store_dwordx4 v[48:51], v1, s[4:7], s30 offen offset:2048 sc1
    v_accvgpr_read_b32 v52, a120
    v_accvgpr_read_b32 v53, a121
    v_accvgpr_read_b32 v54, a122
    v_accvgpr_read_b32 v55, a123
    v_accvgpr_read_b32 v56, a124
    v_accvgpr_read_b32 v57, a125
    v_accvgpr_read_b32 v58, a126
    v_accvgpr_read_b32 v59, a127
    v_cvt_pk_bf16_f32 v60, v52, v53
    v_cvt_pk_bf16_f32 v61, v54, v55
    v_cvt_pk_bf16_f32 v62, v56, v57
    v_cvt_pk_bf16_f32 v63, v58, v59
    buffer_store_dwordx4 v[60:63], v1, s[4:7], s30 offen offset:3072 sc1
    s_add_u32 s30, s30, 0x20000
    v_accvgpr_read_b32 v16, a128
    v_accvgpr_read_b32 v17, a129
    v_accvgpr_read_b32 v18, a130
    v_accvgpr_read_b32 v19, a131
    v_accvgpr_read_b32 v20, a132
    v_accvgpr_read_b32 v21, a133
    v_accvgpr_read_b32 v22, a134
    v_accvgpr_read_b32 v23, a135
    v_cvt_pk_bf16_f32 v24, v16, v17
    v_cvt_pk_bf16_f32 v25, v18, v19
    v_cvt_pk_bf16_f32 v26, v20, v21
    v_cvt_pk_bf16_f32 v27, v22, v23
    buffer_store_dwordx4 v[24:27], v1, s[4:7], s30 offen offset:0 sc1
    v_accvgpr_read_b32 v28, a136
    v_accvgpr_read_b32 v29, a137
    v_accvgpr_read_b32 v30, a138
    v_accvgpr_read_b32 v31, a139
    v_accvgpr_read_b32 v32, a140
    v_accvgpr_read_b32 v33, a141
    v_accvgpr_read_b32 v34, a142
    v_accvgpr_read_b32 v35, a143
    v_cvt_pk_bf16_f32 v36, v28, v29
    v_cvt_pk_bf16_f32 v37, v30, v31
    v_cvt_pk_bf16_f32 v38, v32, v33
    v_cvt_pk_bf16_f32 v39, v34, v35
    buffer_store_dwordx4 v[36:39], v1, s[4:7], s30 offen offset:1024 sc1
    v_accvgpr_read_b32 v40, a144
    v_accvgpr_read_b32 v41, a145
    v_accvgpr_read_b32 v42, a146
    v_accvgpr_read_b32 v43, a147
    v_accvgpr_read_b32 v44, a148
    v_accvgpr_read_b32 v45, a149
    v_accvgpr_read_b32 v46, a150
    v_accvgpr_read_b32 v47, a151
    v_cvt_pk_bf16_f32 v48, v40, v41
    v_cvt_pk_bf16_f32 v49, v42, v43
    v_cvt_pk_bf16_f32 v50, v44, v45
    v_cvt_pk_bf16_f32 v51, v46, v47
    buffer_store_dwordx4 v[48:51], v1, s[4:7], s30 offen offset:2048 sc1
    v_accvgpr_read_b32 v52, a152
    v_accvgpr_read_b32 v53, a153
    v_accvgpr_read_b32 v54, a154
    v_accvgpr_read_b32 v55, a155
    v_accvgpr_read_b32 v56, a156
    v_accvgpr_read_b32 v57, a157
    v_accvgpr_read_b32 v58, a158
    v_accvgpr_read_b32 v59, a159
    v_cvt_pk_bf16_f32 v60, v52, v53
    v_cvt_pk_bf16_f32 v61, v54, v55
    v_cvt_pk_bf16_f32 v62, v56, v57
    v_cvt_pk_bf16_f32 v63, v58, v59
    buffer_store_dwordx4 v[60:63], v1, s[4:7], s30 offen offset:3072 sc1
    s_add_u32 s30, s30, 0x20000
    v_accvgpr_read_b32 v16, a160
    v_accvgpr_read_b32 v17, a161
    v_accvgpr_read_b32 v18, a162
    v_accvgpr_read_b32 v19, a163
    v_accvgpr_read_b32 v20, a164
    v_accvgpr_read_b32 v21, a165
    v_accvgpr_read_b32 v22, a166
    v_accvgpr_read_b32 v23, a167
    v_cvt_pk_bf16_f32 v24, v16, v17
    v_cvt_pk_bf16_f32 v25, v18, v19
    v_cvt_pk_bf16_f32 v26, v20, v21
    v_cvt_pk_bf16_f32 v27, v22, v23
    buffer_store_dwordx4 v[24:27], v1, s[4:7], s30 offen offset:0 sc1
    v_accvgpr_read_b32 v28, a168
    v_accvgpr_read_b32 v29, a169
    v_accvgpr_read_b32 v30, a170
    v_accvgpr_read_b32 v31, a171
    v_accvgpr_read_b32 v32, a172
    v_accvgpr_read_b32 v33, a173
    v_accvgpr_read_b32 v34, a174
    v_accvgpr_read_b32 v35, a175
    v_cvt_pk_bf16_f32 v36, v28, v29
    v_cvt_pk_bf16_f32 v37, v30, v31
    v_cvt_pk_bf16_f32 v38, v32, v33
    v_cvt_pk_bf16_f32 v39, v34, v35
    buffer_store_dwordx4 v[36:39], v1, s[4:7], s30 offen offset:1024 sc1
    v_accvgpr_read_b32 v40, a176
    v_accvgpr_read_b32 v41, a177
    v_accvgpr_read_b32 v42, a178
    v_accvgpr_read_b32 v43, a179
    v_accvgpr_read_b32 v44, a180
    v_accvgpr_read_b32 v45, a181
    v_accvgpr_read_b32 v46, a182
    v_accvgpr_read_b32 v47, a183
    v_cvt_pk_bf16_f32 v48, v40, v41
    v_cvt_pk_bf16_f32 v49, v42, v43
    v_cvt_pk_bf16_f32 v50, v44, v45
    v_cvt_pk_bf16_f32 v51, v46, v47
    buffer_store_dwordx4 v[48:51], v1, s[4:7], s30 offen offset:2048 sc1
    v_accvgpr_read_b32 v52, a184
    v_accvgpr_read_b32 v53, a185
    v_accvgpr_read_b32 v54, a186
    v_accvgpr_read_b32 v55, a187
    v_accvgpr_read_b32 v56, a188
    v_accvgpr_read_b32 v57, a189
    v_accvgpr_read_b32 v58, a190
    v_accvgpr_read_b32 v59, a191
    v_cvt_pk_bf16_f32 v60, v52, v53
    v_cvt_pk_bf16_f32 v61, v54, v55
    v_cvt_pk_bf16_f32 v62, v56, v57
    v_cvt_pk_bf16_f32 v63, v58, v59
    buffer_store_dwordx4 v[60:63], v1, s[4:7], s30 offen offset:3072 sc1
    s_add_u32 s30, s30, 0x20000
    v_accvgpr_read_b32 v16, a192
    v_accvgpr_read_b32 v17, a193
    v_accvgpr_read_b32 v18, a194
    v_accvgpr_read_b32 v19, a195
    v_accvgpr_read_b32 v20, a196
    v_accvgpr_read_b32 v21, a197
    v_accvgpr_read_b32 v22, a198
    v_accvgpr_read_b32 v23, a199
    v_cvt_pk_bf16_f32 v24, v16, v17
    v_cvt_pk_bf16_f32 v25, v18, v19
    v_cvt_pk_bf16_f32 v26, v20, v21
    v_cvt_pk_bf16_f32 v27, v22, v23
    buffer_store_dwordx4 v[24:27], v1, s[4:7], s30 offen offset:0 sc1
    v_accvgpr_read_b32 v28, a200
    v_accvgpr_read_b32 v29, a201
    v_accvgpr_read_b32 v30, a202
    v_accvgpr_read_b32 v31, a203
    v_accvgpr_read_b32 v32, a204
    v_accvgpr_read_b32 v33, a205
    v_accvgpr_read_b32 v34, a206
    v_accvgpr_read_b32 v35, a207
    v_cvt_pk_bf16_f32 v36, v28, v29
    v_cvt_pk_bf16_f32 v37, v30, v31
    v_cvt_pk_bf16_f32 v38, v32, v33
    v_cvt_pk_bf16_f32 v39, v34, v35
    buffer_store_dwordx4 v[36:39], v1, s[4:7], s30 offen offset:1024 sc1
    v_accvgpr_read_b32 v40, a208
    v_accvgpr_read_b32 v41, a209
    v_accvgpr_read_b32 v42, a210
    v_accvgpr_read_b32 v43, a211
    v_accvgpr_read_b32 v44, a212
    v_accvgpr_read_b32 v45, a213
    v_accvgpr_read_b32 v46, a214
    v_accvgpr_read_b32 v47, a215
    v_cvt_pk_bf16_f32 v48, v40, v41
    v_cvt_pk_bf16_f32 v49, v42, v43
    v_cvt_pk_bf16_f32 v50, v44, v45
    v_cvt_pk_bf16_f32 v51, v46, v47
    buffer_store_dwordx4 v[48:51], v1, s[4:7], s30 offen offset:2048 sc1
    v_accvgpr_read_b32 v52, a216
    v_accvgpr_read_b32 v53, a217
    v_accvgpr_read_b32 v54, a218
    v_accvgpr_read_b32 v55, a219
    v_accvgpr_read_b32 v56, a220
    v_accvgpr_read_b32 v57, a221
    v_accvgpr_read_b32 v58, a222
    v_accvgpr_read_b32 v59, a223
    v_cvt_pk_bf16_f32 v60, v52, v53
    v_cvt_pk_bf16_f32 v61, v54, v55
    v_cvt_pk_bf16_f32 v62, v56, v57
    v_cvt_pk_bf16_f32 v63, v58, v59
    buffer_store_dwordx4 v[60:63], v1, s[4:7], s30 offen offset:3072 sc1
    s_add_u32 s30, s30, 0x20000
    v_accvgpr_read_b32 v16, a224
    v_accvgpr_read_b32 v17, a225
    v_accvgpr_read_b32 v18, a226
    v_accvgpr_read_b32 v19, a227
    v_accvgpr_read_b32 v20, a228
    v_accvgpr_read_b32 v21, a229
    v_accvgpr_read_b32 v22, a230
    v_accvgpr_read_b32 v23, a231
    v_cvt_pk_bf16_f32 v24, v16, v17
    v_cvt_pk_bf16_f32 v25, v18, v19
    v_cvt_pk_bf16_f32 v26, v20, v21
    v_cvt_pk_bf16_f32 v27, v22, v23
    buffer_store_dwordx4 v[24:27], v1, s[4:7], s30 offen offset:0 sc1
    v_accvgpr_read_b32 v28, a232
    v_accvgpr_read_b32 v29, a233
    v_accvgpr_read_b32 v30, a234
    v_accvgpr_read_b32 v31, a235
    v_accvgpr_read_b32 v32, a236
    v_accvgpr_read_b32 v33, a237
    v_accvgpr_read_b32 v34, a238
    v_accvgpr_read_b32 v35, a239
    v_cvt_pk_bf16_f32 v36, v28, v29
    v_cvt_pk_bf16_f32 v37, v30, v31
    v_cvt_pk_bf16_f32 v38, v32, v33
    v_cvt_pk_bf16_f32 v39, v34, v35
    buffer_store_dwordx4 v[36:39], v1, s[4:7], s30 offen offset:1024 sc1
    v_accvgpr_read_b32 v40, a240
    v_accvgpr_read_b32 v41, a241
    v_accvgpr_read_b32 v42, a242
    v_accvgpr_read_b32 v43, a243
    v_accvgpr_read_b32 v44, a244
    v_accvgpr_read_b32 v45, a245
    v_accvgpr_read_b32 v46, a246
    v_accvgpr_read_b32 v47, a247
    v_cvt_pk_bf16_f32 v48, v40, v41
    v_cvt_pk_bf16_f32 v49, v42, v43
    v_cvt_pk_bf16_f32 v50, v44, v45
    v_cvt_pk_bf16_f32 v51, v46, v47
    buffer_store_dwordx4 v[48:51], v1, s[4:7], s30 offen offset:2048 sc1
    v_accvgpr_read_b32 v52, a248
    v_accvgpr_read_b32 v53, a249
    v_accvgpr_read_b32 v54, a250
    v_accvgpr_read_b32 v55, a251
    v_accvgpr_read_b32 v56, a252
    v_accvgpr_read_b32 v57, a253
    v_accvgpr_read_b32 v58, a254
    v_accvgpr_read_b32 v59, a255
    v_cvt_pk_bf16_f32 v60, v52, v53
    v_cvt_pk_bf16_f32 v61, v54, v55
    v_cvt_pk_bf16_f32 v62, v56, v57
    v_cvt_pk_bf16_f32 v63, v58, v59
    buffer_store_dwordx4 v[60:63], v1, s[4:7], s30 offen offset:3072 sc1
    s_add_u32 s30, s30, 0x20000
    s_branch wk_done
wk_egu:
    s_cmp_ge_u32 s20, 27
    s_cbranch_scc1 wk_done
    s_lshl_b32 s30, s21, 1
    s_add_u32 s30, s30, s36
    s_mul_i32 s30, s30, 1490944
    s_lshl_b32 s31, s20, 11
    s_add_u32 s30, s30, s31
    s_add_u32 s30, s30, 84017152
    s_mov_b32 s28, 0xc0135761
    v_mov_b32 v9, 0xbdd2d3e8
    v_accvgpr_read_b32 v16, a0
    v_accvgpr_read_b32 v17, a1
    v_accvgpr_read_b32 v18, a2
    v_accvgpr_read_b32 v19, a3
    v_accvgpr_read_b32 v24, a16
    v_accvgpr_read_b32 v25, a17
    v_accvgpr_read_b32 v26, a18
    v_accvgpr_read_b32 v27, a19
    v_accvgpr_read_b32 v20, a4
    v_accvgpr_read_b32 v21, a5
    v_accvgpr_read_b32 v22, a6
    v_accvgpr_read_b32 v23, a7
    v_accvgpr_read_b32 v28, a20
    v_accvgpr_read_b32 v29, a21
    v_accvgpr_read_b32 v30, a22
    v_accvgpr_read_b32 v31, a23
    v_mul_f32 v32, v16, v16
    v_mul_f32 v33, v17, v17
    v_mul_f32 v34, v18, v18
    v_mul_f32 v35, v19, v19
    v_mul_f32 v36, v20, v20
    v_mul_f32 v37, v21, v21
    v_mul_f32 v38, v22, v22
    v_mul_f32 v39, v23, v23
    v_fma_f32 v32, v32, v9, s28
    v_fma_f32 v33, v33, v9, s28
    v_fma_f32 v34, v34, v9, s28
    v_fma_f32 v35, v35, v9, s28
    v_fma_f32 v36, v36, v9, s28
    v_fma_f32 v37, v37, v9, s28
    v_fma_f32 v38, v38, v9, s28
    v_fma_f32 v39, v39, v9, s28
    v_mul_f32 v32, v32, v16
    v_mul_f32 v33, v33, v17
    v_mul_f32 v34, v34, v18
    v_mul_f32 v35, v35, v19
    v_mul_f32 v36, v36, v20
    v_mul_f32 v37, v37, v21
    v_mul_f32 v38, v38, v22
    v_mul_f32 v39, v39, v23
    v_exp_f32 v32, v32
    v_exp_f32 v33, v33
    v_exp_f32 v34, v34
    v_exp_f32 v35, v35
    v_exp_f32 v36, v36
    v_exp_f32 v37, v37
    v_exp_f32 v38, v38
    v_exp_f32 v39, v39
    v_add_f32 v32, 1.0, v32
    v_add_f32 v33, 1.0, v33
    v_add_f32 v34, 1.0, v34
    v_add_f32 v35, 1.0, v35
    v_add_f32 v36, 1.0, v36
    v_add_f32 v37, 1.0, v37
    v_add_f32 v38, 1.0, v38
    v_add_f32 v39, 1.0, v39
    v_rcp_f32 v32, v32
    v_rcp_f32 v33, v33
    v_rcp_f32 v34, v34
    v_rcp_f32 v35, v35
    v_rcp_f32 v36, v36
    v_rcp_f32 v37, v37
    v_rcp_f32 v38, v38
    v_rcp_f32 v39, v39
    v_mul_f32 v16, v16, v32
    v_mul_f32 v17, v17, v33
    v_mul_f32 v18, v18, v34
    v_mul_f32 v19, v19, v35
    v_mul_f32 v20, v20, v36
    v_mul_f32 v21, v21, v37
    v_mul_f32 v22, v22, v38
    v_mul_f32 v23, v23, v39
    v_mul_f32 v16, v16, v24
    v_mul_f32 v17, v17, v25
    v_mul_f32 v18, v18, v26
    v_mul_f32 v19, v19, v27
    v_mul_f32 v20, v20, v28
    v_mul_f32 v21, v21, v29
    v_mul_f32 v22, v22, v30
    v_mul_f32 v23, v23, v31
    v_cvt_pk_bf16_f32 v40, v16, v17
    v_cvt_pk_bf16_f32 v41, v18, v19
    v_cvt_pk_bf16_f32 v42, v20, v21
    v_cvt_pk_bf16_f32 v43, v22, v23
    buffer_store_dwordx4 v[40:43], v1, s[4:7], s30 offen offset:0 sc1
    v_accvgpr_read_b32 v48, a8
    v_accvgpr_read_b32 v49, a9
    v_accvgpr_read_b32 v50, a10
    v_accvgpr_read_b32 v51, a11
    v_accvgpr_read_b32 v56, a24
    v_accvgpr_read_b32 v57, a25
    v_accvgpr_read_b32 v58, a26
    v_accvgpr_read_b32 v59, a27
    v_accvgpr_read_b32 v52, a12
    v_accvgpr_read_b32 v53, a13
    v_accvgpr_read_b32 v54, a14
    v_accvgpr_read_b32 v55, a15
    v_accvgpr_read_b32 v60, a28
    v_accvgpr_read_b32 v61, a29
    v_accvgpr_read_b32 v62, a30
    v_accvgpr_read_b32 v63, a31
    v_mul_f32 v64, v48, v48
    v_mul_f32 v65, v49, v49
    v_mul_f32 v66, v50, v50
    v_mul_f32 v67, v51, v51
    v_mul_f32 v68, v52, v52
    v_mul_f32 v69, v53, v53
    v_mul_f32 v70, v54, v54
    v_mul_f32 v71, v55, v55
    v_fma_f32 v64, v64, v9, s28
    v_fma_f32 v65, v65, v9, s28
    v_fma_f32 v66, v66, v9, s28
    v_fma_f32 v67, v67, v9, s28
    v_fma_f32 v68, v68, v9, s28
    v_fma_f32 v69, v69, v9, s28
    v_fma_f32 v70, v70, v9, s28
    v_fma_f32 v71, v71, v9, s28
    v_mul_f32 v64, v64, v48
    v_mul_f32 v65, v65, v49
    v_mul_f32 v66, v66, v50
    v_mul_f32 v67, v67, v51
    v_mul_f32 v68, v68, v52
    v_mul_f32 v69, v69, v53
    v_mul_f32 v70, v70, v54
    v_mul_f32 v71, v71, v55
    v_exp_f32 v64, v64
    v_exp_f32 v65, v65
    v_exp_f32 v66, v66
    v_exp_f32 v67, v67
    v_exp_f32 v68, v68
    v_exp_f32 v69, v69
    v_exp_f32 v70, v70
    v_exp_f32 v71, v71
    v_add_f32 v64, 1.0, v64
    v_add_f32 v65, 1.0, v65
    v_add_f32 v66, 1.0, v66
    v_add_f32 v67, 1.0, v67
    v_add_f32 v68, 1.0, v68
    v_add_f32 v69, 1.0, v69
    v_add_f32 v70, 1.0, v70
    v_add_f32 v71, 1.0, v71
    v_rcp_f32 v64, v64
    v_rcp_f32 v65, v65
    v_rcp_f32 v66, v66
    v_rcp_f32 v67, v67
    v_rcp_f32 v68, v68
    v_rcp_f32 v69, v69
    v_rcp_f32 v70, v70
    v_rcp_f32 v71, v71
    v_mul_f32 v48, v48, v64
    v_mul_f32 v49, v49, v65
    v_mul_f32 v50, v50, v66
    v_mul_f32 v51, v51, v67
    v_mul_f32 v52, v52, v68
    v_mul_f32 v53, v53, v69
    v_mul_f32 v54, v54, v70
    v_mul_f32 v55, v55, v71
    v_mul_f32 v48, v48, v56
    v_mul_f32 v49, v49, v57
    v_mul_f32 v50, v50, v58
    v_mul_f32 v51, v51, v59
    v_mul_f32 v52, v52, v60
    v_mul_f32 v53, v53, v61
    v_mul_f32 v54, v54, v62
    v_mul_f32 v55, v55, v63
    v_cvt_pk_bf16_f32 v72, v48, v49
    v_cvt_pk_bf16_f32 v73, v50, v51
    v_cvt_pk_bf16_f32 v74, v52, v53
    v_cvt_pk_bf16_f32 v75, v54, v55
    buffer_store_dwordx4 v[72:75], v1, s[4:7], s30 offen offset:1024 sc1
    s_add_u32 s30, s30, 186368
    v_accvgpr_read_b32 v16, a32
    v_accvgpr_read_b32 v17, a33
    v_accvgpr_read_b32 v18, a34
    v_accvgpr_read_b32 v19, a35
    v_accvgpr_read_b32 v24, a48
    v_accvgpr_read_b32 v25, a49
    v_accvgpr_read_b32 v26, a50
    v_accvgpr_read_b32 v27, a51
    v_accvgpr_read_b32 v20, a36
    v_accvgpr_read_b32 v21, a37
    v_accvgpr_read_b32 v22, a38
    v_accvgpr_read_b32 v23, a39
    v_accvgpr_read_b32 v28, a52
    v_accvgpr_read_b32 v29, a53
    v_accvgpr_read_b32 v30, a54
    v_accvgpr_read_b32 v31, a55
    v_mul_f32 v32, v16, v16
    v_mul_f32 v33, v17, v17
    v_mul_f32 v34, v18, v18
    v_mul_f32 v35, v19, v19
    v_mul_f32 v36, v20, v20
    v_mul_f32 v37, v21, v21
    v_mul_f32 v38, v22, v22
    v_mul_f32 v39, v23, v23
    v_fma_f32 v32, v32, v9, s28
    v_fma_f32 v33, v33, v9, s28
    v_fma_f32 v34, v34, v9, s28
    v_fma_f32 v35, v35, v9, s28
    v_fma_f32 v36, v36, v9, s28
    v_fma_f32 v37, v37, v9, s28
    v_fma_f32 v38, v38, v9, s28
    v_fma_f32 v39, v39, v9, s28
    v_mul_f32 v32, v32, v16
    v_mul_f32 v33, v33, v17
    v_mul_f32 v34, v34, v18
    v_mul_f32 v35, v35, v19
    v_mul_f32 v36, v36, v20
    v_mul_f32 v37, v37, v21
    v_mul_f32 v38, v38, v22
    v_mul_f32 v39, v39, v23
    v_exp_f32 v32, v32
    v_exp_f32 v33, v33
    v_exp_f32 v34, v34
    v_exp_f32 v35, v35
    v_exp_f32 v36, v36
    v_exp_f32 v37, v37
    v_exp_f32 v38, v38
    v_exp_f32 v39, v39
    v_add_f32 v32, 1.0, v32
    v_add_f32 v33, 1.0, v33
    v_add_f32 v34, 1.0, v34
    v_add_f32 v35, 1.0, v35
    v_add_f32 v36, 1.0, v36
    v_add_f32 v37, 1.0, v37
    v_add_f32 v38, 1.0, v38
    v_add_f32 v39, 1.0, v39
    v_rcp_f32 v32, v32
    v_rcp_f32 v33, v33
    v_rcp_f32 v34, v34
    v_rcp_f32 v35, v35
    v_rcp_f32 v36, v36
    v_rcp_f32 v37, v37
    v_rcp_f32 v38, v38
    v_rcp_f32 v39, v39
    v_mul_f32 v16, v16, v32
    v_mul_f32 v17, v17, v33
    v_mul_f32 v18, v18, v34
    v_mul_f32 v19, v19, v35
    v_mul_f32 v20, v20, v36
    v_mul_f32 v21, v21, v37
    v_mul_f32 v22, v22, v38
    v_mul_f32 v23, v23, v39
    v_mul_f32 v16, v16, v24
    v_mul_f32 v17, v17, v25
    v_mul_f32 v18, v18, v26
    v_mul_f32 v19, v19, v27
    v_mul_f32 v20, v20, v28
    v_mul_f32 v21, v21, v29
    v_mul_f32 v22, v22, v30
    v_mul_f32 v23, v23, v31
    v_cvt_pk_bf16_f32 v40, v16, v17
    v_cvt_pk_bf16_f32 v41, v18, v19
    v_cvt_pk_bf16_f32 v42, v20, v21
    v_cvt_pk_bf16_f32 v43, v22, v23
    buffer_store_dwordx4 v[40:43], v1, s[4:7], s30 offen offset:0 sc1
    v_accvgpr_read_b32 v48, a40
    v_accvgpr_read_b32 v49, a41
    v_accvgpr_read_b32 v50, a42
    v_accvgpr_read_b32 v51, a43
    v_accvgpr_read_b32 v56, a56
    v_accvgpr_read_b32 v57, a57
    v_accvgpr_read_b32 v58, a58
    v_accvgpr_read_b32 v59, a59
    v_accvgpr_read_b32 v52, a44
    v_accvgpr_read_b32 v53, a45
    v_accvgpr_read_b32 v54, a46
    v_accvgpr_read_b32 v55, a47
    v_accvgpr_read_b32 v60, a60
    v_accvgpr_read_b32 v61, a61
    v_accvgpr_read_b32 v62, a62
    v_accvgpr_read_b32 v63, a63
    v_mul_f32 v64, v48, v48
    v_mul_f32 v65, v49, v49
    v_mul_f32 v66, v50, v50
    v_mul_f32 v67, v51, v51
    v_mul_f32 v68, v52, v52
    v_mul_f32 v69, v53, v53
    v_mul_f32 v70, v54, v54
    v_mul_f32 v71, v55, v55
    v_fma_f32 v64, v64, v9, s28
    v_fma_f32 v65, v65, v9, s28
    v_fma_f32 v66, v66, v9, s28
    v_fma_f32 v67, v67, v9, s28
    v_fma_f32 v68, v68, v9, s28
    v_fma_f32 v69, v69, v9, s28
    v_fma_f32 v70, v70, v9, s28
    v_fma_f32 v71, v71, v9, s28
    v_mul_f32 v64, v64, v48
    v_mul_f32 v65, v65, v49
    v_mul_f32 v66, v66, v50
    v_mul_f32 v67, v67, v51
    v_mul_f32 v68, v68, v52
    v_mul_f32 v69, v69, v53
    v_mul_f32 v70, v70, v54
    v_mul_f32 v71, v71, v55
    v_exp_f32 v64, v64
    v_exp_f32 v65, v65
    v_exp_f32 v66, v66
    v_exp_f32 v67, v67
    v_exp_f32 v68, v68
    v_exp_f32 v69, v69
    v_exp_f32 v70, v70
    v_exp_f32 v71, v71
    v_add_f32 v64, 1.0, v64
    v_add_f32 v65, 1.0, v65
    v_add_f32 v66, 1.0, v66
    v_add_f32 v67, 1.0, v67
    v_add_f32 v68, 1.0, v68
    v_add_f32 v69, 1.0, v69
    v_add_f32 v70, 1.0, v70
    v_add_f32 v71, 1.0, v71
    v_rcp_f32 v64, v64
    v_rcp_f32 v65, v65
    v_rcp_f32 v66, v66
    v_rcp_f32 v67, v67
    v_rcp_f32 v68, v68
    v_rcp_f32 v69, v69
    v_rcp_f32 v70, v70
    v_rcp_f32 v71, v71
    v_mul_f32 v48, v48, v64
    v_mul_f32 v49, v49, v65
    v_mul_f32 v50, v50, v66
    v_mul_f32 v51, v51, v67
    v_mul_f32 v52, v52, v68
    v_mul_f32 v53, v53, v69
    v_mul_f32 v54, v54, v70
    v_mul_f32 v55, v55, v71
    v_mul_f32 v48, v48, v56
    v_mul_f32 v49, v49, v57
    v_mul_f32 v50, v50, v58
    v_mul_f32 v51, v51, v59
    v_mul_f32 v52, v52, v60
    v_mul_f32 v53, v53, v61
    v_mul_f32 v54, v54, v62
    v_mul_f32 v55, v55, v63
    v_cvt_pk_bf16_f32 v72, v48, v49
    v_cvt_pk_bf16_f32 v73, v50, v51
    v_cvt_pk_bf16_f32 v74, v52, v53
    v_cvt_pk_bf16_f32 v75, v54, v55
    buffer_store_dwordx4 v[72:75], v1, s[4:7], s30 offen offset:1024 sc1
    s_add_u32 s30, s30, 186368
    v_accvgpr_read_b32 v16, a64
    v_accvgpr_read_b32 v17, a65
    v_accvgpr_read_b32 v18, a66
    v_accvgpr_read_b32 v19, a67
    v_accvgpr_read_b32 v24, a80
    v_accvgpr_read_b32 v25, a81
    v_accvgpr_read_b32 v26, a82
    v_accvgpr_read_b32 v27, a83
    v_accvgpr_read_b32 v20, a68
    v_accvgpr_read_b32 v21, a69
    v_accvgpr_read_b32 v22, a70
    v_accvgpr_read_b32 v23, a71
    v_accvgpr_read_b32 v28, a84
    v_accvgpr_read_b32 v29, a85
    v_accvgpr_read_b32 v30, a86
    v_accvgpr_read_b32 v31, a87
    v_mul_f32 v32, v16, v16
    v_mul_f32 v33, v17, v17
    v_mul_f32 v34, v18, v18
    v_mul_f32 v35, v19, v19
    v_mul_f32 v36, v20, v20
    v_mul_f32 v37, v21, v21
    v_mul_f32 v38, v22, v22
    v_mul_f32 v39, v23, v23
    v_fma_f32 v32, v32, v9, s28
    v_fma_f32 v33, v33, v9, s28
    v_fma_f32 v34, v34, v9, s28
    v_fma_f32 v35, v35, v9, s28
    v_fma_f32 v36, v36, v9, s28
    v_fma_f32 v37, v37, v9, s28
    v_fma_f32 v38, v38, v9, s28
    v_fma_f32 v39, v39, v9, s28
    v_mul_f32 v32, v32, v16
    v_mul_f32 v33, v33, v17
    v_mul_f32 v34, v34, v18
    v_mul_f32 v35, v35, v19
    v_mul_f32 v36, v36, v20
    v_mul_f32 v37, v37, v21
    v_mul_f32 v38, v38, v22
    v_mul_f32 v39, v39, v23
    v_exp_f32 v32, v32
    v_exp_f32 v33, v33
    v_exp_f32 v34, v34
    v_exp_f32 v35, v35
    v_exp_f32 v36, v36
    v_exp_f32 v37, v37
    v_exp_f32 v38, v38
    v_exp_f32 v39, v39
    v_add_f32 v32, 1.0, v32
    v_add_f32 v33, 1.0, v33
    v_add_f32 v34, 1.0, v34
    v_add_f32 v35, 1.0, v35
    v_add_f32 v36, 1.0, v36
    v_add_f32 v37, 1.0, v37
    v_add_f32 v38, 1.0, v38
    v_add_f32 v39, 1.0, v39
    v_rcp_f32 v32, v32
    v_rcp_f32 v33, v33
    v_rcp_f32 v34, v34
    v_rcp_f32 v35, v35
    v_rcp_f32 v36, v36
    v_rcp_f32 v37, v37
    v_rcp_f32 v38, v38
    v_rcp_f32 v39, v39
    v_mul_f32 v16, v16, v32
    v_mul_f32 v17, v17, v33
    v_mul_f32 v18, v18, v34
    v_mul_f32 v19, v19, v35
    v_mul_f32 v20, v20, v36
    v_mul_f32 v21, v21, v37
    v_mul_f32 v22, v22, v38
    v_mul_f32 v23, v23, v39
    v_mul_f32 v16, v16, v24
    v_mul_f32 v17, v17, v25
    v_mul_f32 v18, v18, v26
    v_mul_f32 v19, v19, v27
    v_mul_f32 v20, v20, v28
    v_mul_f32 v21, v21, v29
    v_mul_f32 v22, v22, v30
    v_mul_f32 v23, v23, v31
    v_cvt_pk_bf16_f32 v40, v16, v17
    v_cvt_pk_bf16_f32 v41, v18, v19
    v_cvt_pk_bf16_f32 v42, v20, v21
    v_cvt_pk_bf16_f32 v43, v22, v23
    buffer_store_dwordx4 v[40:43], v1, s[4:7], s30 offen offset:0 sc1
    v_accvgpr_read_b32 v48, a72
    v_accvgpr_read_b32 v49, a73
    v_accvgpr_read_b32 v50, a74
    v_accvgpr_read_b32 v51, a75
    v_accvgpr_read_b32 v56, a88
    v_accvgpr_read_b32 v57, a89
    v_accvgpr_read_b32 v58, a90
    v_accvgpr_read_b32 v59, a91
    v_accvgpr_read_b32 v52, a76
    v_accvgpr_read_b32 v53, a77
    v_accvgpr_read_b32 v54, a78
    v_accvgpr_read_b32 v55, a79
    v_accvgpr_read_b32 v60, a92
    v_accvgpr_read_b32 v61, a93
    v_accvgpr_read_b32 v62, a94
    v_accvgpr_read_b32 v63, a95
    v_mul_f32 v64, v48, v48
    v_mul_f32 v65, v49, v49
    v_mul_f32 v66, v50, v50
    v_mul_f32 v67, v51, v51
    v_mul_f32 v68, v52, v52
    v_mul_f32 v69, v53, v53
    v_mul_f32 v70, v54, v54
    v_mul_f32 v71, v55, v55
    v_fma_f32 v64, v64, v9, s28
    v_fma_f32 v65, v65, v9, s28
    v_fma_f32 v66, v66, v9, s28
    v_fma_f32 v67, v67, v9, s28
    v_fma_f32 v68, v68, v9, s28
    v_fma_f32 v69, v69, v9, s28
    v_fma_f32 v70, v70, v9, s28
    v_fma_f32 v71, v71, v9, s28
    v_mul_f32 v64, v64, v48
    v_mul_f32 v65, v65, v49
    v_mul_f32 v66, v66, v50
    v_mul_f32 v67, v67, v51
    v_mul_f32 v68, v68, v52
    v_mul_f32 v69, v69, v53
    v_mul_f32 v70, v70, v54
    v_mul_f32 v71, v71, v55
    v_exp_f32 v64, v64
    v_exp_f32 v65, v65
    v_exp_f32 v66, v66
    v_exp_f32 v67, v67
    v_exp_f32 v68, v68
    v_exp_f32 v69, v69
    v_exp_f32 v70, v70
    v_exp_f32 v71, v71
    v_add_f32 v64, 1.0, v64
    v_add_f32 v65, 1.0, v65
    v_add_f32 v66, 1.0, v66
    v_add_f32 v67, 1.0, v67
    v_add_f32 v68, 1.0, v68
    v_add_f32 v69, 1.0, v69
    v_add_f32 v70, 1.0, v70
    v_add_f32 v71, 1.0, v71
    v_rcp_f32 v64, v64
    v_rcp_f32 v65, v65
    v_rcp_f32 v66, v66
    v_rcp_f32 v67, v67
    v_rcp_f32 v68, v68
    v_rcp_f32 v69, v69
    v_rcp_f32 v70, v70
    v_rcp_f32 v71, v71
    v_mul_f32 v48, v48, v64
    v_mul_f32 v49, v49, v65
    v_mul_f32 v50, v50, v66
    v_mul_f32 v51, v51, v67
    v_mul_f32 v52, v52, v68
    v_mul_f32 v53, v53, v69
    v_mul_f32 v54, v54, v70
    v_mul_f32 v55, v55, v71
    v_mul_f32 v48, v48, v56
    v_mul_f32 v49, v49, v57
    v_mul_f32 v50, v50, v58
    v_mul_f32 v51, v51, v59
    v_mul_f32 v52, v52, v60
    v_mul_f32 v53, v53, v61
    v_mul_f32 v54, v54, v62
    v_mul_f32 v55, v55, v63
    v_cvt_pk_bf16_f32 v72, v48, v49
    v_cvt_pk_bf16_f32 v73, v50, v51
    v_cvt_pk_bf16_f32 v74, v52, v53
    v_cvt_pk_bf16_f32 v75, v54, v55
    buffer_store_dwordx4 v[72:75], v1, s[4:7], s30 offen offset:1024 sc1
    s_add_u32 s30, s30, 186368
    v_accvgpr_read_b32 v16, a96
    v_accvgpr_read_b32 v17, a97
    v_accvgpr_read_b32 v18, a98
    v_accvgpr_read_b32 v19, a99
    v_accvgpr_read_b32 v24, a112
    v_accvgpr_read_b32 v25, a113
    v_accvgpr_read_b32 v26, a114
    v_accvgpr_read_b32 v27, a115
    v_accvgpr_read_b32 v20, a100
    v_accvgpr_read_b32 v21, a101
    v_accvgpr_read_b32 v22, a102
    v_accvgpr_read_b32 v23, a103
    v_accvgpr_read_b32 v28, a116
    v_accvgpr_read_b32 v29, a117
    v_accvgpr_read_b32 v30, a118
    v_accvgpr_read_b32 v31, a119
    v_mul_f32 v32, v16, v16
    v_mul_f32 v33, v17, v17
    v_mul_f32 v34, v18, v18
    v_mul_f32 v35, v19, v19
    v_mul_f32 v36, v20, v20
    v_mul_f32 v37, v21, v21
    v_mul_f32 v38, v22, v22
    v_mul_f32 v39, v23, v23
    v_fma_f32 v32, v32, v9, s28
    v_fma_f32 v33, v33, v9, s28
    v_fma_f32 v34, v34, v9, s28
    v_fma_f32 v35, v35, v9, s28
    v_fma_f32 v36, v36, v9, s28
    v_fma_f32 v37, v37, v9, s28
    v_fma_f32 v38, v38, v9, s28
    v_fma_f32 v39, v39, v9, s28
    v_mul_f32 v32, v32, v16
    v_mul_f32 v33, v33, v17
    v_mul_f32 v34, v34, v18
    v_mul_f32 v35, v35, v19
    v_mul_f32 v36, v36, v20
    v_mul_f32 v37, v37, v21
    v_mul_f32 v38, v38, v22
    v_mul_f32 v39, v39, v23
    v_exp_f32 v32, v32
    v_exp_f32 v33, v33
    v_exp_f32 v34, v34
    v_exp_f32 v35, v35
    v_exp_f32 v36, v36
    v_exp_f32 v37, v37
    v_exp_f32 v38, v38
    v_exp_f32 v39, v39
    v_add_f32 v32, 1.0, v32
    v_add_f32 v33, 1.0, v33
    v_add_f32 v34, 1.0, v34
    v_add_f32 v35, 1.0, v35
    v_add_f32 v36, 1.0, v36
    v_add_f32 v37, 1.0, v37
    v_add_f32 v38, 1.0, v38
    v_add_f32 v39, 1.0, v39
    v_rcp_f32 v32, v32
    v_rcp_f32 v33, v33
    v_rcp_f32 v34, v34
    v_rcp_f32 v35, v35
    v_rcp_f32 v36, v36
    v_rcp_f32 v37, v37
    v_rcp_f32 v38, v38
    v_rcp_f32 v39, v39
    v_mul_f32 v16, v16, v32
    v_mul_f32 v17, v17, v33
    v_mul_f32 v18, v18, v34
    v_mul_f32 v19, v19, v35
    v_mul_f32 v20, v20, v36
    v_mul_f32 v21, v21, v37
    v_mul_f32 v22, v22, v38
    v_mul_f32 v23, v23, v39
    v_mul_f32 v16, v16, v24
    v_mul_f32 v17, v17, v25
    v_mul_f32 v18, v18, v26
    v_mul_f32 v19, v19, v27
    v_mul_f32 v20, v20, v28
    v_mul_f32 v21, v21, v29
    v_mul_f32 v22, v22, v30
    v_mul_f32 v23, v23, v31
    v_cvt_pk_bf16_f32 v40, v16, v17
    v_cvt_pk_bf16_f32 v41, v18, v19
    v_cvt_pk_bf16_f32 v42, v20, v21
    v_cvt_pk_bf16_f32 v43, v22, v23
    buffer_store_dwordx4 v[40:43], v1, s[4:7], s30 offen offset:0 sc1
    v_accvgpr_read_b32 v48, a104
    v_accvgpr_read_b32 v49, a105
    v_accvgpr_read_b32 v50, a106
    v_accvgpr_read_b32 v51, a107
    v_accvgpr_read_b32 v56, a120
    v_accvgpr_read_b32 v57, a121
    v_accvgpr_read_b32 v58, a122
    v_accvgpr_read_b32 v59, a123
    v_accvgpr_read_b32 v52, a108
    v_accvgpr_read_b32 v53, a109
    v_accvgpr_read_b32 v54, a110
    v_accvgpr_read_b32 v55, a111
    v_accvgpr_read_b32 v60, a124
    v_accvgpr_read_b32 v61, a125
    v_accvgpr_read_b32 v62, a126
    v_accvgpr_read_b32 v63, a127
    v_mul_f32 v64, v48, v48
    v_mul_f32 v65, v49, v49
    v_mul_f32 v66, v50, v50
    v_mul_f32 v67, v51, v51
    v_mul_f32 v68, v52, v52
    v_mul_f32 v69, v53, v53
    v_mul_f32 v70, v54, v54
    v_mul_f32 v71, v55, v55
    v_fma_f32 v64, v64, v9, s28
    v_fma_f32 v65, v65, v9, s28
    v_fma_f32 v66, v66, v9, s28
    v_fma_f32 v67, v67, v9, s28
    v_fma_f32 v68, v68, v9, s28
    v_fma_f32 v69, v69, v9, s28
    v_fma_f32 v70, v70, v9, s28
    v_fma_f32 v71, v71, v9, s28
    v_mul_f32 v64, v64, v48
    v_mul_f32 v65, v65, v49
    v_mul_f32 v66, v66, v50
    v_mul_f32 v67, v67, v51
    v_mul_f32 v68, v68, v52
    v_mul_f32 v69, v69, v53
    v_mul_f32 v70, v70, v54
    v_mul_f32 v71, v71, v55
    v_exp_f32 v64, v64
    v_exp_f32 v65, v65
    v_exp_f32 v66, v66
    v_exp_f32 v67, v67
    v_exp_f32 v68, v68
    v_exp_f32 v69, v69
    v_exp_f32 v70, v70
    v_exp_f32 v71, v71
    v_add_f32 v64, 1.0, v64
    v_add_f32 v65, 1.0, v65
    v_add_f32 v66, 1.0, v66
    v_add_f32 v67, 1.0, v67
    v_add_f32 v68, 1.0, v68
    v_add_f32 v69, 1.0, v69
    v_add_f32 v70, 1.0, v70
    v_add_f32 v71, 1.0, v71
    v_rcp_f32 v64, v64
    v_rcp_f32 v65, v65
    v_rcp_f32 v66, v66
    v_rcp_f32 v67, v67
    v_rcp_f32 v68, v68
    v_rcp_f32 v69, v69
    v_rcp_f32 v70, v70
    v_rcp_f32 v71, v71
    v_mul_f32 v48, v48, v64
    v_mul_f32 v49, v49, v65
    v_mul_f32 v50, v50, v66
    v_mul_f32 v51, v51, v67
    v_mul_f32 v52, v52, v68
    v_mul_f32 v53, v53, v69
    v_mul_f32 v54, v54, v70
    v_mul_f32 v55, v55, v71
    v_mul_f32 v48, v48, v56
    v_mul_f32 v49, v49, v57
    v_mul_f32 v50, v50, v58
    v_mul_f32 v51, v51, v59
    v_mul_f32 v52, v52, v60
    v_mul_f32 v53, v53, v61
    v_mul_f32 v54, v54, v62
    v_mul_f32 v55, v55, v63
    v_cvt_pk_bf16_f32 v72, v48, v49
    v_cvt_pk_bf16_f32 v73, v50, v51
    v_cvt_pk_bf16_f32 v74, v52, v53
    v_cvt_pk_bf16_f32 v75, v54, v55
    buffer_store_dwordx4 v[72:75], v1, s[4:7], s30 offen offset:1024 sc1
    s_add_u32 s30, s30, 186368
    v_accvgpr_read_b32 v16, a128
    v_accvgpr_read_b32 v17, a129
    v_accvgpr_read_b32 v18, a130
    v_accvgpr_read_b32 v19, a131
    v_accvgpr_read_b32 v24, a144
    v_accvgpr_read_b32 v25, a145
    v_accvgpr_read_b32 v26, a146
    v_accvgpr_read_b32 v27, a147
    v_accvgpr_read_b32 v20, a132
    v_accvgpr_read_b32 v21, a133
    v_accvgpr_read_b32 v22, a134
    v_accvgpr_read_b32 v23, a135
    v_accvgpr_read_b32 v28, a148
    v_accvgpr_read_b32 v29, a149
    v_accvgpr_read_b32 v30, a150
    v_accvgpr_read_b32 v31, a151
    v_mul_f32 v32, v16, v16
    v_mul_f32 v33, v17, v17
    v_mul_f32 v34, v18, v18
    v_mul_f32 v35, v19, v19
    v_mul_f32 v36, v20, v20
    v_mul_f32 v37, v21, v21
    v_mul_f32 v38, v22, v22
    v_mul_f32 v39, v23, v23
    v_fma_f32 v32, v32, v9, s28
    v_fma_f32 v33, v33, v9, s28
    v_fma_f32 v34, v34, v9, s28
    v_fma_f32 v35, v35, v9, s28
    v_fma_f32 v36, v36, v9, s28
    v_fma_f32 v37, v37, v9, s28
    v_fma_f32 v38, v38, v9, s28
    v_fma_f32 v39, v39, v9, s28
    v_mul_f32 v32, v32, v16
    v_mul_f32 v33, v33, v17
    v_mul_f32 v34, v34, v18
    v_mul_f32 v35, v35, v19
    v_mul_f32 v36, v36, v20
    v_mul_f32 v37, v37, v21
    v_mul_f32 v38, v38, v22
    v_mul_f32 v39, v39, v23
    v_exp_f32 v32, v32
    v_exp_f32 v33, v33
    v_exp_f32 v34, v34
    v_exp_f32 v35, v35
    v_exp_f32 v36, v36
    v_exp_f32 v37, v37
    v_exp_f32 v38, v38
    v_exp_f32 v39, v39
    v_add_f32 v32, 1.0, v32
    v_add_f32 v33, 1.0, v33
    v_add_f32 v34, 1.0, v34
    v_add_f32 v35, 1.0, v35
    v_add_f32 v36, 1.0, v36
    v_add_f32 v37, 1.0, v37
    v_add_f32 v38, 1.0, v38
    v_add_f32 v39, 1.0, v39
    v_rcp_f32 v32, v32
    v_rcp_f32 v33, v33
    v_rcp_f32 v34, v34
    v_rcp_f32 v35, v35
    v_rcp_f32 v36, v36
    v_rcp_f32 v37, v37
    v_rcp_f32 v38, v38
    v_rcp_f32 v39, v39
    v_mul_f32 v16, v16, v32
    v_mul_f32 v17, v17, v33
    v_mul_f32 v18, v18, v34
    v_mul_f32 v19, v19, v35
    v_mul_f32 v20, v20, v36
    v_mul_f32 v21, v21, v37
    v_mul_f32 v22, v22, v38
    v_mul_f32 v23, v23, v39
    v_mul_f32 v16, v16, v24
    v_mul_f32 v17, v17, v25
    v_mul_f32 v18, v18, v26
    v_mul_f32 v19, v19, v27
    v_mul_f32 v20, v20, v28
    v_mul_f32 v21, v21, v29
    v_mul_f32 v22, v22, v30
    v_mul_f32 v23, v23, v31
    v_cvt_pk_bf16_f32 v40, v16, v17
    v_cvt_pk_bf16_f32 v41, v18, v19
    v_cvt_pk_bf16_f32 v42, v20, v21
    v_cvt_pk_bf16_f32 v43, v22, v23
    buffer_store_dwordx4 v[40:43], v1, s[4:7], s30 offen offset:0 sc1
    v_accvgpr_read_b32 v48, a136
    v_accvgpr_read_b32 v49, a137
    v_accvgpr_read_b32 v50, a138
    v_accvgpr_read_b32 v51, a139
    v_accvgpr_read_b32 v56, a152
    v_accvgpr_read_b32 v57, a153
    v_accvgpr_read_b32 v58, a154
    v_accvgpr_read_b32 v59, a155
    v_accvgpr_read_b32 v52, a140
    v_accvgpr_read_b32 v53, a141
    v_accvgpr_read_b32 v54, a142
    v_accvgpr_read_b32 v55, a143
    v_accvgpr_read_b32 v60, a156
    v_accvgpr_read_b32 v61, a157
    v_accvgpr_read_b32 v62, a158
    v_accvgpr_read_b32 v63, a159
    v_mul_f32 v64, v48, v48
    v_mul_f32 v65, v49, v49
    v_mul_f32 v66, v50, v50
    v_mul_f32 v67, v51, v51
    v_mul_f32 v68, v52, v52
    v_mul_f32 v69, v53, v53
    v_mul_f32 v70, v54, v54
    v_mul_f32 v71, v55, v55
    v_fma_f32 v64, v64, v9, s28
    v_fma_f32 v65, v65, v9, s28
    v_fma_f32 v66, v66, v9, s28
    v_fma_f32 v67, v67, v9, s28
    v_fma_f32 v68, v68, v9, s28
    v_fma_f32 v69, v69, v9, s28
    v_fma_f32 v70, v70, v9, s28
    v_fma_f32 v71, v71, v9, s28
    v_mul_f32 v64, v64, v48
    v_mul_f32 v65, v65, v49
    v_mul_f32 v66, v66, v50
    v_mul_f32 v67, v67, v51
    v_mul_f32 v68, v68, v52
    v_mul_f32 v69, v69, v53
    v_mul_f32 v70, v70, v54
    v_mul_f32 v71, v71, v55
    v_exp_f32 v64, v64
    v_exp_f32 v65, v65
    v_exp_f32 v66, v66
    v_exp_f32 v67, v67
    v_exp_f32 v68, v68
    v_exp_f32 v69, v69
    v_exp_f32 v70, v70
    v_exp_f32 v71, v71
    v_add_f32 v64, 1.0, v64
    v_add_f32 v65, 1.0, v65
    v_add_f32 v66, 1.0, v66
    v_add_f32 v67, 1.0, v67
    v_add_f32 v68, 1.0, v68
    v_add_f32 v69, 1.0, v69
    v_add_f32 v70, 1.0, v70
    v_add_f32 v71, 1.0, v71
    v_rcp_f32 v64, v64
    v_rcp_f32 v65, v65
    v_rcp_f32 v66, v66
    v_rcp_f32 v67, v67
    v_rcp_f32 v68, v68
    v_rcp_f32 v69, v69
    v_rcp_f32 v70, v70
    v_rcp_f32 v71, v71
    v_mul_f32 v48, v48, v64
    v_mul_f32 v49, v49, v65
    v_mul_f32 v50, v50, v66
    v_mul_f32 v51, v51, v67
    v_mul_f32 v52, v52, v68
    v_mul_f32 v53, v53, v69
    v_mul_f32 v54, v54, v70
    v_mul_f32 v55, v55, v71
    v_mul_f32 v48, v48, v56
    v_mul_f32 v49, v49, v57
    v_mul_f32 v50, v50, v58
    v_mul_f32 v51, v51, v59
    v_mul_f32 v52, v52, v60
    v_mul_f32 v53, v53, v61
    v_mul_f32 v54, v54, v62
    v_mul_f32 v55, v55, v63
    v_cvt_pk_bf16_f32 v72, v48, v49
    v_cvt_pk_bf16_f32 v73, v50, v51
    v_cvt_pk_bf16_f32 v74, v52, v53
    v_cvt_pk_bf16_f32 v75, v54, v55
    buffer_store_dwordx4 v[72:75], v1, s[4:7], s30 offen offset:1024 sc1
    s_add_u32 s30, s30, 186368
    v_accvgpr_read_b32 v16, a160
    v_accvgpr_read_b32 v17, a161
    v_accvgpr_read_b32 v18, a162
    v_accvgpr_read_b32 v19, a163
    v_accvgpr_read_b32 v24, a176
    v_accvgpr_read_b32 v25, a177
    v_accvgpr_read_b32 v26, a178
    v_accvgpr_read_b32 v27, a179
    v_accvgpr_read_b32 v20, a164
    v_accvgpr_read_b32 v21, a165
    v_accvgpr_read_b32 v22, a166
    v_accvgpr_read_b32 v23, a167
    v_accvgpr_read_b32 v28, a180
    v_accvgpr_read_b32 v29, a181
    v_accvgpr_read_b32 v30, a182
    v_accvgpr_read_b32 v31, a183
    v_mul_f32 v32, v16, v16
    v_mul_f32 v33, v17, v17
    v_mul_f32 v34, v18, v18
    v_mul_f32 v35, v19, v19
    v_mul_f32 v36, v20, v20
    v_mul_f32 v37, v21, v21
    v_mul_f32 v38, v22, v22
    v_mul_f32 v39, v23, v23
    v_fma_f32 v32, v32, v9, s28
    v_fma_f32 v33, v33, v9, s28
    v_fma_f32 v34, v34, v9, s28
    v_fma_f32 v35, v35, v9, s28
    v_fma_f32 v36, v36, v9, s28
    v_fma_f32 v37, v37, v9, s28
    v_fma_f32 v38, v38, v9, s28
    v_fma_f32 v39, v39, v9, s28
    v_mul_f32 v32, v32, v16
    v_mul_f32 v33, v33, v17
    v_mul_f32 v34, v34, v18
    v_mul_f32 v35, v35, v19
    v_mul_f32 v36, v36, v20
    v_mul_f32 v37, v37, v21
    v_mul_f32 v38, v38, v22
    v_mul_f32 v39, v39, v23
    v_exp_f32 v32, v32
    v_exp_f32 v33, v33
    v_exp_f32 v34, v34
    v_exp_f32 v35, v35
    v_exp_f32 v36, v36
    v_exp_f32 v37, v37
    v_exp_f32 v38, v38
    v_exp_f32 v39, v39
    v_add_f32 v32, 1.0, v32
    v_add_f32 v33, 1.0, v33
    v_add_f32 v34, 1.0, v34
    v_add_f32 v35, 1.0, v35
    v_add_f32 v36, 1.0, v36
    v_add_f32 v37, 1.0, v37
    v_add_f32 v38, 1.0, v38
    v_add_f32 v39, 1.0, v39
    v_rcp_f32 v32, v32
    v_rcp_f32 v33, v33
    v_rcp_f32 v34, v34
    v_rcp_f32 v35, v35
    v_rcp_f32 v36, v36
    v_rcp_f32 v37, v37
    v_rcp_f32 v38, v38
    v_rcp_f32 v39, v39
    v_mul_f32 v16, v16, v32
    v_mul_f32 v17, v17, v33
    v_mul_f32 v18, v18, v34
    v_mul_f32 v19, v19, v35
    v_mul_f32 v20, v20, v36
    v_mul_f32 v21, v21, v37
    v_mul_f32 v22, v22, v38
    v_mul_f32 v23, v23, v39
    v_mul_f32 v16, v16, v24
    v_mul_f32 v17, v17, v25
    v_mul_f32 v18, v18, v26
    v_mul_f32 v19, v19, v27
    v_mul_f32 v20, v20, v28
    v_mul_f32 v21, v21, v29
    v_mul_f32 v22, v22, v30
    v_mul_f32 v23, v23, v31
    v_cvt_pk_bf16_f32 v40, v16, v17
    v_cvt_pk_bf16_f32 v41, v18, v19
    v_cvt_pk_bf16_f32 v42, v20, v21
    v_cvt_pk_bf16_f32 v43, v22, v23
    buffer_store_dwordx4 v[40:43], v1, s[4:7], s30 offen offset:0 sc1
    v_accvgpr_read_b32 v48, a168
    v_accvgpr_read_b32 v49, a169
    v_accvgpr_read_b32 v50, a170
    v_accvgpr_read_b32 v51, a171
    v_accvgpr_read_b32 v56, a184
    v_accvgpr_read_b32 v57, a185
    v_accvgpr_read_b32 v58, a186
    v_accvgpr_read_b32 v59, a187
    v_accvgpr_read_b32 v52, a172
    v_accvgpr_read_b32 v53, a173
    v_accvgpr_read_b32 v54, a174
    v_accvgpr_read_b32 v55, a175
    v_accvgpr_read_b32 v60, a188
    v_accvgpr_read_b32 v61, a189
    v_accvgpr_read_b32 v62, a190
    v_accvgpr_read_b32 v63, a191
    v_mul_f32 v64, v48, v48
    v_mul_f32 v65, v49, v49
    v_mul_f32 v66, v50, v50
    v_mul_f32 v67, v51, v51
    v_mul_f32 v68, v52, v52
    v_mul_f32 v69, v53, v53
    v_mul_f32 v70, v54, v54
    v_mul_f32 v71, v55, v55
    v_fma_f32 v64, v64, v9, s28
    v_fma_f32 v65, v65, v9, s28
    v_fma_f32 v66, v66, v9, s28
    v_fma_f32 v67, v67, v9, s28
    v_fma_f32 v68, v68, v9, s28
    v_fma_f32 v69, v69, v9, s28
    v_fma_f32 v70, v70, v9, s28
    v_fma_f32 v71, v71, v9, s28
    v_mul_f32 v64, v64, v48
    v_mul_f32 v65, v65, v49
    v_mul_f32 v66, v66, v50
    v_mul_f32 v67, v67, v51
    v_mul_f32 v68, v68, v52
    v_mul_f32 v69, v69, v53
    v_mul_f32 v70, v70, v54
    v_mul_f32 v71, v71, v55
    v_exp_f32 v64, v64
    v_exp_f32 v65, v65
    v_exp_f32 v66, v66
    v_exp_f32 v67, v67
    v_exp_f32 v68, v68
    v_exp_f32 v69, v69
    v_exp_f32 v70, v70
    v_exp_f32 v71, v71
    v_add_f32 v64, 1.0, v64
    v_add_f32 v65, 1.0, v65
    v_add_f32 v66, 1.0, v66
    v_add_f32 v67, 1.0, v67
    v_add_f32 v68, 1.0, v68
    v_add_f32 v69, 1.0, v69
    v_add_f32 v70, 1.0, v70
    v_add_f32 v71, 1.0, v71
    v_rcp_f32 v64, v64
    v_rcp_f32 v65, v65
    v_rcp_f32 v66, v66
    v_rcp_f32 v67, v67
    v_rcp_f32 v68, v68
    v_rcp_f32 v69, v69
    v_rcp_f32 v70, v70
    v_rcp_f32 v71, v71
    v_mul_f32 v48, v48, v64
    v_mul_f32 v49, v49, v65
    v_mul_f32 v50, v50, v66
    v_mul_f32 v51, v51, v67
    v_mul_f32 v52, v52, v68
    v_mul_f32 v53, v53, v69
    v_mul_f32 v54, v54, v70
    v_mul_f32 v55, v55, v71
    v_mul_f32 v48, v48, v56
    v_mul_f32 v49, v49, v57
    v_mul_f32 v50, v50, v58
    v_mul_f32 v51, v51, v59
    v_mul_f32 v52, v52, v60
    v_mul_f32 v53, v53, v61
    v_mul_f32 v54, v54, v62
    v_mul_f32 v55, v55, v63
    v_cvt_pk_bf16_f32 v72, v48, v49
    v_cvt_pk_bf16_f32 v73, v50, v51
    v_cvt_pk_bf16_f32 v74, v52, v53
    v_cvt_pk_bf16_f32 v75, v54, v55
    buffer_store_dwordx4 v[72:75], v1, s[4:7], s30 offen offset:1024 sc1
    s_add_u32 s30, s30, 186368
    v_accvgpr_read_b32 v16, a192
    v_accvgpr_read_b32 v17, a193
    v_accvgpr_read_b32 v18, a194
    v_accvgpr_read_b32 v19, a195
    v_accvgpr_read_b32 v24, a208
    v_accvgpr_read_b32 v25, a209
    v_accvgpr_read_b32 v26, a210
    v_accvgpr_read_b32 v27, a211
    v_accvgpr_read_b32 v20, a196
    v_accvgpr_read_b32 v21, a197
    v_accvgpr_read_b32 v22, a198
    v_accvgpr_read_b32 v23, a199
    v_accvgpr_read_b32 v28, a212
    v_accvgpr_read_b32 v29, a213
    v_accvgpr_read_b32 v30, a214
    v_accvgpr_read_b32 v31, a215
    v_mul_f32 v32, v16, v16
    v_mul_f32 v33, v17, v17
    v_mul_f32 v34, v18, v18
    v_mul_f32 v35, v19, v19
    v_mul_f32 v36, v20, v20
    v_mul_f32 v37, v21, v21
    v_mul_f32 v38, v22, v22
    v_mul_f32 v39, v23, v23
    v_fma_f32 v32, v32, v9, s28
    v_fma_f32 v33, v33, v9, s28
    v_fma_f32 v34, v34, v9, s28
    v_fma_f32 v35, v35, v9, s28
    v_fma_f32 v36, v36, v9, s28
    v_fma_f32 v37, v37, v9, s28
    v_fma_f32 v38, v38, v9, s28
    v_fma_f32 v39, v39, v9, s28
    v_mul_f32 v32, v32, v16
    v_mul_f32 v33, v33, v17
    v_mul_f32 v34, v34, v18
    v_mul_f32 v35, v35, v19
    v_mul_f32 v36, v36, v20
    v_mul_f32 v37, v37, v21
    v_mul_f32 v38, v38, v22
    v_mul_f32 v39, v39, v23
    v_exp_f32 v32, v32
    v_exp_f32 v33, v33
    v_exp_f32 v34, v34
    v_exp_f32 v35, v35
    v_exp_f32 v36, v36
    v_exp_f32 v37, v37
    v_exp_f32 v38, v38
    v_exp_f32 v39, v39
    v_add_f32 v32, 1.0, v32
    v_add_f32 v33, 1.0, v33
    v_add_f32 v34, 1.0, v34
    v_add_f32 v35, 1.0, v35
    v_add_f32 v36, 1.0, v36
    v_add_f32 v37, 1.0, v37
    v_add_f32 v38, 1.0, v38
    v_add_f32 v39, 1.0, v39
    v_rcp_f32 v32, v32
    v_rcp_f32 v33, v33
    v_rcp_f32 v34, v34
    v_rcp_f32 v35, v35
    v_rcp_f32 v36, v36
    v_rcp_f32 v37, v37
    v_rcp_f32 v38, v38
    v_rcp_f32 v39, v39
    v_mul_f32 v16, v16, v32
    v_mul_f32 v17, v17, v33
    v_mul_f32 v18, v18, v34
    v_mul_f32 v19, v19, v35
    v_mul_f32 v20, v20, v36
    v_mul_f32 v21, v21, v37
    v_mul_f32 v22, v22, v38
    v_mul_f32 v23, v23, v39
    v_mul_f32 v16, v16, v24
    v_mul_f32 v17, v17, v25
    v_mul_f32 v18, v18, v26
    v_mul_f32 v19, v19, v27
    v_mul_f32 v20, v20, v28
    v_mul_f32 v21, v21, v29
    v_mul_f32 v22, v22, v30
    v_mul_f32 v23, v23, v31
    v_cvt_pk_bf16_f32 v40, v16, v17
    v_cvt_pk_bf16_f32 v41, v18, v19
    v_cvt_pk_bf16_f32 v42, v20, v21
    v_cvt_pk_bf16_f32 v43, v22, v23
    buffer_store_dwordx4 v[40:43], v1, s[4:7], s30 offen offset:0 sc1
    v_accvgpr_read_b32 v48, a200
    v_accvgpr_read_b32 v49, a201
    v_accvgpr_read_b32 v50, a202
    v_accvgpr_read_b32 v51, a203
    v_accvgpr_read_b32 v56, a216
    v_accvgpr_read_b32 v57, a217
    v_accvgpr_read_b32 v58, a218
    v_accvgpr_read_b32 v59, a219
    v_accvgpr_read_b32 v52, a204
    v_accvgpr_read_b32 v53, a205
    v_accvgpr_read_b32 v54, a206
    v_accvgpr_read_b32 v55, a207
    v_accvgpr_read_b32 v60, a220
    v_accvgpr_read_b32 v61, a221
    v_accvgpr_read_b32 v62, a222
    v_accvgpr_read_b32 v63, a223
    v_mul_f32 v64, v48, v48
    v_mul_f32 v65, v49, v49
    v_mul_f32 v66, v50, v50
    v_mul_f32 v67, v51, v51
    v_mul_f32 v68, v52, v52
    v_mul_f32 v69, v53, v53
    v_mul_f32 v70, v54, v54
    v_mul_f32 v71, v55, v55
    v_fma_f32 v64, v64, v9, s28
    v_fma_f32 v65, v65, v9, s28
    v_fma_f32 v66, v66, v9, s28
    v_fma_f32 v67, v67, v9, s28
    v_fma_f32 v68, v68, v9, s28
    v_fma_f32 v69, v69, v9, s28
    v_fma_f32 v70, v70, v9, s28
    v_fma_f32 v71, v71, v9, s28
    v_mul_f32 v64, v64, v48
    v_mul_f32 v65, v65, v49
    v_mul_f32 v66, v66, v50
    v_mul_f32 v67, v67, v51
    v_mul_f32 v68, v68, v52
    v_mul_f32 v69, v69, v53
    v_mul_f32 v70, v70, v54
    v_mul_f32 v71, v71, v55
    v_exp_f32 v64, v64
    v_exp_f32 v65, v65
    v_exp_f32 v66, v66
    v_exp_f32 v67, v67
    v_exp_f32 v68, v68
    v_exp_f32 v69, v69
    v_exp_f32 v70, v70
    v_exp_f32 v71, v71
    v_add_f32 v64, 1.0, v64
    v_add_f32 v65, 1.0, v65
    v_add_f32 v66, 1.0, v66
    v_add_f32 v67, 1.0, v67
    v_add_f32 v68, 1.0, v68
    v_add_f32 v69, 1.0, v69
    v_add_f32 v70, 1.0, v70
    v_add_f32 v71, 1.0, v71
    v_rcp_f32 v64, v64
    v_rcp_f32 v65, v65
    v_rcp_f32 v66, v66
    v_rcp_f32 v67, v67
    v_rcp_f32 v68, v68
    v_rcp_f32 v69, v69
    v_rcp_f32 v70, v70
    v_rcp_f32 v71, v71
    v_mul_f32 v48, v48, v64
    v_mul_f32 v49, v49, v65
    v_mul_f32 v50, v50, v66
    v_mul_f32 v51, v51, v67
    v_mul_f32 v52, v52, v68
    v_mul_f32 v53, v53, v69
    v_mul_f32 v54, v54, v70
    v_mul_f32 v55, v55, v71
    v_mul_f32 v48, v48, v56
    v_mul_f32 v49, v49, v57
    v_mul_f32 v50, v50, v58
    v_mul_f32 v51, v51, v59
    v_mul_f32 v52, v52, v60
    v_mul_f32 v53, v53, v61
    v_mul_f32 v54, v54, v62
    v_mul_f32 v55, v55, v63
    v_cvt_pk_bf16_f32 v72, v48, v49
    v_cvt_pk_bf16_f32 v73, v50, v51
    v_cvt_pk_bf16_f32 v74, v52, v53
    v_cvt_pk_bf16_f32 v75, v54, v55
    buffer_store_dwordx4 v[72:75], v1, s[4:7], s30 offen offset:1024 sc1
    s_add_u32 s30, s30, 186368
    v_accvgpr_read_b32 v16, a224
    v_accvgpr_read_b32 v17, a225
    v_accvgpr_read_b32 v18, a226
    v_accvgpr_read_b32 v19, a227
    v_accvgpr_read_b32 v24, a240
    v_accvgpr_read_b32 v25, a241
    v_accvgpr_read_b32 v26, a242
    v_accvgpr_read_b32 v27, a243
    v_accvgpr_read_b32 v20, a228
    v_accvgpr_read_b32 v21, a229
    v_accvgpr_read_b32 v22, a230
    v_accvgpr_read_b32 v23, a231
    v_accvgpr_read_b32 v28, a244
    v_accvgpr_read_b32 v29, a245
    v_accvgpr_read_b32 v30, a246
    v_accvgpr_read_b32 v31, a247
    v_mul_f32 v32, v16, v16
    v_mul_f32 v33, v17, v17
    v_mul_f32 v34, v18, v18
    v_mul_f32 v35, v19, v19
    v_mul_f32 v36, v20, v20
    v_mul_f32 v37, v21, v21
    v_mul_f32 v38, v22, v22
    v_mul_f32 v39, v23, v23
    v_fma_f32 v32, v32, v9, s28
    v_fma_f32 v33, v33, v9, s28
    v_fma_f32 v34, v34, v9, s28
    v_fma_f32 v35, v35, v9, s28
    v_fma_f32 v36, v36, v9, s28
    v_fma_f32 v37, v37, v9, s28
    v_fma_f32 v38, v38, v9, s28
    v_fma_f32 v39, v39, v9, s28
    v_mul_f32 v32, v32, v16
    v_mul_f32 v33, v33, v17
    v_mul_f32 v34, v34, v18
    v_mul_f32 v35, v35, v19
    v_mul_f32 v36, v36, v20
    v_mul_f32 v37, v37, v21
    v_mul_f32 v38, v38, v22
    v_mul_f32 v39, v39, v23
    v_exp_f32 v32, v32
    v_exp_f32 v33, v33
    v_exp_f32 v34, v34
    v_exp_f32 v35, v35
    v_exp_f32 v36, v36
    v_exp_f32 v37, v37
    v_exp_f32 v38, v38
    v_exp_f32 v39, v39
    v_add_f32 v32, 1.0, v32
    v_add_f32 v33, 1.0, v33
    v_add_f32 v34, 1.0, v34
    v_add_f32 v35, 1.0, v35
    v_add_f32 v36, 1.0, v36
    v_add_f32 v37, 1.0, v37
    v_add_f32 v38, 1.0, v38
    v_add_f32 v39, 1.0, v39
    v_rcp_f32 v32, v32
    v_rcp_f32 v33, v33
    v_rcp_f32 v34, v34
    v_rcp_f32 v35, v35
    v_rcp_f32 v36, v36
    v_rcp_f32 v37, v37
    v_rcp_f32 v38, v38
    v_rcp_f32 v39, v39
    v_mul_f32 v16, v16, v32
    v_mul_f32 v17, v17, v33
    v_mul_f32 v18, v18, v34
    v_mul_f32 v19, v19, v35
    v_mul_f32 v20, v20, v36
    v_mul_f32 v21, v21, v37
    v_mul_f32 v22, v22, v38
    v_mul_f32 v23, v23, v39
    v_mul_f32 v16, v16, v24
    v_mul_f32 v17, v17, v25
    v_mul_f32 v18, v18, v26
    v_mul_f32 v19, v19, v27
    v_mul_f32 v20, v20, v28
    v_mul_f32 v21, v21, v29
    v_mul_f32 v22, v22, v30
    v_mul_f32 v23, v23, v31
    v_cvt_pk_bf16_f32 v40, v16, v17
    v_cvt_pk_bf16_f32 v41, v18, v19
    v_cvt_pk_bf16_f32 v42, v20, v21
    v_cvt_pk_bf16_f32 v43, v22, v23
    buffer_store_dwordx4 v[40:43], v1, s[4:7], s30 offen offset:0 sc1
    v_accvgpr_read_b32 v48, a232
    v_accvgpr_read_b32 v49, a233
    v_accvgpr_read_b32 v50, a234
    v_accvgpr_read_b32 v51, a235
    v_accvgpr_read_b32 v56, a248
    v_accvgpr_read_b32 v57, a249
    v_accvgpr_read_b32 v58, a250
    v_accvgpr_read_b32 v59, a251
    v_accvgpr_read_b32 v52, a236
    v_accvgpr_read_b32 v53, a237
    v_accvgpr_read_b32 v54, a238
    v_accvgpr_read_b32 v55, a239
    v_accvgpr_read_b32 v60, a252
    v_accvgpr_read_b32 v61, a253
    v_accvgpr_read_b32 v62, a254
    v_accvgpr_read_b32 v63, a255
    v_mul_f32 v64, v48, v48
    v_mul_f32 v65, v49, v49
    v_mul_f32 v66, v50, v50
    v_mul_f32 v67, v51, v51
    v_mul_f32 v68, v52, v52
    v_mul_f32 v69, v53, v53
    v_mul_f32 v70, v54, v54
    v_mul_f32 v71, v55, v55
    v_fma_f32 v64, v64, v9, s28
    v_fma_f32 v65, v65, v9, s28
    v_fma_f32 v66, v66, v9, s28
    v_fma_f32 v67, v67, v9, s28
    v_fma_f32 v68, v68, v9, s28
    v_fma_f32 v69, v69, v9, s28
    v_fma_f32 v70, v70, v9, s28
    v_fma_f32 v71, v71, v9, s28
    v_mul_f32 v64, v64, v48
    v_mul_f32 v65, v65, v49
    v_mul_f32 v66, v66, v50
    v_mul_f32 v67, v67, v51
    v_mul_f32 v68, v68, v52
    v_mul_f32 v69, v69, v53
    v_mul_f32 v70, v70, v54
    v_mul_f32 v71, v71, v55
    v_exp_f32 v64, v64
    v_exp_f32 v65, v65
    v_exp_f32 v66, v66
    v_exp_f32 v67, v67
    v_exp_f32 v68, v68
    v_exp_f32 v69, v69
    v_exp_f32 v70, v70
    v_exp_f32 v71, v71
    v_add_f32 v64, 1.0, v64
    v_add_f32 v65, 1.0, v65
    v_add_f32 v66, 1.0, v66
    v_add_f32 v67, 1.0, v67
    v_add_f32 v68, 1.0, v68
    v_add_f32 v69, 1.0, v69
    v_add_f32 v70, 1.0, v70
    v_add_f32 v71, 1.0, v71
    v_rcp_f32 v64, v64
    v_rcp_f32 v65, v65
    v_rcp_f32 v66, v66
    v_rcp_f32 v67, v67
    v_rcp_f32 v68, v68
    v_rcp_f32 v69, v69
    v_rcp_f32 v70, v70
    v_rcp_f32 v71, v71
    v_mul_f32 v48, v48, v64
    v_mul_f32 v49, v49, v65
    v_mul_f32 v50, v50, v66
    v_mul_f32 v51, v51, v67
    v_mul_f32 v52, v52, v68
    v_mul_f32 v53, v53, v69
    v_mul_f32 v54, v54, v70
    v_mul_f32 v55, v55, v71
    v_mul_f32 v48, v48, v56
    v_mul_f32 v49, v49, v57
    v_mul_f32 v50, v50, v58
    v_mul_f32 v51, v51, v59
    v_mul_f32 v52, v52, v60
    v_mul_f32 v53, v53, v61
    v_mul_f32 v54, v54, v62
    v_mul_f32 v55, v55, v63
    v_cvt_pk_bf16_f32 v72, v48, v49
    v_cvt_pk_bf16_f32 v73, v50, v51
    v_cvt_pk_bf16_f32 v74, v52, v53
    v_cvt_pk_bf16_f32 v75, v54, v55
    buffer_store_dwordx4 v[72:75], v1, s[4:7], s30 offen offset:1024 sc1
    s_add_u32 s30, s30, 186368
wk_done:
    v_mov_b32 v9, 0x10000
    s_branch wk_at
wk_cnt:
    s_lshl_b32 s22, s20, 11
    s_lshl_b32 s23, s21, 8
    s_add_u32 s22, s22, s23
    s_lshl_b32 s23, s3, 6
    s_add_u32 s22, s22, s23
    s_add_u32 s22, s22, 143605760
    v_lshlrev_b32 v10, 2, v3
    s_waitcnt vmcnt(0)
    buffer_store_dword v9, v10, s[4:7], s22 offen sc1
wk_at:
    s_add_u32 s19, s19, 192
    s_lshl_b32 s21, s21, 2
    v_lshlrev_b32 v10, 8, v0
    s_waitcnt vmcnt(0)
    s_barrier
    s_cmp_lg_u32 s3, 0
    s_cbranch_scc1 wk_na
    buffer_atomic_add v9, v10, s[72:75], s21 offen sc1
wk_na:
    s_cmp_ge_u32 s19, 382
    s_cbranch_scc1 wk_next
    s_lshl_b32 s21, s17, 2
    s_add_u32 s21, s21, s3
    s_lshl_b32 s21, s21, 14
    s_add_u32 s21, s21, 131137536
    v_mov_b32 v12, -1
    v_mov_b32 v13, -1
    v_mov_b32 v14, -1
    v_mov_b32 v15, -1
    buffer_store_dwordx4 v[12:15], v1, s[4:7], s21 offen offset:0 sc1
    buffer_store_dwordx4 v[12:15], v1, s[4:7], s21 offen offset:1024 sc1
    buffer_store_dwordx4 v[12:15], v1, s[4:7], s21 offen offset:2048 sc1
    buffer_store_dwordx4 v[12:15], v1, s[4:7], s21 offen offset:3072 sc1
    s_add_u32 s21, s21, 4096
    buffer_store_dwordx4 v[12:15], v1, s[4:7], s21 offen offset:0 sc1
    buffer_store_dwordx4 v[12:15], v1, s[4:7], s21 offen offset:1024 sc1
    buffer_store_dwordx4 v[12:15], v1, s[4:7], s21 offen offset:2048 sc1
    buffer_store_dwordx4 v[12:15], v1, s[4:7], s21 offen offset:3072 sc1
    s_add_u32 s21, s21, 4096
    buffer_store_dwordx4 v[12:15], v1, s[4:7], s21 offen offset:0 sc1
    buffer_store_dwordx4 v[12:15], v1, s[4:7], s21 offen offset:1024 sc1
    buffer_store_dwordx4 v[12:15], v1, s[4:7], s21 offen offset:2048 sc1
    buffer_store_dwordx4 v[12:15], v1, s[4:7], s21 offen offset:3072 sc1
    s_add_u32 s21, s21, 4096
    buffer_store_dwordx4 v[12:15], v1, s[4:7], s21 offen offset:0 sc1
    buffer_store_dwordx4 v[12:15], v1, s[4:7], s21 offen offset:1024 sc1
    buffer_store_dwordx4 v[12:15], v1, s[4:7], s21 offen offset:2048 sc1
    buffer_store_dwordx4 v[12:15], v1, s[4:7], s21 offen offset:3072 sc1
    s_add_u32 s21, s21, 4096
    s_waitcnt vmcnt(0)
    s_branch wk_next
wk_kv:
    v_mov_b32 v9, 1
    s_mul_i32 s20, s19, 10923
    s_lshr_b32 s20, s20, 16
    s_mul_i32 s21, s20, 6
    s_sub_u32 s21, s19, s21
    s_bfe_u32 s22, s19, 0x50001
    s_and_b32 s23, s19, 1
    s_add_u32 s23, s23, 6
    s_cmp_ge_u32 s19, 192
    s_cselect_b32 s20, s22, s20
    s_cselect_b32 s21, s23, s21
    s_mul_i32 s22, s21, 327680
    s_mul_i32 s23, s20, 163840
    s_add_u32 s24, s23, 13631488
    s_add_u32 s23, s23, 8388608
    s_mul_i32 s40, s3, 163840
    s_add_u32 s40, s40, s22
    s_cmp_eq_u32 s3, 2
    s_cselect_b32 s40, s23, s40
    s_cmp_eq_u32 s3, 3
    s_cselect_b32 s40, s24, s40
    s_mov_b32 s39, 81920
    s_cmp_ge_u32 s3, 2
    s_cselect_b32 s39, 81920, s39
    s_add_u32 s44, s40, s39
    s_add_u32 s41, s40, 20480
    s_add_u32 s45, s44, 20480
    s_add_u32 s42, s40, 40960
    s_add_u32 s46, s44, 40960
    s_add_u32 s43, s40, 61440
    s_add_u32 s47, s44, 61440
    s_waitcnt lgkmcnt(0)
    s_mul_i32 s38, s3, 8192
    v_mov_b32 v4, v1
    s_lshr_b32 s36, s3, 1
    s_and_b32 s37, s3, 1
    s_add_u32 m0, s38, 0
    s_nop 0
    buffer_load_dwordx4 v4, s[4:7], s40 offen  lds
    s_add_u32 m0, s38, 1024
    s_nop 0
    buffer_load_dwordx4 v4, s[4:7], s41 offen  lds
    s_add_u32 m0, s38, 2048
    s_nop 0
    buffer_load_dwordx4 v4, s[4:7], s42 offen  lds
    s_add_u32 m0, s38, 3072
    s_nop 0
    buffer_load_dwordx4 v4, s[4:7], s43 offen  lds
    s_add_u32 m0, s38, 4096
    s_nop 0
    buffer_load_dwordx4 v4, s[4:7], s44 offen  lds
    s_add_u32 m0, s38, 5120
    s_nop 0
    buffer_load_dwordx4 v4, s[4:7], s45 offen  lds
    s_add_u32 m0, s38, 6144
    s_nop 0
    buffer_load_dwordx4 v4, s[4:7], s46 offen  lds
    s_add_u32 m0, s38, 7168
    s_nop 0
    buffer_load_dwordx4 v4, s[4:7], s47 offen  lds
    v_add_u32 v4, 1024, v4
    s_add_u32 m0, s38, 32768
    s_nop 0
    buffer_load_dwordx4 v4, s[4:7], s40 offen  lds
    s_add_u32 m0, s38, 33792
    s_nop 0
    buffer_load_dwordx4 v4, s[4:7], s41 offen  lds
    s_add_u32 m0, s38, 34816
    s_nop 0
    buffer_load_dwordx4 v4, s[4:7], s42 offen  lds
    s_add_u32 m0, s38, 35840
    s_nop 0
    buffer_load_dwordx4 v4, s[4:7], s43 offen  lds
    s_add_u32 m0, s38, 36864
    s_nop 0
    buffer_load_dwordx4 v4, s[4:7], s44 offen  lds
    s_add_u32 m0, s38, 37888
    s_nop 0
    buffer_load_dwordx4 v4, s[4:7], s45 offen  lds
    s_add_u32 m0, s38, 38912
    s_nop 0
    buffer_load_dwordx4 v4, s[4:7], s46 offen  lds
    s_add_u32 m0, s38, 39936
    s_nop 0
    buffer_load_dwordx4 v4, s[4:7], s47 offen  lds
    v_add_u32 v4, 1024, v4
    s_add_u32 m0, s38, 65536
    s_nop 0
    buffer_load_dwordx4 v4, s[4:7], s40 offen  lds
    s_add_u32 m0, s38, 66560
    s_nop 0
    buffer_load_dwordx4 v4, s[4:7], s41 offen  lds
    s_add_u32 m0, s38, 67584
    s_nop 0
    buffer_load_dwordx4 v4, s[4:7], s42 offen  lds
    s_add_u32 m0, s38, 68608
    s_nop 0
    buffer_load_dwordx4 v4, s[4:7], s43 offen  lds
    s_add_u32 m0, s38, 69632
    s_nop 0
    buffer_load_dwordx4 v4, s[4:7], s44 offen  lds
    s_add_u32 m0, s38, 70656
    s_nop 0
    buffer_load_dwordx4 v4, s[4:7], s45 offen  lds
    s_add_u32 m0, s38, 71680
    s_nop 0
    buffer_load_dwordx4 v4, s[4:7], s46 offen  lds
    s_add_u32 m0, s38, 72704
    s_nop 0
    buffer_load_dwordx4 v4, s[4:7], s47 offen  lds
    v_add_u32 v4, 1024, v4
    s_add_u32 m0, s38, 98304
    s_nop 0
    buffer_load_dwordx4 v4, s[4:7], s40 offen  lds
    s_add_u32 m0, s38, 99328
    s_nop 0
    buffer_load_dwordx4 v4, s[4:7], s41 offen  lds
    s_add_u32 m0, s38, 100352
    s_nop 0
    buffer_load_dwordx4 v4, s[4:7], s42 offen  lds
    s_add_u32 m0, s38, 101376
    s_nop 0
    buffer_load_dwordx4 v4, s[4:7], s43 offen  lds
    s_add_u32 m0, s38, 102400
    s_nop 0
    buffer_load_dwordx4 v4, s[4:7], s44 offen  lds
    s_add_u32 m0, s38, 103424
    s_nop 0
    buffer_load_dwordx4 v4, s[4:7], s45 offen  lds
    s_add_u32 m0, s38, 104448
    s_nop 0
    buffer_load_dwordx4 v4, s[4:7], s46 offen  lds
    s_add_u32 m0, s38, 105472
    s_nop 0
    buffer_load_dwordx4 v4, s[4:7], s47 offen  lds
    v_add_u32 v4, 1024, v4
    s_mul_i32 s39, s36, 8192
    v_add_u32 v5, s39, v1
    s_mul_i32 s39, s37, 8192
    s_add_u32 s39, s39, 16384
    v_add_u32 v6, s39, v1
    v_add_u32 v7, 65536, v5
    v_add_u32 v8, 65536, v6
    s_mov_b32 s35, 20
    v_accvgpr_write_b32 a0, 0
    v_accvgpr_write_b32 a1, 0
    v_accvgpr_write_b32 a2, 0
    v_accvgpr_write_b32 a3, 0
    v_accvgpr_write_b32 a4, 0
    v_accvgpr_write_b32 a5, 0
    v_accvgpr_write_b32 a6, 0
    v_accvgpr_write_b32 a7, 0
    v_accvgpr_write_b32 a8, 0
    v_accvgpr_write_b32 a9, 0
    v_accvgpr_write_b32 a10, 0
    v_accvgpr_write_b32 a11, 0
    v_accvgpr_write_b32 a12, 0
    v_accvgpr_write_b32 a13, 0
    v_accvgpr_write_b32 a14, 0
    v_accvgpr_write_b32 a15, 0
    v_accvgpr_write_b32 a16, 0
    v_accvgpr_write_b32 a17, 0
    v_accvgpr_write_b32 a18, 0
    v_accvgpr_write_b32 a19, 0
    v_accvgpr_write_b32 a20, 0
    v_accvgpr_write_b32 a21, 0
    v_accvgpr_write_b32 a22, 0
    v_accvgpr_write_b32 a23, 0
    v_accvgpr_write_b32 a24, 0
    v_accvgpr_write_b32 a25, 0
    v_accvgpr_write_b32 a26, 0
    v_accvgpr_write_b32 a27, 0
    v_accvgpr_write_b32 a28, 0
    v_accvgpr_write_b32 a29, 0
    v_accvgpr_write_b32 a30, 0
    v_accvgpr_write_b32 a31, 0
    v_accvgpr_write_b32 a32, 0
    v_accvgpr_write_b32 a33, 0
    v_accvgpr_write_b32 a34, 0
    v_accvgpr_write_b32 a35, 0
    v_accvgpr_write_b32 a36, 0
    v_accvgpr_write_b32 a37, 0
    v_accvgpr_write_b32 a38, 0
    v_accvgpr_write_b32 a39, 0
    v_accvgpr_write_b32 a40, 0
    v_accvgpr_write_b32 a41, 0
    v_accvgpr_write_b32 a42, 0
    v_accvgpr_write_b32 a43, 0
    v_accvgpr_write_b32 a44, 0
    v_accvgpr_write_b32 a45, 0
    v_accvgpr_write_b32 a46, 0
    v_accvgpr_write_b32 a47, 0
    v_accvgpr_write_b32 a48, 0
    v_accvgpr_write_b32 a49, 0
    v_accvgpr_write_b32 a50, 0
    v_accvgpr_write_b32 a51, 0
    v_accvgpr_write_b32 a52, 0
    v_accvgpr_write_b32 a53, 0
    v_accvgpr_write_b32 a54, 0
    v_accvgpr_write_b32 a55, 0
    v_accvgpr_write_b32 a56, 0
    v_accvgpr_write_b32 a57, 0
    v_accvgpr_write_b32 a58, 0
    v_accvgpr_write_b32 a59, 0
    v_accvgpr_write_b32 a60, 0
    v_accvgpr_write_b32 a61, 0
    v_accvgpr_write_b32 a62, 0
    v_accvgpr_write_b32 a63, 0
    v_accvgpr_write_b32 a64, 0
    v_accvgpr_write_b32 a65, 0
    v_accvgpr_write_b32 a66, 0
    v_accvgpr_write_b32 a67, 0
    v_accvgpr_write_b32 a68, 0
    v_accvgpr_write_b32 a69, 0
    v_accvgpr_write_b32 a70, 0
    v_accvgpr_write_b32 a71, 0
    v_accvgpr_write_b32 a72, 0
    v_accvgpr_write_b32 a73, 0
    v_accvgpr_write_b32 a74, 0
    v_accvgpr_write_b32 a75, 0
    v_accvgpr_write_b32 a76, 0
    v_accvgpr_write_b32 a77, 0
    v_accvgpr_write_b32 a78, 0
    v_accvgpr_write_b32 a79, 0
    v_accvgpr_write_b32 a80, 0
    v_accvgpr_write_b32 a81, 0
    v_accvgpr_write_b32 a82, 0
    v_accvgpr_write_b32 a83, 0
    v_accvgpr_write_b32 a84, 0
    v_accvgpr_write_b32 a85, 0
    v_accvgpr_write_b32 a86, 0
    v_accvgpr_write_b32 a87, 0
    v_accvgpr_write_b32 a88, 0
    v_accvgpr_write_b32 a89, 0
    v_accvgpr_write_b32 a90, 0
    v_accvgpr_write_b32 a91, 0
    v_accvgpr_write_b32 a92, 0
    v_accvgpr_write_b32 a93, 0
    v_accvgpr_write_b32 a94, 0
    v_accvgpr_write_b32 a95, 0
    v_accvgpr_write_b32 a96, 0
    v_accvgpr_write_b32 a97, 0
    v_accvgpr_write_b32 a98, 0
    v_accvgpr_write_b32 a99, 0
    v_accvgpr_write_b32 a100, 0
    v_accvgpr_write_b32 a101, 0
    v_accvgpr_write_b32 a102, 0
    v_accvgpr_write_b32 a103, 0
    v_accvgpr_write_b32 a104, 0
    v_accvgpr_write_b32 a105, 0
    v_accvgpr_write_b32 a106, 0
    v_accvgpr_write_b32 a107, 0
    v_accvgpr_write_b32 a108, 0
    v_accvgpr_write_b32 a109, 0
    v_accvgpr_write_b32 a110, 0
    v_accvgpr_write_b32 a111, 0
    v_accvgpr_write_b32 a112, 0
    v_accvgpr_write_b32 a113, 0
    v_accvgpr_write_b32 a114, 0
    v_accvgpr_write_b32 a115, 0
    v_accvgpr_write_b32 a116, 0
    v_accvgpr_write_b32 a117, 0
    v_accvgpr_write_b32 a118, 0
    v_accvgpr_write_b32 a119, 0
    v_accvgpr_write_b32 a120, 0
    v_accvgpr_write_b32 a121, 0
    v_accvgpr_write_b32 a122, 0
    v_accvgpr_write_b32 a123, 0
    v_accvgpr_write_b32 a124, 0
    v_accvgpr_write_b32 a125, 0
    v_accvgpr_write_b32 a126, 0
    v_accvgpr_write_b32 a127, 0
    v_accvgpr_write_b32 a128, 0
    v_accvgpr_write_b32 a129, 0
    v_accvgpr_write_b32 a130, 0
    v_accvgpr_write_b32 a131, 0
    v_accvgpr_write_b32 a132, 0
    v_accvgpr_write_b32 a133, 0
    v_accvgpr_write_b32 a134, 0
    v_accvgpr_write_b32 a135, 0
    v_accvgpr_write_b32 a136, 0
    v_accvgpr_write_b32 a137, 0
    v_accvgpr_write_b32 a138, 0
    v_accvgpr_write_b32 a139, 0
    v_accvgpr_write_b32 a140, 0
    v_accvgpr_write_b32 a141, 0
    v_accvgpr_write_b32 a142, 0
    v_accvgpr_write_b32 a143, 0
    v_accvgpr_write_b32 a144, 0
    v_accvgpr_write_b32 a145, 0
    v_accvgpr_write_b32 a146, 0
    v_accvgpr_write_b32 a147, 0
    v_accvgpr_write_b32 a148, 0
    v_accvgpr_write_b32 a149, 0
    v_accvgpr_write_b32 a150, 0
    v_accvgpr_write_b32 a151, 0
    v_accvgpr_write_b32 a152, 0
    v_accvgpr_write_b32 a153, 0
    v_accvgpr_write_b32 a154, 0
    v_accvgpr_write_b32 a155, 0
    v_accvgpr_write_b32 a156, 0
    v_accvgpr_write_b32 a157, 0
    v_accvgpr_write_b32 a158, 0
    v_accvgpr_write_b32 a159, 0
    v_accvgpr_write_b32 a160, 0
    v_accvgpr_write_b32 a161, 0
    v_accvgpr_write_b32 a162, 0
    v_accvgpr_write_b32 a163, 0
    v_accvgpr_write_b32 a164, 0
    v_accvgpr_write_b32 a165, 0
    v_accvgpr_write_b32 a166, 0
    v_accvgpr_write_b32 a167, 0
    v_accvgpr_write_b32 a168, 0
    v_accvgpr_write_b32 a169, 0
    v_accvgpr_write_b32 a170, 0
    v_accvgpr_write_b32 a171, 0
    v_accvgpr_write_b32 a172, 0
    v_accvgpr_write_b32 a173, 0
    v_accvgpr_write_b32 a174, 0
    v_accvgpr_write_b32 a175, 0
    v_accvgpr_write_b32 a176, 0
    v_accvgpr_write_b32 a177, 0
    v_accvgpr_write_b32 a178, 0
    v_accvgpr_write_b32 a179, 0
    v_accvgpr_write_b32 a180, 0
    v_accvgpr_write_b32 a181, 0
    v_accvgpr_write_b32 a182, 0
    v_accvgpr_write_b32 a183, 0
    v_accvgpr_write_b32 a184, 0
    v_accvgpr_write_b32 a185, 0
    v_accvgpr_write_b32 a186, 0
    v_accvgpr_write_b32 a187, 0
    v_accvgpr_write_b32 a188, 0
    v_accvgpr_write_b32 a189, 0
    v_accvgpr_write_b32 a190, 0
    v_accvgpr_write_b32 a191, 0
    v_accvgpr_write_b32 a192, 0
    v_accvgpr_write_b32 a193, 0
    v_accvgpr_write_b32 a194, 0
    v_accvgpr_write_b32 a195, 0
    v_accvgpr_write_b32 a196, 0
    v_accvgpr_write_b32 a197, 0
    v_accvgpr_write_b32 a198, 0
    v_accvgpr_write_b32 a199, 0
    v_accvgpr_write_b32 a200, 0
    v_accvgpr_write_b32 a201, 0
    v_accvgpr_write_b32 a202, 0
    v_accvgpr_write_b32 a203, 0
    v_accvgpr_write_b32 a204, 0
    v_accvgpr_write_b32 a205, 0
    v_accvgpr_write_b32 a206, 0
    v_accvgpr_write_b32 a207, 0
    v_accvgpr_write_b32 a208, 0
    v_accvgpr_write_b32 a209, 0
    v_accvgpr_write_b32 a210, 0
    v_accvgpr_write_b32 a211, 0
    v_accvgpr_write_b32 a212, 0
    v_accvgpr_write_b32 a213, 0
    v_accvgpr_write_b32 a214, 0
    v_accvgpr_write_b32 a215, 0
    v_accvgpr_write_b32 a216, 0
    v_accvgpr_write_b32 a217, 0
    v_accvgpr_write_b32 a218, 0
    v_accvgpr_write_b32 a219, 0
    v_accvgpr_write_b32 a220, 0
    v_accvgpr_write_b32 a221, 0
    v_accvgpr_write_b32 a222, 0
    v_accvgpr_write_b32 a223, 0
    v_accvgpr_write_b32 a224, 0
    v_accvgpr_write_b32 a225, 0
    v_accvgpr_write_b32 a226, 0
    v_accvgpr_write_b32 a227, 0
    v_accvgpr_write_b32 a228, 0
    v_accvgpr_write_b32 a229, 0
    v_accvgpr_write_b32 a230, 0
    v_accvgpr_write_b32 a231, 0
    v_accvgpr_write_b32 a232, 0
    v_accvgpr_write_b32 a233, 0
    v_accvgpr_write_b32 a234, 0
    v_accvgpr_write_b32 a235, 0
    v_accvgpr_write_b32 a236, 0
    v_accvgpr_write_b32 a237, 0
    v_accvgpr_write_b32 a238, 0
    v_accvgpr_write_b32 a239, 0
    v_accvgpr_write_b32 a240, 0
    v_accvgpr_write_b32 a241, 0
    v_accvgpr_write_b32 a242, 0
    v_accvgpr_write_b32 a243, 0
    v_accvgpr_write_b32 a244, 0
    v_accvgpr_write_b32 a245, 0
    v_accvgpr_write_b32 a246, 0
    v_accvgpr_write_b32 a247, 0
    v_accvgpr_write_b32 a248, 0
    v_accvgpr_write_b32 a249, 0
    v_accvgpr_write_b32 a250, 0
    v_accvgpr_write_b32 a251, 0
    v_accvgpr_write_b32 a252, 0
    v_accvgpr_write_b32 a253, 0
    v_accvgpr_write_b32 a254, 0
    v_accvgpr_write_b32 a255, 0
    s_waitcnt vmcnt(24)
    s_barrier
    ds_read_b128 v[16:19], v5 offset:0
    ds_read_b128 v[20:23], v5 offset:1024
    ds_read_b128 v[24:27], v5 offset:2048
    ds_read_b128 v[28:31], v5 offset:3072
    ds_read_b128 v[32:35], v5 offset:4096
    ds_read_b128 v[36:39], v5 offset:5120
    ds_read_b128 v[40:43], v5 offset:6144
    ds_read_b128 v[44:47], v5 offset:7168
    ds_read_b128 v[48:51], v6 offset:0
    ds_read_b128 v[52:55], v6 offset:1024
    ds_read_b128 v[56:59], v6 offset:2048
    ds_read_b128 v[60:63], v6 offset:3072
    ds_read_b128 v[64:67], v6 offset:4096
    ds_read_b128 v[68:71], v6 offset:5120
    ds_read_b128 v[72:75], v6 offset:6144
    ds_read_b128 v[76:79], v6 offset:7168
    s_lshl_b32 s30, s21, 21
    s_lshl_b32 s31, s36, 20
    s_add_u32 s30, s30, s31
    s_cmp_eq_u32 s37, 1
    s_cbranch_scc1 kv_v
kv_k_loop:
    s_waitcnt vmcnt(16) lgkmcnt(0)
    s_barrier
    v_mfma_f32_16x16x32_bf16 a[0:3], v[48:51], v[16:19], a[0:3]
    ds_read_b128 v[80:83], v5 offset:32768
    v_mfma_f32_16x16x32_bf16 a[4:7], v[52:55], v[16:19], a[4:7]
    ds_read_b128 v[84:87], v5 offset:33792
    v_mfma_f32_16x16x32_bf16 a[8:11], v[56:59], v[16:19], a[8:11]
    v_mfma_f32_16x16x32_bf16 a[12:15], v[60:63], v[16:19], a[12:15]
    ds_read_b128 v[88:91], v5 offset:34816
    v_mfma_f32_16x16x32_bf16 a[16:19], v[64:67], v[16:19], a[16:19]
    v_mfma_f32_16x16x32_bf16 a[20:23], v[68:71], v[16:19], a[20:23]
    ds_read_b128 v[92:95], v5 offset:35840
    v_mfma_f32_16x16x32_bf16 a[24:27], v[72:75], v[16:19], a[24:27]
    ds_read_b128 v[96:99], v5 offset:36864
    v_mfma_f32_16x16x32_bf16 a[28:31], v[76:79], v[16:19], a[28:31]
    v_mfma_f32_16x16x32_bf16 a[32:35], v[48:51], v[20:23], a[32:35]
    ds_read_b128 v[100:103], v5 offset:37888
    v_mfma_f32_16x16x32_bf16 a[36:39], v[52:55], v[20:23], a[36:39]
    v_mfma_f32_16x16x32_bf16 a[40:43], v[56:59], v[20:23], a[40:43]
    ds_read_b128 v[104:107], v5 offset:38912
    v_mfma_f32_16x16x32_bf16 a[44:47], v[60:63], v[20:23], a[44:47]
    ds_read_b128 v[108:111], v5 offset:39936
    v_mfma_f32_16x16x32_bf16 a[48:51], v[64:67], v[20:23], a[48:51]
    v_mfma_f32_16x16x32_bf16 a[52:55], v[68:71], v[20:23], a[52:55]
    ds_read_b128 v[112:115], v6 offset:32768
    v_mfma_f32_16x16x32_bf16 a[56:59], v[72:75], v[20:23], a[56:59]
    v_mfma_f32_16x16x32_bf16 a[60:63], v[76:79], v[20:23], a[60:63]
    ds_read_b128 v[116:119], v6 offset:33792
    v_mfma_f32_16x16x32_bf16 a[64:67], v[48:51], v[24:27], a[64:67]
    v_mfma_f32_16x16x32_bf16 a[68:71], v[52:55], v[24:27], a[68:71]
    ds_read_b128 v[120:123], v6 offset:34816
    v_mfma_f32_16x16x32_bf16 a[72:75], v[56:59], v[24:27], a[72:75]
    ds_read_b128 v[124:127], v6 offset:35840
    v_mfma_f32_16x16x32_bf16 a[76:79], v[60:63], v[24:27], a[76:79]
    v_mfma_f32_16x16x32_bf16 a[80:83], v[64:67], v[24:27], a[80:83]
    ds_read_b128 v[128:131], v6 offset:36864
    v_mfma_f32_16x16x32_bf16 a[84:87], v[68:71], v[24:27], a[84:87]
    v_mfma_f32_16x16x32_bf16 a[88:91], v[72:75], v[24:27], a[88:91]
    ds_read_b128 v[132:135], v6 offset:37888
    v_mfma_f32_16x16x32_bf16 a[92:95], v[76:79], v[24:27], a[92:95]
    ds_read_b128 v[136:139], v6 offset:38912
    v_mfma_f32_16x16x32_bf16 a[96:99], v[48:51], v[28:31], a[96:99]
    v_mfma_f32_16x16x32_bf16 a[100:103], v[52:55], v[28:31], a[100:103]
    ds_read_b128 v[140:143], v6 offset:39936
    v_mfma_f32_16x16x32_bf16 a[104:107], v[56:59], v[28:31], a[104:107]
    v_mfma_f32_16x16x32_bf16 a[108:111], v[60:63], v[28:31], a[108:111]
    s_add_u32 m0, s38, 0
    s_nop 0
    buffer_load_dwordx4 v4, s[4:7], s40 offen  lds
    v_mfma_f32_16x16x32_bf16 a[112:115], v[64:67], v[28:31], a[112:115]
    v_mfma_f32_16x16x32_bf16 a[116:119], v[68:71], v[28:31], a[116:119]
    s_add_u32 m0, s38, 1024
    s_nop 0
    buffer_load_dwordx4 v4, s[4:7], s41 offen  lds
    v_mfma_f32_16x16x32_bf16 a[120:123], v[72:75], v[28:31], a[120:123]
    s_add_u32 m0, s38, 2048
    s_nop 0
    buffer_load_dwordx4 v4, s[4:7], s42 offen  lds
    v_mfma_f32_16x16x32_bf16 a[124:127], v[76:79], v[28:31], a[124:127]
    v_mfma_f32_16x16x32_bf16 a[128:131], v[48:51], v[32:35], a[128:131]
    s_add_u32 m0, s38, 3072
    s_nop 0
    buffer_load_dwordx4 v4, s[4:7], s43 offen  lds
    v_mfma_f32_16x16x32_bf16 a[132:135], v[52:55], v[32:35], a[132:135]
    v_mfma_f32_16x16x32_bf16 a[136:139], v[56:59], v[32:35], a[136:139]
    s_add_u32 m0, s38, 4096
    s_nop 0
    buffer_load_dwordx4 v4, s[4:7], s44 offen  lds
    v_mfma_f32_16x16x32_bf16 a[140:143], v[60:63], v[32:35], a[140:143]
    s_add_u32 m0, s38, 5120
    s_nop 0
    buffer_load_dwordx4 v4, s[4:7], s45 offen  lds
    v_mfma_f32_16x16x32_bf16 a[144:147], v[64:67], v[32:35], a[144:147]
    v_mfma_f32_16x16x32_bf16 a[148:151], v[68:71], v[32:35], a[148:151]
    s_add_u32 m0, s38, 6144
    s_nop 0
    buffer_load_dwordx4 v4, s[4:7], s46 offen  lds
    v_mfma_f32_16x16x32_bf16 a[152:155], v[72:75], v[32:35], a[152:155]
    v_mfma_f32_16x16x32_bf16 a[156:159], v[76:79], v[32:35], a[156:159]
    s_add_u32 m0, s38, 7168
    s_nop 0
    buffer_load_dwordx4 v4, s[4:7], s47 offen  lds
    v_mfma_f32_16x16x32_bf16 a[160:163], v[48:51], v[36:39], a[160:163]
    v_add_u32 v4, 1024, v4
    v_mfma_f32_16x16x32_bf16 a[164:167], v[52:55], v[36:39], a[164:167]
    v_mfma_f32_16x16x32_bf16 a[168:171], v[56:59], v[36:39], a[168:171]
    v_mfma_f32_16x16x32_bf16 a[172:175], v[60:63], v[36:39], a[172:175]
    v_mfma_f32_16x16x32_bf16 a[176:179], v[64:67], v[36:39], a[176:179]
    v_mfma_f32_16x16x32_bf16 a[180:183], v[68:71], v[36:39], a[180:183]
    v_mfma_f32_16x16x32_bf16 a[184:187], v[72:75], v[36:39], a[184:187]
    v_mfma_f32_16x16x32_bf16 a[188:191], v[76:79], v[36:39], a[188:191]
    v_mfma_f32_16x16x32_bf16 a[192:195], v[48:51], v[40:43], a[192:195]
    v_mfma_f32_16x16x32_bf16 a[196:199], v[52:55], v[40:43], a[196:199]
    v_mfma_f32_16x16x32_bf16 a[200:203], v[56:59], v[40:43], a[200:203]
    v_mfma_f32_16x16x32_bf16 a[204:207], v[60:63], v[40:43], a[204:207]
    v_mfma_f32_16x16x32_bf16 a[208:211], v[64:67], v[40:43], a[208:211]
    v_mfma_f32_16x16x32_bf16 a[212:215], v[68:71], v[40:43], a[212:215]
    v_mfma_f32_16x16x32_bf16 a[216:219], v[72:75], v[40:43], a[216:219]
    v_mfma_f32_16x16x32_bf16 a[220:223], v[76:79], v[40:43], a[220:223]
    v_mfma_f32_16x16x32_bf16 a[224:227], v[48:51], v[44:47], a[224:227]
    v_mfma_f32_16x16x32_bf16 a[228:231], v[52:55], v[44:47], a[228:231]
    v_mfma_f32_16x16x32_bf16 a[232:235], v[56:59], v[44:47], a[232:235]
    v_mfma_f32_16x16x32_bf16 a[236:239], v[60:63], v[44:47], a[236:239]
    v_mfma_f32_16x16x32_bf16 a[240:243], v[64:67], v[44:47], a[240:243]
    v_mfma_f32_16x16x32_bf16 a[244:247], v[68:71], v[44:47], a[244:247]
    v_mfma_f32_16x16x32_bf16 a[248:251], v[72:75], v[44:47], a[248:251]
    v_mfma_f32_16x16x32_bf16 a[252:255], v[76:79], v[44:47], a[252:255]
    s_waitcnt vmcnt(16) lgkmcnt(0)
    s_barrier
    v_mfma_f32_16x16x32_bf16 a[0:3], v[112:115], v[80:83], a[0:3]
    ds_read_b128 v[16:19], v7 offset:0
    v_mfma_f32_16x16x32_bf16 a[4:7], v[116:119], v[80:83], a[4:7]
    ds_read_b128 v[20:23], v7 offset:1024
    v_mfma_f32_16x16x32_bf16 a[8:11], v[120:123], v[80:83], a[8:11]
    v_mfma_f32_16x16x32_bf16 a[12:15], v[124:127], v[80:83], a[12:15]
    ds_read_b128 v[24:27], v7 offset:2048
    v_mfma_f32_16x16x32_bf16 a[16:19], v[128:131], v[80:83], a[16:19]
    v_mfma_f32_16x16x32_bf16 a[20:23], v[132:135], v[80:83], a[20:23]
    ds_read_b128 v[28:31], v7 offset:3072
    v_mfma_f32_16x16x32_bf16 a[24:27], v[136:139], v[80:83], a[24:27]
    ds_read_b128 v[32:35], v7 offset:4096
    v_mfma_f32_16x16x32_bf16 a[28:31], v[140:143], v[80:83], a[28:31]
    v_mfma_f32_16x16x32_bf16 a[32:35], v[112:115], v[84:87], a[32:35]
    ds_read_b128 v[36:39], v7 offset:5120
    v_mfma_f32_16x16x32_bf16 a[36:39], v[116:119], v[84:87], a[36:39]
    v_mfma_f32_16x16x32_bf16 a[40:43], v[120:123], v[84:87], a[40:43]
    ds_read_b128 v[40:43], v7 offset:6144
    v_mfma_f32_16x16x32_bf16 a[44:47], v[124:127], v[84:87], a[44:47]
    ds_read_b128 v[44:47], v7 offset:7168
    v_mfma_f32_16x16x32_bf16 a[48:51], v[128:131], v[84:87], a[48:51]
    v_mfma_f32_16x16x32_bf16 a[52:55], v[132:135], v[84:87], a[52:55]
    ds_read_b128 v[48:51], v8 offset:0
    v_mfma_f32_16x16x32_bf16 a[56:59], v[136:139], v[84:87], a[56:59]
    v_mfma_f32_16x16x32_bf16 a[60:63], v[140:143], v[84:87], a[60:63]
    ds_read_b128 v[52:55], v8 offset:1024
    v_mfma_f32_16x16x32_bf16 a[64:67], v[112:115], v[88:91], a[64:67]
    v_mfma_f32_16x16x32_bf16 a[68:71], v[116:119], v[88:91], a[68:71]
    ds_read_b128 v[56:59], v8 offset:2048
    v_mfma_f32_16x16x32_bf16 a[72:75], v[120:123], v[88:91], a[72:75]
    ds_read_b128 v[60:63], v8 offset:3072
    v_mfma_f32_16x16x32_bf16 a[76:79], v[124:127], v[88:91], a[76:79]
    v_mfma_f32_16x16x32_bf16 a[80:83], v[128:131], v[88:91], a[80:83]
    ds_read_b128 v[64:67], v8 offset:4096
    v_mfma_f32_16x16x32_bf16 a[84:87], v[132:135], v[88:91], a[84:87]
    v_mfma_f32_16x16x32_bf16 a[88:91], v[136:139], v[88:91], a[88:91]
    ds_read_b128 v[68:71], v8 offset:5120
    v_mfma_f32_16x16x32_bf16 a[92:95], v[140:143], v[88:91], a[92:95]
    ds_read_b128 v[72:75], v8 offset:6144
    v_mfma_f32_16x16x32_bf16 a[96:99], v[112:115], v[92:95], a[96:99]
    v_mfma_f32_16x16x32_bf16 a[100:103], v[116:119], v[92:95], a[100:103]
    ds_read_b128 v[76:79], v8 offset:7168
    v_mfma_f32_16x16x32_bf16 a[104:107], v[120:123], v[92:95], a[104:107]
    v_mfma_f32_16x16x32_bf16 a[108:111], v[124:127], v[92:95], a[108:111]
    s_add_u32 m0, s38, 32768
    s_nop 0
    buffer_load_dwordx4 v4, s[4:7], s40 offen  lds
    v_mfma_f32_16x16x32_bf16 a[112:115], v[128:131], v[92:95], a[112:115]
    v_mfma_f32_16x16x32_bf16 a[116:119], v[132:135], v[92:95], a[116:119]
    s_add_u32 m0, s38, 33792
    s_nop 0
    buffer_load_dwordx4 v4, s[4:7], s41 offen  lds
    v_mfma_f32_16x16x32_bf16 a[120:123], v[136:139], v[92:95], a[120:123]
    s_add_u32 m0, s38, 34816
    s_nop 0
    buffer_load_dwordx4 v4, s[4:7], s42 offen  lds
    v_mfma_f32_16x16x32_bf16 a[124:127], v[140:143], v[92:95], a[124:127]
    v_mfma_f32_16x16x32_bf16 a[128:131], v[112:115], v[96:99], a[128:131]
    s_add_u32 m0, s38, 35840
    s_nop 0
    buffer_load_dwordx4 v4, s[4:7], s43 offen  lds
    v_mfma_f32_16x16x32_bf16 a[132:135], v[116:119], v[96:99], a[132:135]
    v_mfma_f32_16x16x32_bf16 a[136:139], v[120:123], v[96:99], a[136:139]
    s_add_u32 m0, s38, 36864
    s_nop 0
    buffer_load_dwordx4 v4, s[4:7], s44 offen  lds
    v_mfma_f32_16x16x32_bf16 a[140:143], v[124:127], v[96:99], a[140:143]
    s_add_u32 m0, s38, 37888
    s_nop 0
    buffer_load_dwordx4 v4, s[4:7], s45 offen  lds
    v_mfma_f32_16x16x32_bf16 a[144:147], v[128:131], v[96:99], a[144:147]
    v_mfma_f32_16x16x32_bf16 a[148:151], v[132:135], v[96:99], a[148:151]
    s_add_u32 m0, s38, 38912
    s_nop 0
    buffer_load_dwordx4 v4, s[4:7], s46 offen  lds
    v_mfma_f32_16x16x32_bf16 a[152:155], v[136:139], v[96:99], a[152:155]
    v_mfma_f32_16x16x32_bf16 a[156:159], v[140:143], v[96:99], a[156:159]
    s_add_u32 m0, s38, 39936
    s_nop 0
    buffer_load_dwordx4 v4, s[4:7], s47 offen  lds
    v_mfma_f32_16x16x32_bf16 a[160:163], v[112:115], v[100:103], a[160:163]
    v_add_u32 v4, 1024, v4
    v_mfma_f32_16x16x32_bf16 a[164:167], v[116:119], v[100:103], a[164:167]
    v_mfma_f32_16x16x32_bf16 a[168:171], v[120:123], v[100:103], a[168:171]
    v_mfma_f32_16x16x32_bf16 a[172:175], v[124:127], v[100:103], a[172:175]
    v_mfma_f32_16x16x32_bf16 a[176:179], v[128:131], v[100:103], a[176:179]
    v_mfma_f32_16x16x32_bf16 a[180:183], v[132:135], v[100:103], a[180:183]
    v_mfma_f32_16x16x32_bf16 a[184:187], v[136:139], v[100:103], a[184:187]
    v_mfma_f32_16x16x32_bf16 a[188:191], v[140:143], v[100:103], a[188:191]
    v_mfma_f32_16x16x32_bf16 a[192:195], v[112:115], v[104:107], a[192:195]
    v_mfma_f32_16x16x32_bf16 a[196:199], v[116:119], v[104:107], a[196:199]
    v_mfma_f32_16x16x32_bf16 a[200:203], v[120:123], v[104:107], a[200:203]
    v_mfma_f32_16x16x32_bf16 a[204:207], v[124:127], v[104:107], a[204:207]
    v_mfma_f32_16x16x32_bf16 a[208:211], v[128:131], v[104:107], a[208:211]
    v_mfma_f32_16x16x32_bf16 a[212:215], v[132:135], v[104:107], a[212:215]
    v_mfma_f32_16x16x32_bf16 a[216:219], v[136:139], v[104:107], a[216:219]
    v_mfma_f32_16x16x32_bf16 a[220:223], v[140:143], v[104:107], a[220:223]
    v_mfma_f32_16x16x32_bf16 a[224:227], v[112:115], v[108:111], a[224:227]
    v_mfma_f32_16x16x32_bf16 a[228:231], v[116:119], v[108:111], a[228:231]
    v_mfma_f32_16x16x32_bf16 a[232:235], v[120:123], v[108:111], a[232:235]
    v_mfma_f32_16x16x32_bf16 a[236:239], v[124:127], v[108:111], a[236:239]
    v_mfma_f32_16x16x32_bf16 a[240:243], v[128:131], v[108:111], a[240:243]
    v_mfma_f32_16x16x32_bf16 a[244:247], v[132:135], v[108:111], a[244:247]
    v_mfma_f32_16x16x32_bf16 a[248:251], v[136:139], v[108:111], a[248:251]
    v_mfma_f32_16x16x32_bf16 a[252:255], v[140:143], v[108:111], a[252:255]
    s_sub_u32 s35, s35, 2
    s_cmp_eq_u32 s35, 0
    s_cbranch_scc1 kv_k_end
    s_waitcnt vmcnt(16) lgkmcnt(0)
    s_barrier
    v_mfma_f32_16x16x32_bf16 a[0:3], v[48:51], v[16:19], a[0:3]
    ds_read_b128 v[80:83], v7 offset:32768
    v_mfma_f32_16x16x32_bf16 a[4:7], v[52:55], v[16:19], a[4:7]
    ds_read_b128 v[84:87], v7 offset:33792
    v_mfma_f32_16x16x32_bf16 a[8:11], v[56:59], v[16:19], a[8:11]
    v_mfma_f32_16x16x32_bf16 a[12:15], v[60:63], v[16:19], a[12:15]
    ds_read_b128 v[88:91], v7 offset:34816
    v_mfma_f32_16x16x32_bf16 a[16:19], v[64:67], v[16:19], a[16:19]
    v_mfma_f32_16x16x32_bf16 a[20:23], v[68:71], v[16:19], a[20:23]
    ds_read_b128 v[92:95], v7 offset:35840
    v_mfma_f32_16x16x32_bf16 a[24:27], v[72:75], v[16:19], a[24:27]
    ds_read_b128 v[96:99], v7 offset:36864
    v_mfma_f32_16x16x32_bf16 a[28:31], v[76:79], v[16:19], a[28:31]
    v_mfma_f32_16x16x32_bf16 a[32:35], v[48:51], v[20:23], a[32:35]
    ds_read_b128 v[100:103], v7 offset:37888
    v_mfma_f32_16x16x32_bf16 a[36:39], v[52:55], v[20:23], a[36:39]
    v_mfma_f32_16x16x32_bf16 a[40:43], v[56:59], v[20:23], a[40:43]
    ds_read_b128 v[104:107], v7 offset:38912
    v_mfma_f32_16x16x32_bf16 a[44:47], v[60:63], v[20:23], a[44:47]
    ds_read_b128 v[108:111], v7 offset:39936
    v_mfma_f32_16x16x32_bf16 a[48:51], v[64:67], v[20:23], a[48:51]
    v_mfma_f32_16x16x32_bf16 a[52:55], v[68:71], v[20:23], a[52:55]
    ds_read_b128 v[112:115], v8 offset:32768
    v_mfma_f32_16x16x32_bf16 a[56:59], v[72:75], v[20:23], a[56:59]
    v_mfma_f32_16x16x32_bf16 a[60:63], v[76:79], v[20:23], a[60:63]
    ds_read_b128 v[116:119], v8 offset:33792
    v_mfma_f32_16x16x32_bf16 a[64:67], v[48:51], v[24:27], a[64:67]
    v_mfma_f32_16x16x32_bf16 a[68:71], v[52:55], v[24:27], a[68:71]
    ds_read_b128 v[120:123], v8 offset:34816
    v_mfma_f32_16x16x32_bf16 a[72:75], v[56:59], v[24:27], a[72:75]
    ds_read_b128 v[124:127], v8 offset:35840
    v_mfma_f32_16x16x32_bf16 a[76:79], v[60:63], v[24:27], a[76:79]
    v_mfma_f32_16x16x32_bf16 a[80:83], v[64:67], v[24:27], a[80:83]
    ds_read_b128 v[128:131], v8 offset:36864
    v_mfma_f32_16x16x32_bf16 a[84:87], v[68:71], v[24:27], a[84:87]
    v_mfma_f32_16x16x32_bf16 a[88:91], v[72:75], v[24:27], a[88:91]
    ds_read_b128 v[132:135], v8 offset:37888
    v_mfma_f32_16x16x32_bf16 a[92:95], v[76:79], v[24:27], a[92:95]
    ds_read_b128 v[136:139], v8 offset:38912
    v_mfma_f32_16x16x32_bf16 a[96:99], v[48:51], v[28:31], a[96:99]
    v_mfma_f32_16x16x32_bf16 a[100:103], v[52:55], v[28:31], a[100:103]
    ds_read_b128 v[140:143], v8 offset:39936
    v_mfma_f32_16x16x32_bf16 a[104:107], v[56:59], v[28:31], a[104:107]
    v_mfma_f32_16x16x32_bf16 a[108:111], v[60:63], v[28:31], a[108:111]
    s_add_u32 m0, s38, 65536
    s_nop 0
    buffer_load_dwordx4 v4, s[4:7], s40 offen  lds
    v_mfma_f32_16x16x32_bf16 a[112:115], v[64:67], v[28:31], a[112:115]
    v_mfma_f32_16x16x32_bf16 a[116:119], v[68:71], v[28:31], a[116:119]
    s_add_u32 m0, s38, 66560
    s_nop 0
    buffer_load_dwordx4 v4, s[4:7], s41 offen  lds
    v_mfma_f32_16x16x32_bf16 a[120:123], v[72:75], v[28:31], a[120:123]
    s_add_u32 m0, s38, 67584
    s_nop 0
    buffer_load_dwordx4 v4, s[4:7], s42 offen  lds
    v_mfma_f32_16x16x32_bf16 a[124:127], v[76:79], v[28:31], a[124:127]
    v_mfma_f32_16x16x32_bf16 a[128:131], v[48:51], v[32:35], a[128:131]
    s_add_u32 m0, s38, 68608
    s_nop 0
    buffer_load_dwordx4 v4, s[4:7], s43 offen  lds
    v_mfma_f32_16x16x32_bf16 a[132:135], v[52:55], v[32:35], a[132:135]
    v_mfma_f32_16x16x32_bf16 a[136:139], v[56:59], v[32:35], a[136:139]
    s_add_u32 m0, s38, 69632
    s_nop 0
    buffer_load_dwordx4 v4, s[4:7], s44 offen  lds
    v_mfma_f32_16x16x32_bf16 a[140:143], v[60:63], v[32:35], a[140:143]
    s_add_u32 m0, s38, 70656
    s_nop 0
    buffer_load_dwordx4 v4, s[4:7], s45 offen  lds
    v_mfma_f32_16x16x32_bf16 a[144:147], v[64:67], v[32:35], a[144:147]
    v_mfma_f32_16x16x32_bf16 a[148:151], v[68:71], v[32:35], a[148:151]
    s_add_u32 m0, s38, 71680
    s_nop 0
    buffer_load_dwordx4 v4, s[4:7], s46 offen  lds
    v_mfma_f32_16x16x32_bf16 a[152:155], v[72:75], v[32:35], a[152:155]
    v_mfma_f32_16x16x32_bf16 a[156:159], v[76:79], v[32:35], a[156:159]
    s_add_u32 m0, s38, 72704
    s_nop 0
    buffer_load_dwordx4 v4, s[4:7], s47 offen  lds
    v_mfma_f32_16x16x32_bf16 a[160:163], v[48:51], v[36:39], a[160:163]
    v_add_u32 v4, 1024, v4
    v_mfma_f32_16x16x32_bf16 a[164:167], v[52:55], v[36:39], a[164:167]
    v_mfma_f32_16x16x32_bf16 a[168:171], v[56:59], v[36:39], a[168:171]
    v_mfma_f32_16x16x32_bf16 a[172:175], v[60:63], v[36:39], a[172:175]
    v_mfma_f32_16x16x32_bf16 a[176:179], v[64:67], v[36:39], a[176:179]
    v_mfma_f32_16x16x32_bf16 a[180:183], v[68:71], v[36:39], a[180:183]
    v_mfma_f32_16x16x32_bf16 a[184:187], v[72:75], v[36:39], a[184:187]
    v_mfma_f32_16x16x32_bf16 a[188:191], v[76:79], v[36:39], a[188:191]
    v_mfma_f32_16x16x32_bf16 a[192:195], v[48:51], v[40:43], a[192:195]
    v_mfma_f32_16x16x32_bf16 a[196:199], v[52:55], v[40:43], a[196:199]
    v_mfma_f32_16x16x32_bf16 a[200:203], v[56:59], v[40:43], a[200:203]
    v_mfma_f32_16x16x32_bf16 a[204:207], v[60:63], v[40:43], a[204:207]
    v_mfma_f32_16x16x32_bf16 a[208:211], v[64:67], v[40:43], a[208:211]
    v_mfma_f32_16x16x32_bf16 a[212:215], v[68:71], v[40:43], a[212:215]
    v_mfma_f32_16x16x32_bf16 a[216:219], v[72:75], v[40:43], a[216:219]
    v_mfma_f32_16x16x32_bf16 a[220:223], v[76:79], v[40:43], a[220:223]
    v_mfma_f32_16x16x32_bf16 a[224:227], v[48:51], v[44:47], a[224:227]
    v_mfma_f32_16x16x32_bf16 a[228:231], v[52:55], v[44:47], a[228:231]
    v_mfma_f32_16x16x32_bf16 a[232:235], v[56:59], v[44:47], a[232:235]
    v_mfma_f32_16x16x32_bf16 a[236:239], v[60:63], v[44:47], a[236:239]
    v_mfma_f32_16x16x32_bf16 a[240:243], v[64:67], v[44:47], a[240:243]
    v_mfma_f32_16x16x32_bf16 a[244:247], v[68:71], v[44:47], a[244:247]
    v_mfma_f32_16x16x32_bf16 a[248:251], v[72:75], v[44:47], a[248:251]
    v_mfma_f32_16x16x32_bf16 a[252:255], v[76:79], v[44:47], a[252:255]
    s_waitcnt vmcnt(16) lgkmcnt(0)
    s_barrier
    v_mfma_f32_16x16x32_bf16 a[0:3], v[112:115], v[80:83], a[0:3]
    ds_read_b128 v[16:19], v5 offset:0
    v_mfma_f32_16x16x32_bf16 a[4:7], v[116:119], v[80:83], a[4:7]
    ds_read_b128 v[20:23], v5 offset:1024
    v_mfma_f32_16x16x32_bf16 a[8:11], v[120:123], v[80:83], a[8:11]
    v_mfma_f32_16x16x32_bf16 a[12:15], v[124:127], v[80:83], a[12:15]
    ds_read_b128 v[24:27], v5 offset:2048
    v_mfma_f32_16x16x32_bf16 a[16:19], v[128:131], v[80:83], a[16:19]
    v_mfma_f32_16x16x32_bf16 a[20:23], v[132:135], v[80:83], a[20:23]
    ds_read_b128 v[28:31], v5 offset:3072
    v_mfma_f32_16x16x32_bf16 a[24:27], v[136:139], v[80:83], a[24:27]
    ds_read_b128 v[32:35], v5 offset:4096
    v_mfma_f32_16x16x32_bf16 a[28:31], v[140:143], v[80:83], a[28:31]
    v_mfma_f32_16x16x32_bf16 a[32:35], v[112:115], v[84:87], a[32:35]
    ds_read_b128 v[36:39], v5 offset:5120
    v_mfma_f32_16x16x32_bf16 a[36:39], v[116:119], v[84:87], a[36:39]
    v_mfma_f32_16x16x32_bf16 a[40:43], v[120:123], v[84:87], a[40:43]
    ds_read_b128 v[40:43], v5 offset:6144
    v_mfma_f32_16x16x32_bf16 a[44:47], v[124:127], v[84:87], a[44:47]
    ds_read_b128 v[44:47], v5 offset:7168
    v_mfma_f32_16x16x32_bf16 a[48:51], v[128:131], v[84:87], a[48:51]
    v_mfma_f32_16x16x32_bf16 a[52:55], v[132:135], v[84:87], a[52:55]
    ds_read_b128 v[48:51], v6 offset:0
    v_mfma_f32_16x16x32_bf16 a[56:59], v[136:139], v[84:87], a[56:59]
    v_mfma_f32_16x16x32_bf16 a[60:63], v[140:143], v[84:87], a[60:63]
    ds_read_b128 v[52:55], v6 offset:1024
    v_mfma_f32_16x16x32_bf16 a[64:67], v[112:115], v[88:91], a[64:67]
    v_mfma_f32_16x16x32_bf16 a[68:71], v[116:119], v[88:91], a[68:71]
    ds_read_b128 v[56:59], v6 offset:2048
    v_mfma_f32_16x16x32_bf16 a[72:75], v[120:123], v[88:91], a[72:75]
    ds_read_b128 v[60:63], v6 offset:3072
    v_mfma_f32_16x16x32_bf16 a[76:79], v[124:127], v[88:91], a[76:79]
    v_mfma_f32_16x16x32_bf16 a[80:83], v[128:131], v[88:91], a[80:83]
    ds_read_b128 v[64:67], v6 offset:4096
    v_mfma_f32_16x16x32_bf16 a[84:87], v[132:135], v[88:91], a[84:87]
    v_mfma_f32_16x16x32_bf16 a[88:91], v[136:139], v[88:91], a[88:91]
    ds_read_b128 v[68:71], v6 offset:5120
    v_mfma_f32_16x16x32_bf16 a[92:95], v[140:143], v[88:91], a[92:95]
    ds_read_b128 v[72:75], v6 offset:6144
    v_mfma_f32_16x16x32_bf16 a[96:99], v[112:115], v[92:95], a[96:99]
    v_mfma_f32_16x16x32_bf16 a[100:103], v[116:119], v[92:95], a[100:103]
    ds_read_b128 v[76:79], v6 offset:7168
    v_mfma_f32_16x16x32_bf16 a[104:107], v[120:123], v[92:95], a[104:107]
    v_mfma_f32_16x16x32_bf16 a[108:111], v[124:127], v[92:95], a[108:111]
    s_add_u32 m0, s38, 98304
    s_nop 0
    buffer_load_dwordx4 v4, s[4:7], s40 offen  lds
    v_mfma_f32_16x16x32_bf16 a[112:115], v[128:131], v[92:95], a[112:115]
    v_mfma_f32_16x16x32_bf16 a[116:119], v[132:135], v[92:95], a[116:119]
    s_add_u32 m0, s38, 99328
    s_nop 0
    buffer_load_dwordx4 v4, s[4:7], s41 offen  lds
    v_mfma_f32_16x16x32_bf16 a[120:123], v[136:139], v[92:95], a[120:123]
    s_add_u32 m0, s38, 100352
    s_nop 0
    buffer_load_dwordx4 v4, s[4:7], s42 offen  lds
    v_mfma_f32_16x16x32_bf16 a[124:127], v[140:143], v[92:95], a[124:127]
    v_mfma_f32_16x16x32_bf16 a[128:131], v[112:115], v[96:99], a[128:131]
    s_add_u32 m0, s38, 101376
    s_nop 0
    buffer_load_dwordx4 v4, s[4:7], s43 offen  lds
    v_mfma_f32_16x16x32_bf16 a[132:135], v[116:119], v[96:99], a[132:135]
    v_mfma_f32_16x16x32_bf16 a[136:139], v[120:123], v[96:99], a[136:139]
    s_add_u32 m0, s38, 102400
    s_nop 0
    buffer_load_dwordx4 v4, s[4:7], s44 offen  lds
    v_mfma_f32_16x16x32_bf16 a[140:143], v[124:127], v[96:99], a[140:143]
    s_add_u32 m0, s38, 103424
    s_nop 0
    buffer_load_dwordx4 v4, s[4:7], s45 offen  lds
    v_mfma_f32_16x16x32_bf16 a[144:147], v[128:131], v[96:99], a[144:147]
    v_mfma_f32_16x16x32_bf16 a[148:151], v[132:135], v[96:99], a[148:151]
    s_add_u32 m0, s38, 104448
    s_nop 0
    buffer_load_dwordx4 v4, s[4:7], s46 offen  lds
    v_mfma_f32_16x16x32_bf16 a[152:155], v[136:139], v[96:99], a[152:155]
    v_mfma_f32_16x16x32_bf16 a[156:159], v[140:143], v[96:99], a[156:159]
    s_add_u32 m0, s38, 105472
    s_nop 0
    buffer_load_dwordx4 v4, s[4:7], s47 offen  lds
    v_mfma_f32_16x16x32_bf16 a[160:163], v[112:115], v[100:103], a[160:163]
    v_add_u32 v4, 1024, v4
    v_mfma_f32_16x16x32_bf16 a[164:167], v[116:119], v[100:103], a[164:167]
    v_mfma_f32_16x16x32_bf16 a[168:171], v[120:123], v[100:103], a[168:171]
    v_mfma_f32_16x16x32_bf16 a[172:175], v[124:127], v[100:103], a[172:175]
    v_mfma_f32_16x16x32_bf16 a[176:179], v[128:131], v[100:103], a[176:179]
    v_mfma_f32_16x16x32_bf16 a[180:183], v[132:135], v[100:103], a[180:183]
    v_mfma_f32_16x16x32_bf16 a[184:187], v[136:139], v[100:103], a[184:187]
    v_mfma_f32_16x16x32_bf16 a[188:191], v[140:143], v[100:103], a[188:191]
    v_mfma_f32_16x16x32_bf16 a[192:195], v[112:115], v[104:107], a[192:195]
    v_mfma_f32_16x16x32_bf16 a[196:199], v[116:119], v[104:107], a[196:199]
    v_mfma_f32_16x16x32_bf16 a[200:203], v[120:123], v[104:107], a[200:203]
    v_mfma_f32_16x16x32_bf16 a[204:207], v[124:127], v[104:107], a[204:207]
    v_mfma_f32_16x16x32_bf16 a[208:211], v[128:131], v[104:107], a[208:211]
    v_mfma_f32_16x16x32_bf16 a[212:215], v[132:135], v[104:107], a[212:215]
    v_mfma_f32_16x16x32_bf16 a[216:219], v[136:139], v[104:107], a[216:219]
    v_mfma_f32_16x16x32_bf16 a[220:223], v[140:143], v[104:107], a[220:223]
    v_mfma_f32_16x16x32_bf16 a[224:227], v[112:115], v[108:111], a[224:227]
    v_mfma_f32_16x16x32_bf16 a[228:231], v[116:119], v[108:111], a[228:231]
    v_mfma_f32_16x16x32_bf16 a[232:235], v[120:123], v[108:111], a[232:235]
    v_mfma_f32_16x16x32_bf16 a[236:239], v[124:127], v[108:111], a[236:239]
    v_mfma_f32_16x16x32_bf16 a[240:243], v[128:131], v[108:111], a[240:243]
    v_mfma_f32_16x16x32_bf16 a[244:247], v[132:135], v[108:111], a[244:247]
    v_mfma_f32_16x16x32_bf16 a[248:251], v[136:139], v[108:111], a[248:251]
    v_mfma_f32_16x16x32_bf16 a[252:255], v[140:143], v[108:111], a[252:255]
    s_sub_u32 s35, s35, 2
    s_cmp_eq_u32 s35, 0
    s_cbranch_scc0 kv_k_loop
kv_k_end:
    s_waitcnt vmcnt(0) lgkmcnt(0)
    s_barrier
    s_nop 7
    s_lshl_b32 s31, s20, 12
    s_add_u32 s30, s30, s31
    s_add_u32 s30, s30, 50331648
    v_accvgpr_read_b32 v16, a0
    v_accvgpr_read_b32 v17, a1
    v_accvgpr_read_b32 v18, a2
    v_accvgpr_read_b32 v19, a3
    v_accvgpr_read_b32 v20, a4
    v_accvgpr_read_b32 v21, a5
    v_accvgpr_read_b32 v22, a6
    v_accvgpr_read_b32 v23, a7
    v_cvt_pk_bf16_f32 v24, v16, v17
    v_cvt_pk_bf16_f32 v25, v18, v19
    v_cvt_pk_bf16_f32 v26, v20, v21
    v_cvt_pk_bf16_f32 v27, v22, v23
    buffer_store_dwordx4 v[24:27], v1, s[4:7], s30 offen offset:0 sc1
    v_accvgpr_read_b32 v28, a8
    v_accvgpr_read_b32 v29, a9
    v_accvgpr_read_b32 v30, a10
    v_accvgpr_read_b32 v31, a11
    v_accvgpr_read_b32 v32, a12
    v_accvgpr_read_b32 v33, a13
    v_accvgpr_read_b32 v34, a14
    v_accvgpr_read_b32 v35, a15
    v_cvt_pk_bf16_f32 v36, v28, v29
    v_cvt_pk_bf16_f32 v37, v30, v31
    v_cvt_pk_bf16_f32 v38, v32, v33
    v_cvt_pk_bf16_f32 v39, v34, v35
    buffer_store_dwordx4 v[36:39], v1, s[4:7], s30 offen offset:1024 sc1
    v_accvgpr_read_b32 v40, a16
    v_accvgpr_read_b32 v41, a17
    v_accvgpr_read_b32 v42, a18
    v_accvgpr_read_b32 v43, a19
    v_accvgpr_read_b32 v44, a20
    v_accvgpr_read_b32 v45, a21
    v_accvgpr_read_b32 v46, a22
    v_accvgpr_read_b32 v47, a23
    v_cvt_pk_bf16_f32 v48, v40, v41
    v_cvt_pk_bf16_f32 v49, v42, v43
    v_cvt_pk_bf16_f32 v50, v44, v45
    v_cvt_pk_bf16_f32 v51, v46, v47
    buffer_store_dwordx4 v[48:51], v1, s[4:7], s30 offen offset:2048 sc1
    v_accvgpr_read_b32 v52, a24
    v_accvgpr_read_b32 v53, a25
    v_accvgpr_read_b32 v54, a26
    v_accvgpr_read_b32 v55, a27
    v_accvgpr_read_b32 v56, a28
    v_accvgpr_read_b32 v57, a29
    v_accvgpr_read_b32 v58, a30
    v_accvgpr_read_b32 v59, a31
    v_cvt_pk_bf16_f32 v60, v52, v53
    v_cvt_pk_bf16_f32 v61, v54, v55
    v_cvt_pk_bf16_f32 v62, v56, v57
    v_cvt_pk_bf16_f32 v63, v58, v59
    buffer_store_dwordx4 v[60:63], v1, s[4:7], s30 offen offset:3072 sc1
    s_add_u32 s30, s30, 0x20000
    v_accvgpr_read_b32 v16, a32
    v_accvgpr_read_b32 v17, a33
    v_accvgpr_read_b32 v18, a34
    v_accvgpr_read_b32 v19, a35
    v_accvgpr_read_b32 v20, a36
    v_accvgpr_read_b32 v21, a37
    v_accvgpr_read_b32 v22, a38
    v_accvgpr_read_b32 v23, a39
    v_cvt_pk_bf16_f32 v24, v16, v17
    v_cvt_pk_bf16_f32 v25, v18, v19
    v_cvt_pk_bf16_f32 v26, v20, v21
    v_cvt_pk_bf16_f32 v27, v22, v23
    buffer_store_dwordx4 v[24:27], v1, s[4:7], s30 offen offset:0 sc1
    v_accvgpr_read_b32 v28, a40
    v_accvgpr_read_b32 v29, a41
    v_accvgpr_read_b32 v30, a42
    v_accvgpr_read_b32 v31, a43
    v_accvgpr_read_b32 v32, a44
    v_accvgpr_read_b32 v33, a45
    v_accvgpr_read_b32 v34, a46
    v_accvgpr_read_b32 v35, a47
    v_cvt_pk_bf16_f32 v36, v28, v29
    v_cvt_pk_bf16_f32 v37, v30, v31
    v_cvt_pk_bf16_f32 v38, v32, v33
    v_cvt_pk_bf16_f32 v39, v34, v35
    buffer_store_dwordx4 v[36:39], v1, s[4:7], s30 offen offset:1024 sc1
    v_accvgpr_read_b32 v40, a48
    v_accvgpr_read_b32 v41, a49
    v_accvgpr_read_b32 v42, a50
    v_accvgpr_read_b32 v43, a51
    v_accvgpr_read_b32 v44, a52
    v_accvgpr_read_b32 v45, a53
    v_accvgpr_read_b32 v46, a54
    v_accvgpr_read_b32 v47, a55
    v_cvt_pk_bf16_f32 v48, v40, v41
    v_cvt_pk_bf16_f32 v49, v42, v43
    v_cvt_pk_bf16_f32 v50, v44, v45
    v_cvt_pk_bf16_f32 v51, v46, v47
    buffer_store_dwordx4 v[48:51], v1, s[4:7], s30 offen offset:2048 sc1
    v_accvgpr_read_b32 v52, a56
    v_accvgpr_read_b32 v53, a57
    v_accvgpr_read_b32 v54, a58
    v_accvgpr_read_b32 v55, a59
    v_accvgpr_read_b32 v56, a60
    v_accvgpr_read_b32 v57, a61
    v_accvgpr_read_b32 v58, a62
    v_accvgpr_read_b32 v59, a63
    v_cvt_pk_bf16_f32 v60, v52, v53
    v_cvt_pk_bf16_f32 v61, v54, v55
    v_cvt_pk_bf16_f32 v62, v56, v57
    v_cvt_pk_bf16_f32 v63, v58, v59
    buffer_store_dwordx4 v[60:63], v1, s[4:7], s30 offen offset:3072 sc1
    s_add_u32 s30, s30, 0x20000
    v_accvgpr_read_b32 v16, a64
    v_accvgpr_read_b32 v17, a65
    v_accvgpr_read_b32 v18, a66
    v_accvgpr_read_b32 v19, a67
    v_accvgpr_read_b32 v20, a68
    v_accvgpr_read_b32 v21, a69
    v_accvgpr_read_b32 v22, a70
    v_accvgpr_read_b32 v23, a71
    v_cvt_pk_bf16_f32 v24, v16, v17
    v_cvt_pk_bf16_f32 v25, v18, v19
    v_cvt_pk_bf16_f32 v26, v20, v21
    v_cvt_pk_bf16_f32 v27, v22, v23
    buffer_store_dwordx4 v[24:27], v1, s[4:7], s30 offen offset:0 sc1
    v_accvgpr_read_b32 v28, a72
    v_accvgpr_read_b32 v29, a73
    v_accvgpr_read_b32 v30, a74
    v_accvgpr_read_b32 v31, a75
    v_accvgpr_read_b32 v32, a76
    v_accvgpr_read_b32 v33, a77
    v_accvgpr_read_b32 v34, a78
    v_accvgpr_read_b32 v35, a79
    v_cvt_pk_bf16_f32 v36, v28, v29
    v_cvt_pk_bf16_f32 v37, v30, v31
    v_cvt_pk_bf16_f32 v38, v32, v33
    v_cvt_pk_bf16_f32 v39, v34, v35
    buffer_store_dwordx4 v[36:39], v1, s[4:7], s30 offen offset:1024 sc1
    v_accvgpr_read_b32 v40, a80
    v_accvgpr_read_b32 v41, a81
    v_accvgpr_read_b32 v42, a82
    v_accvgpr_read_b32 v43, a83
    v_accvgpr_read_b32 v44, a84
    v_accvgpr_read_b32 v45, a85
    v_accvgpr_read_b32 v46, a86
    v_accvgpr_read_b32 v47, a87
    v_cvt_pk_bf16_f32 v48, v40, v41
    v_cvt_pk_bf16_f32 v49, v42, v43
    v_cvt_pk_bf16_f32 v50, v44, v45
    v_cvt_pk_bf16_f32 v51, v46, v47
    buffer_store_dwordx4 v[48:51], v1, s[4:7], s30 offen offset:2048 sc1
    v_accvgpr_read_b32 v52, a88
    v_accvgpr_read_b32 v53, a89
    v_accvgpr_read_b32 v54, a90
    v_accvgpr_read_b32 v55, a91
    v_accvgpr_read_b32 v56, a92
    v_accvgpr_read_b32 v57, a93
    v_accvgpr_read_b32 v58, a94
    v_accvgpr_read_b32 v59, a95
    v_cvt_pk_bf16_f32 v60, v52, v53
    v_cvt_pk_bf16_f32 v61, v54, v55
    v_cvt_pk_bf16_f32 v62, v56, v57
    v_cvt_pk_bf16_f32 v63, v58, v59
    buffer_store_dwordx4 v[60:63], v1, s[4:7], s30 offen offset:3072 sc1
    s_add_u32 s30, s30, 0x20000
    v_accvgpr_read_b32 v16, a96
    v_accvgpr_read_b32 v17, a97
    v_accvgpr_read_b32 v18, a98
    v_accvgpr_read_b32 v19, a99
    v_accvgpr_read_b32 v20, a100
    v_accvgpr_read_b32 v21, a101
    v_accvgpr_read_b32 v22, a102
    v_accvgpr_read_b32 v23, a103
    v_cvt_pk_bf16_f32 v24, v16, v17
    v_cvt_pk_bf16_f32 v25, v18, v19
    v_cvt_pk_bf16_f32 v26, v20, v21
    v_cvt_pk_bf16_f32 v27, v22, v23
    buffer_store_dwordx4 v[24:27], v1, s[4:7], s30 offen offset:0 sc1
    v_accvgpr_read_b32 v28, a104
    v_accvgpr_read_b32 v29, a105
    v_accvgpr_read_b32 v30, a106
    v_accvgpr_read_b32 v31, a107
    v_accvgpr_read_b32 v32, a108
    v_accvgpr_read_b32 v33, a109
    v_accvgpr_read_b32 v34, a110
    v_accvgpr_read_b32 v35, a111
    v_cvt_pk_bf16_f32 v36, v28, v29
    v_cvt_pk_bf16_f32 v37, v30, v31
    v_cvt_pk_bf16_f32 v38, v32, v33
    v_cvt_pk_bf16_f32 v39, v34, v35
    buffer_store_dwordx4 v[36:39], v1, s[4:7], s30 offen offset:1024 sc1
    v_accvgpr_read_b32 v40, a112
    v_accvgpr_read_b32 v41, a113
    v_accvgpr_read_b32 v42, a114
    v_accvgpr_read_b32 v43, a115
    v_accvgpr_read_b32 v44, a116
    v_accvgpr_read_b32 v45, a117
    v_accvgpr_read_b32 v46, a118
    v_accvgpr_read_b32 v47, a119
    v_cvt_pk_bf16_f32 v48, v40, v41
    v_cvt_pk_bf16_f32 v49, v42, v43
    v_cvt_pk_bf16_f32 v50, v44, v45
    v_cvt_pk_bf16_f32 v51, v46, v47
    buffer_store_dwordx4 v[48:51], v1, s[4:7], s30 offen offset:2048 sc1
    v_accvgpr_read_b32 v52, a120
    v_accvgpr_read_b32 v53, a121
    v_accvgpr_read_b32 v54, a122
    v_accvgpr_read_b32 v55, a123
    v_accvgpr_read_b32 v56, a124
    v_accvgpr_read_b32 v57, a125
    v_accvgpr_read_b32 v58, a126
    v_accvgpr_read_b32 v59, a127
    v_cvt_pk_bf16_f32 v60, v52, v53
    v_cvt_pk_bf16_f32 v61, v54, v55
    v_cvt_pk_bf16_f32 v62, v56, v57
    v_cvt_pk_bf16_f32 v63, v58, v59
    buffer_store_dwordx4 v[60:63], v1, s[4:7], s30 offen offset:3072 sc1
    s_add_u32 s30, s30, 0x20000
    v_accvgpr_read_b32 v16, a128
    v_accvgpr_read_b32 v17, a129
    v_accvgpr_read_b32 v18, a130
    v_accvgpr_read_b32 v19, a131
    v_accvgpr_read_b32 v20, a132
    v_accvgpr_read_b32 v21, a133
    v_accvgpr_read_b32 v22, a134
    v_accvgpr_read_b32 v23, a135
    v_cvt_pk_bf16_f32 v24, v16, v17
    v_cvt_pk_bf16_f32 v25, v18, v19
    v_cvt_pk_bf16_f32 v26, v20, v21
    v_cvt_pk_bf16_f32 v27, v22, v23
    buffer_store_dwordx4 v[24:27], v1, s[4:7], s30 offen offset:0 sc1
    v_accvgpr_read_b32 v28, a136
    v_accvgpr_read_b32 v29, a137
    v_accvgpr_read_b32 v30, a138
    v_accvgpr_read_b32 v31, a139
    v_accvgpr_read_b32 v32, a140
    v_accvgpr_read_b32 v33, a141
    v_accvgpr_read_b32 v34, a142
    v_accvgpr_read_b32 v35, a143
    v_cvt_pk_bf16_f32 v36, v28, v29
    v_cvt_pk_bf16_f32 v37, v30, v31
    v_cvt_pk_bf16_f32 v38, v32, v33
    v_cvt_pk_bf16_f32 v39, v34, v35
    buffer_store_dwordx4 v[36:39], v1, s[4:7], s30 offen offset:1024 sc1
    v_accvgpr_read_b32 v40, a144
    v_accvgpr_read_b32 v41, a145
    v_accvgpr_read_b32 v42, a146
    v_accvgpr_read_b32 v43, a147
    v_accvgpr_read_b32 v44, a148
    v_accvgpr_read_b32 v45, a149
    v_accvgpr_read_b32 v46, a150
    v_accvgpr_read_b32 v47, a151
    v_cvt_pk_bf16_f32 v48, v40, v41
    v_cvt_pk_bf16_f32 v49, v42, v43
    v_cvt_pk_bf16_f32 v50, v44, v45
    v_cvt_pk_bf16_f32 v51, v46, v47
    buffer_store_dwordx4 v[48:51], v1, s[4:7], s30 offen offset:2048 sc1
    v_accvgpr_read_b32 v52, a152
    v_accvgpr_read_b32 v53, a153
    v_accvgpr_read_b32 v54, a154
    v_accvgpr_read_b32 v55, a155
    v_accvgpr_read_b32 v56, a156
    v_accvgpr_read_b32 v57, a157
    v_accvgpr_read_b32 v58, a158
    v_accvgpr_read_b32 v59, a159
    v_cvt_pk_bf16_f32 v60, v52, v53
    v_cvt_pk_bf16_f32 v61, v54, v55
    v_cvt_pk_bf16_f32 v62, v56, v57
    v_cvt_pk_bf16_f32 v63, v58, v59
    buffer_store_dwordx4 v[60:63], v1, s[4:7], s30 offen offset:3072 sc1
    s_add_u32 s30, s30, 0x20000
    v_accvgpr_read_b32 v16, a160
    v_accvgpr_read_b32 v17, a161
    v_accvgpr_read_b32 v18, a162
    v_accvgpr_read_b32 v19, a163
    v_accvgpr_read_b32 v20, a164
    v_accvgpr_read_b32 v21, a165
    v_accvgpr_read_b32 v22, a166
    v_accvgpr_read_b32 v23, a167
    v_cvt_pk_bf16_f32 v24, v16, v17
    v_cvt_pk_bf16_f32 v25, v18, v19
    v_cvt_pk_bf16_f32 v26, v20, v21
    v_cvt_pk_bf16_f32 v27, v22, v23
    buffer_store_dwordx4 v[24:27], v1, s[4:7], s30 offen offset:0 sc1
    v_accvgpr_read_b32 v28, a168
    v_accvgpr_read_b32 v29, a169
    v_accvgpr_read_b32 v30, a170
    v_accvgpr_read_b32 v31, a171
    v_accvgpr_read_b32 v32, a172
    v_accvgpr_read_b32 v33, a173
    v_accvgpr_read_b32 v34, a174
    v_accvgpr_read_b32 v35, a175
    v_cvt_pk_bf16_f32 v36, v28, v29
    v_cvt_pk_bf16_f32 v37, v30, v31
    v_cvt_pk_bf16_f32 v38, v32, v33
    v_cvt_pk_bf16_f32 v39, v34, v35
    buffer_store_dwordx4 v[36:39], v1, s[4:7], s30 offen offset:1024 sc1
    v_accvgpr_read_b32 v40, a176
    v_accvgpr_read_b32 v41, a177
    v_accvgpr_read_b32 v42, a178
    v_accvgpr_read_b32 v43, a179
    v_accvgpr_read_b32 v44, a180
    v_accvgpr_read_b32 v45, a181
    v_accvgpr_read_b32 v46, a182
    v_accvgpr_read_b32 v47, a183
    v_cvt_pk_bf16_f32 v48, v40, v41
    v_cvt_pk_bf16_f32 v49, v42, v43
    v_cvt_pk_bf16_f32 v50, v44, v45
    v_cvt_pk_bf16_f32 v51, v46, v47
    buffer_store_dwordx4 v[48:51], v1, s[4:7], s30 offen offset:2048 sc1
    v_accvgpr_read_b32 v52, a184
    v_accvgpr_read_b32 v53, a185
    v_accvgpr_read_b32 v54, a186
    v_accvgpr_read_b32 v55, a187
    v_accvgpr_read_b32 v56, a188
    v_accvgpr_read_b32 v57, a189
    v_accvgpr_read_b32 v58, a190
    v_accvgpr_read_b32 v59, a191
    v_cvt_pk_bf16_f32 v60, v52, v53
    v_cvt_pk_bf16_f32 v61, v54, v55
    v_cvt_pk_bf16_f32 v62, v56, v57
    v_cvt_pk_bf16_f32 v63, v58, v59
    buffer_store_dwordx4 v[60:63], v1, s[4:7], s30 offen offset:3072 sc1
    s_add_u32 s30, s30, 0x20000
    v_accvgpr_read_b32 v16, a192
    v_accvgpr_read_b32 v17, a193
    v_accvgpr_read_b32 v18, a194
    v_accvgpr_read_b32 v19, a195
    v_accvgpr_read_b32 v20, a196
    v_accvgpr_read_b32 v21, a197
    v_accvgpr_read_b32 v22, a198
    v_accvgpr_read_b32 v23, a199
    v_cvt_pk_bf16_f32 v24, v16, v17
    v_cvt_pk_bf16_f32 v25, v18, v19
    v_cvt_pk_bf16_f32 v26, v20, v21
    v_cvt_pk_bf16_f32 v27, v22, v23
    buffer_store_dwordx4 v[24:27], v1, s[4:7], s30 offen offset:0 sc1
    v_accvgpr_read_b32 v28, a200
    v_accvgpr_read_b32 v29, a201
    v_accvgpr_read_b32 v30, a202
    v_accvgpr_read_b32 v31, a203
    v_accvgpr_read_b32 v32, a204
    v_accvgpr_read_b32 v33, a205
    v_accvgpr_read_b32 v34, a206
    v_accvgpr_read_b32 v35, a207
    v_cvt_pk_bf16_f32 v36, v28, v29
    v_cvt_pk_bf16_f32 v37, v30, v31
    v_cvt_pk_bf16_f32 v38, v32, v33
    v_cvt_pk_bf16_f32 v39, v34, v35
    buffer_store_dwordx4 v[36:39], v1, s[4:7], s30 offen offset:1024 sc1
    v_accvgpr_read_b32 v40, a208
    v_accvgpr_read_b32 v41, a209
    v_accvgpr_read_b32 v42, a210
    v_accvgpr_read_b32 v43, a211
    v_accvgpr_read_b32 v44, a212
    v_accvgpr_read_b32 v45, a213
    v_accvgpr_read_b32 v46, a214
    v_accvgpr_read_b32 v47, a215
    v_cvt_pk_bf16_f32 v48, v40, v41
    v_cvt_pk_bf16_f32 v49, v42, v43
    v_cvt_pk_bf16_f32 v50, v44, v45
    v_cvt_pk_bf16_f32 v51, v46, v47
    buffer_store_dwordx4 v[48:51], v1, s[4:7], s30 offen offset:2048 sc1
    v_accvgpr_read_b32 v52, a216
    v_accvgpr_read_b32 v53, a217
    v_accvgpr_read_b32 v54, a218
    v_accvgpr_read_b32 v55, a219
    v_accvgpr_read_b32 v56, a220
    v_accvgpr_read_b32 v57, a221
    v_accvgpr_read_b32 v58, a222
    v_accvgpr_read_b32 v59, a223
    v_cvt_pk_bf16_f32 v60, v52, v53
    v_cvt_pk_bf16_f32 v61, v54, v55
    v_cvt_pk_bf16_f32 v62, v56, v57
    v_cvt_pk_bf16_f32 v63, v58, v59
    buffer_store_dwordx4 v[60:63], v1, s[4:7], s30 offen offset:3072 sc1
    s_add_u32 s30, s30, 0x20000
    v_accvgpr_read_b32 v16, a224
    v_accvgpr_read_b32 v17, a225
    v_accvgpr_read_b32 v18, a226
    v_accvgpr_read_b32 v19, a227
    v_accvgpr_read_b32 v20, a228
    v_accvgpr_read_b32 v21, a229
    v_accvgpr_read_b32 v22, a230
    v_accvgpr_read_b32 v23, a231
    v_cvt_pk_bf16_f32 v24, v16, v17
    v_cvt_pk_bf16_f32 v25, v18, v19
    v_cvt_pk_bf16_f32 v26, v20, v21
    v_cvt_pk_bf16_f32 v27, v22, v23
    buffer_store_dwordx4 v[24:27], v1, s[4:7], s30 offen offset:0 sc1
    v_accvgpr_read_b32 v28, a232
    v_accvgpr_read_b32 v29, a233
    v_accvgpr_read_b32 v30, a234
    v_accvgpr_read_b32 v31, a235
    v_accvgpr_read_b32 v32, a236
    v_accvgpr_read_b32 v33, a237
    v_accvgpr_read_b32 v34, a238
    v_accvgpr_read_b32 v35, a239
    v_cvt_pk_bf16_f32 v36, v28, v29
    v_cvt_pk_bf16_f32 v37, v30, v31
    v_cvt_pk_bf16_f32 v38, v32, v33
    v_cvt_pk_bf16_f32 v39, v34, v35
    buffer_store_dwordx4 v[36:39], v1, s[4:7], s30 offen offset:1024 sc1
    v_accvgpr_read_b32 v40, a240
    v_accvgpr_read_b32 v41, a241
    v_accvgpr_read_b32 v42, a242
    v_accvgpr_read_b32 v43, a243
    v_accvgpr_read_b32 v44, a244
    v_accvgpr_read_b32 v45, a245
    v_accvgpr_read_b32 v46, a246
    v_accvgpr_read_b32 v47, a247
    v_cvt_pk_bf16_f32 v48, v40, v41
    v_cvt_pk_bf16_f32 v49, v42, v43
    v_cvt_pk_bf16_f32 v50, v44, v45
    v_cvt_pk_bf16_f32 v51, v46, v47
    buffer_store_dwordx4 v[48:51], v1, s[4:7], s30 offen offset:2048 sc1
    v_accvgpr_read_b32 v52, a248
    v_accvgpr_read_b32 v53, a249
    v_accvgpr_read_b32 v54, a250
    v_accvgpr_read_b32 v55, a251
    v_accvgpr_read_b32 v56, a252
    v_accvgpr_read_b32 v57, a253
    v_accvgpr_read_b32 v58, a254
    v_accvgpr_read_b32 v59, a255
    v_cvt_pk_bf16_f32 v60, v52, v53
    v_cvt_pk_bf16_f32 v61, v54, v55
    v_cvt_pk_bf16_f32 v62, v56, v57
    v_cvt_pk_bf16_f32 v63, v58, v59
    buffer_store_dwordx4 v[60:63], v1, s[4:7], s30 offen offset:3072 sc1
    s_add_u32 s30, s30, 0x20000
    s_branch wk_cnt
kv_v:
kv_vv_loop:
    s_waitcnt vmcnt(16) lgkmcnt(0)
    s_barrier
    v_mfma_f32_16x16x32_bf16 a[0:3], v[16:19], v[48:51], a[0:3]
    ds_read_b128 v[80:83], v5 offset:32768
    v_mfma_f32_16x16x32_bf16 a[4:7], v[16:19], v[52:55], a[4:7]
    ds_read_b128 v[84:87], v5 offset:33792
    v_mfma_f32_16x16x32_bf16 a[8:11], v[16:19], v[56:59], a[8:11]
    v_mfma_f32_16x16x32_bf16 a[12:15], v[16:19], v[60:63], a[12:15]
    ds_read_b128 v[88:91], v5 offset:34816
    v_mfma_f32_16x16x32_bf16 a[16:19], v[16:19], v[64:67], a[16:19]
    v_mfma_f32_16x16x32_bf16 a[20:23], v[16:19], v[68:71], a[20:23]
    ds_read_b128 v[92:95], v5 offset:35840
    v_mfma_f32_16x16x32_bf16 a[24:27], v[16:19], v[72:75], a[24:27]
    ds_read_b128 v[96:99], v5 offset:36864
    v_mfma_f32_16x16x32_bf16 a[28:31], v[16:19], v[76:79], a[28:31]
    v_mfma_f32_16x16x32_bf16 a[32:35], v[20:23], v[48:51], a[32:35]
    ds_read_b128 v[100:103], v5 offset:37888
    v_mfma_f32_16x16x32_bf16 a[36:39], v[20:23], v[52:55], a[36:39]
    v_mfma_f32_16x16x32_bf16 a[40:43], v[20:23], v[56:59], a[40:43]
    ds_read_b128 v[104:107], v5 offset:38912
    v_mfma_f32_16x16x32_bf16 a[44:47], v[20:23], v[60:63], a[44:47]
    ds_read_b128 v[108:111], v5 offset:39936
    v_mfma_f32_16x16x32_bf16 a[48:51], v[20:23], v[64:67], a[48:51]
    v_mfma_f32_16x16x32_bf16 a[52:55], v[20:23], v[68:71], a[52:55]
    ds_read_b128 v[112:115], v6 offset:32768
    v_mfma_f32_16x16x32_bf16 a[56:59], v[20:23], v[72:75], a[56:59]
    v_mfma_f32_16x16x32_bf16 a[60:63], v[20:23], v[76:79], a[60:63]
    ds_read_b128 v[116:119], v6 offset:33792
    v_mfma_f32_16x16x32_bf16 a[64:67], v[24:27], v[48:51], a[64:67]
    v_mfma_f32_16x16x32_bf16 a[68:71], v[24:27], v[52:55], a[68:71]
    ds_read_b128 v[120:123], v6 offset:34816
    v_mfma_f32_16x16x32_bf16 a[72:75], v[24:27], v[56:59], a[72:75]
    ds_read_b128 v[124:127], v6 offset:35840
    v_mfma_f32_16x16x32_bf16 a[76:79], v[24:27], v[60:63], a[76:79]
    v_mfma_f32_16x16x32_bf16 a[80:83], v[24:27], v[64:67], a[80:83]
    ds_read_b128 v[128:131], v6 offset:36864
    v_mfma_f32_16x16x32_bf16 a[84:87], v[24:27], v[68:71], a[84:87]
    v_mfma_f32_16x16x32_bf16 a[88:91], v[24:27], v[72:75], a[88:91]
    ds_read_b128 v[132:135], v6 offset:37888
    v_mfma_f32_16x16x32_bf16 a[92:95], v[24:27], v[76:79], a[92:95]
    ds_read_b128 v[136:139], v6 offset:38912
    v_mfma_f32_16x16x32_bf16 a[96:99], v[28:31], v[48:51], a[96:99]
    v_mfma_f32_16x16x32_bf16 a[100:103], v[28:31], v[52:55], a[100:103]
    ds_read_b128 v[140:143], v6 offset:39936
    v_mfma_f32_16x16x32_bf16 a[104:107], v[28:31], v[56:59], a[104:107]
    v_mfma_f32_16x16x32_bf16 a[108:111], v[28:31], v[60:63], a[108:111]
    s_add_u32 m0, s38, 0
    s_nop 0
    buffer_load_dwordx4 v4, s[4:7], s40 offen  lds
    v_mfma_f32_16x16x32_bf16 a[112:115], v[28:31], v[64:67], a[112:115]
    v_mfma_f32_16x16x32_bf16 a[116:119], v[28:31], v[68:71], a[116:119]
    s_add_u32 m0, s38, 1024
    s_nop 0
    buffer_load_dwordx4 v4, s[4:7], s41 offen  lds
    v_mfma_f32_16x16x32_bf16 a[120:123], v[28:31], v[72:75], a[120:123]
    s_add_u32 m0, s38, 2048
    s_nop 0
    buffer_load_dwordx4 v4, s[4:7], s42 offen  lds
    v_mfma_f32_16x16x32_bf16 a[124:127], v[28:31], v[76:79], a[124:127]
    v_mfma_f32_16x16x32_bf16 a[128:131], v[32:35], v[48:51], a[128:131]
    s_add_u32 m0, s38, 3072
    s_nop 0
    buffer_load_dwordx4 v4, s[4:7], s43 offen  lds
    v_mfma_f32_16x16x32_bf16 a[132:135], v[32:35], v[52:55], a[132:135]
    v_mfma_f32_16x16x32_bf16 a[136:139], v[32:35], v[56:59], a[136:139]
    s_add_u32 m0, s38, 4096
    s_nop 0
    buffer_load_dwordx4 v4, s[4:7], s44 offen  lds
    v_mfma_f32_16x16x32_bf16 a[140:143], v[32:35], v[60:63], a[140:143]
    s_add_u32 m0, s38, 5120
    s_nop 0
    buffer_load_dwordx4 v4, s[4:7], s45 offen  lds
    v_mfma_f32_16x16x32_bf16 a[144:147], v[32:35], v[64:67], a[144:147]
    v_mfma_f32_16x16x32_bf16 a[148:151], v[32:35], v[68:71], a[148:151]
    s_add_u32 m0, s38, 6144
    s_nop 0
    buffer_load_dwordx4 v4, s[4:7], s46 offen  lds
    v_mfma_f32_16x16x32_bf16 a[152:155], v[32:35], v[72:75], a[152:155]
    v_mfma_f32_16x16x32_bf16 a[156:159], v[32:35], v[76:79], a[156:159]
    s_add_u32 m0, s38, 7168
    s_nop 0
    buffer_load_dwordx4 v4, s[4:7], s47 offen  lds
    v_mfma_f32_16x16x32_bf16 a[160:163], v[36:39], v[48:51], a[160:163]
    v_add_u32 v4, 1024, v4
    v_mfma_f32_16x16x32_bf16 a[164:167], v[36:39], v[52:55], a[164:167]
    v_mfma_f32_16x16x32_bf16 a[168:171], v[36:39], v[56:59], a[168:171]
    v_mfma_f32_16x16x32_bf16 a[172:175], v[36:39], v[60:63], a[172:175]
    v_mfma_f32_16x16x32_bf16 a[176:179], v[36:39], v[64:67], a[176:179]
    v_mfma_f32_16x16x32_bf16 a[180:183], v[36:39], v[68:71], a[180:183]
    v_mfma_f32_16x16x32_bf16 a[184:187], v[36:39], v[72:75], a[184:187]
    v_mfma_f32_16x16x32_bf16 a[188:191], v[36:39], v[76:79], a[188:191]
    v_mfma_f32_16x16x32_bf16 a[192:195], v[40:43], v[48:51], a[192:195]
    v_mfma_f32_16x16x32_bf16 a[196:199], v[40:43], v[52:55], a[196:199]
    v_mfma_f32_16x16x32_bf16 a[200:203], v[40:43], v[56:59], a[200:203]
    v_mfma_f32_16x16x32_bf16 a[204:207], v[40:43], v[60:63], a[204:207]
    v_mfma_f32_16x16x32_bf16 a[208:211], v[40:43], v[64:67], a[208:211]
    v_mfma_f32_16x16x32_bf16 a[212:215], v[40:43], v[68:71], a[212:215]
    v_mfma_f32_16x16x32_bf16 a[216:219], v[40:43], v[72:75], a[216:219]
    v_mfma_f32_16x16x32_bf16 a[220:223], v[40:43], v[76:79], a[220:223]
    v_mfma_f32_16x16x32_bf16 a[224:227], v[44:47], v[48:51], a[224:227]
    v_mfma_f32_16x16x32_bf16 a[228:231], v[44:47], v[52:55], a[228:231]
    v_mfma_f32_16x16x32_bf16 a[232:235], v[44:47], v[56:59], a[232:235]
    v_mfma_f32_16x16x32_bf16 a[236:239], v[44:47], v[60:63], a[236:239]
    v_mfma_f32_16x16x32_bf16 a[240:243], v[44:47], v[64:67], a[240:243]
    v_mfma_f32_16x16x32_bf16 a[244:247], v[44:47], v[68:71], a[244:247]
    v_mfma_f32_16x16x32_bf16 a[248:251], v[44:47], v[72:75], a[248:251]
    v_mfma_f32_16x16x32_bf16 a[252:255], v[44:47], v[76:79], a[252:255]
    s_waitcnt vmcnt(16) lgkmcnt(0)
    s_barrier
    v_mfma_f32_16x16x32_bf16 a[0:3], v[80:83], v[112:115], a[0:3]
    ds_read_b128 v[16:19], v7 offset:0
    v_mfma_f32_16x16x32_bf16 a[4:7], v[80:83], v[116:119], a[4:7]
    ds_read_b128 v[20:23], v7 offset:1024
    v_mfma_f32_16x16x32_bf16 a[8:11], v[80:83], v[120:123], a[8:11]
    v_mfma_f32_16x16x32_bf16 a[12:15], v[80:83], v[124:127], a[12:15]
    ds_read_b128 v[24:27], v7 offset:2048
    v_mfma_f32_16x16x32_bf16 a[16:19], v[80:83], v[128:131], a[16:19]
    v_mfma_f32_16x16x32_bf16 a[20:23], v[80:83], v[132:135], a[20:23]
    ds_read_b128 v[28:31], v7 offset:3072
    v_mfma_f32_16x16x32_bf16 a[24:27], v[80:83], v[136:139], a[24:27]
    ds_read_b128 v[32:35], v7 offset:4096
    v_mfma_f32_16x16x32_bf16 a[28:31], v[80:83], v[140:143], a[28:31]
    v_mfma_f32_16x16x32_bf16 a[32:35], v[84:87], v[112:115], a[32:35]
    ds_read_b128 v[36:39], v7 offset:5120
    v_mfma_f32_16x16x32_bf16 a[36:39], v[84:87], v[116:119], a[36:39]
    v_mfma_f32_16x16x32_bf16 a[40:43], v[84:87], v[120:123], a[40:43]
    ds_read_b128 v[40:43], v7 offset:6144
    v_mfma_f32_16x16x32_bf16 a[44:47], v[84:87], v[124:127], a[44:47]
    ds_read_b128 v[44:47], v7 offset:7168
    v_mfma_f32_16x16x32_bf16 a[48:51], v[84:87], v[128:131], a[48:51]
    v_mfma_f32_16x16x32_bf16 a[52:55], v[84:87], v[132:135], a[52:55]
    ds_read_b128 v[48:51], v8 offset:0
    v_mfma_f32_16x16x32_bf16 a[56:59], v[84:87], v[136:139], a[56:59]
    v_mfma_f32_16x16x32_bf16 a[60:63], v[84:87], v[140:143], a[60:63]
    ds_read_b128 v[52:55], v8 offset:1024
    v_mfma_f32_16x16x32_bf16 a[64:67], v[88:91], v[112:115], a[64:67]
    v_mfma_f32_16x16x32_bf16 a[68:71], v[88:91], v[116:119], a[68:71]
    ds_read_b128 v[56:59], v8 offset:2048
    v_mfma_f32_16x16x32_bf16 a[72:75], v[88:91], v[120:123], a[72:75]
    ds_read_b128 v[60:63], v8 offset:3072
    v_mfma_f32_16x16x32_bf16 a[76:79], v[88:91], v[124:127], a[76:79]
    v_mfma_f32_16x16x32_bf16 a[80:83], v[88:91], v[128:131], a[80:83]
    ds_read_b128 v[64:67], v8 offset:4096
    v_mfma_f32_16x16x32_bf16 a[84:87], v[88:91], v[132:135], a[84:87]
    v_mfma_f32_16x16x32_bf16 a[88:91], v[88:91], v[136:139], a[88:91]
    ds_read_b128 v[68:71], v8 offset:5120
    v_mfma_f32_16x16x32_bf16 a[92:95], v[88:91], v[140:143], a[92:95]
    ds_read_b128 v[72:75], v8 offset:6144
    v_mfma_f32_16x16x32_bf16 a[96:99], v[92:95], v[112:115], a[96:99]
    v_mfma_f32_16x16x32_bf16 a[100:103], v[92:95], v[116:119], a[100:103]
    ds_read_b128 v[76:79], v8 offset:7168
    v_mfma_f32_16x16x32_bf16 a[104:107], v[92:95], v[120:123], a[104:107]
    v_mfma_f32_16x16x32_bf16 a[108:111], v[92:95], v[124:127], a[108:111]
    s_add_u32 m0, s38, 32768
    s_nop 0
    buffer_load_dwordx4 v4, s[4:7], s40 offen  lds
    v_mfma_f32_16x16x32_bf16 a[112:115], v[92:95], v[128:131], a[112:115]
    v_mfma_f32_16x16x32_bf16 a[116:119], v[92:95], v[132:135], a[116:119]
    s_add_u32 m0, s38, 33792
    s_nop 0
    buffer_load_dwordx4 v4, s[4:7], s41 offen  lds
    v_mfma_f32_16x16x32_bf16 a[120:123], v[92:95], v[136:139], a[120:123]
    s_add_u32 m0, s38, 34816
    s_nop 0
    buffer_load_dwordx4 v4, s[4:7], s42 offen  lds
    v_mfma_f32_16x16x32_bf16 a[124:127], v[92:95], v[140:143], a[124:127]
    v_mfma_f32_16x16x32_bf16 a[128:131], v[96:99], v[112:115], a[128:131]
    s_add_u32 m0, s38, 35840
    s_nop 0
    buffer_load_dwordx4 v4, s[4:7], s43 offen  lds
    v_mfma_f32_16x16x32_bf16 a[132:135], v[96:99], v[116:119], a[132:135]
    v_mfma_f32_16x16x32_bf16 a[136:139], v[96:99], v[120:123], a[136:139]
    s_add_u32 m0, s38, 36864
    s_nop 0
    buffer_load_dwordx4 v4, s[4:7], s44 offen  lds
    v_mfma_f32_16x16x32_bf16 a[140:143], v[96:99], v[124:127], a[140:143]
    s_add_u32 m0, s38, 37888
    s_nop 0
    buffer_load_dwordx4 v4, s[4:7], s45 offen  lds
    v_mfma_f32_16x16x32_bf16 a[144:147], v[96:99], v[128:131], a[144:147]
    v_mfma_f32_16x16x32_bf16 a[148:151], v[96:99], v[132:135], a[148:151]
    s_add_u32 m0, s38, 38912
    s_nop 0
    buffer_load_dwordx4 v4, s[4:7], s46 offen  lds
    v_mfma_f32_16x16x32_bf16 a[152:155], v[96:99], v[136:139], a[152:155]
    v_mfma_f32_16x16x32_bf16 a[156:159], v[96:99], v[140:143], a[156:159]
    s_add_u32 m0, s38, 39936
    s_nop 0
    buffer_load_dwordx4 v4, s[4:7], s47 offen  lds
    v_mfma_f32_16x16x32_bf16 a[160:163], v[100:103], v[112:115], a[160:163]
    v_add_u32 v4, 1024, v4
    v_mfma_f32_16x16x32_bf16 a[164:167], v[100:103], v[116:119], a[164:167]
    v_mfma_f32_16x16x32_bf16 a[168:171], v[100:103], v[120:123], a[168:171]
    v_mfma_f32_16x16x32_bf16 a[172:175], v[100:103], v[124:127], a[172:175]
    v_mfma_f32_16x16x32_bf16 a[176:179], v[100:103], v[128:131], a[176:179]
    v_mfma_f32_16x16x32_bf16 a[180:183], v[100:103], v[132:135], a[180:183]
    v_mfma_f32_16x16x32_bf16 a[184:187], v[100:103], v[136:139], a[184:187]
    v_mfma_f32_16x16x32_bf16 a[188:191], v[100:103], v[140:143], a[188:191]
    v_mfma_f32_16x16x32_bf16 a[192:195], v[104:107], v[112:115], a[192:195]
    v_mfma_f32_16x16x32_bf16 a[196:199], v[104:107], v[116:119], a[196:199]
    v_mfma_f32_16x16x32_bf16 a[200:203], v[104:107], v[120:123], a[200:203]
    v_mfma_f32_16x16x32_bf16 a[204:207], v[104:107], v[124:127], a[204:207]
    v_mfma_f32_16x16x32_bf16 a[208:211], v[104:107], v[128:131], a[208:211]
    v_mfma_f32_16x16x32_bf16 a[212:215], v[104:107], v[132:135], a[212:215]
    v_mfma_f32_16x16x32_bf16 a[216:219], v[104:107], v[136:139], a[216:219]
    v_mfma_f32_16x16x32_bf16 a[220:223], v[104:107], v[140:143], a[220:223]
    v_mfma_f32_16x16x32_bf16 a[224:227], v[108:111], v[112:115], a[224:227]
    v_mfma_f32_16x16x32_bf16 a[228:231], v[108:111], v[116:119], a[228:231]
    v_mfma_f32_16x16x32_bf16 a[232:235], v[108:111], v[120:123], a[232:235]
    v_mfma_f32_16x16x32_bf16 a[236:239], v[108:111], v[124:127], a[236:239]
    v_mfma_f32_16x16x32_bf16 a[240:243], v[108:111], v[128:131], a[240:243]
    v_mfma_f32_16x16x32_bf16 a[244:247], v[108:111], v[132:135], a[244:247]
    v_mfma_f32_16x16x32_bf16 a[248:251], v[108:111], v[136:139], a[248:251]
    v_mfma_f32_16x16x32_bf16 a[252:255], v[108:111], v[140:143], a[252:255]
    s_sub_u32 s35, s35, 2
    s_cmp_eq_u32 s35, 0
    s_cbranch_scc1 kv_vv_end
    s_waitcnt vmcnt(16) lgkmcnt(0)
    s_barrier
    v_mfma_f32_16x16x32_bf16 a[0:3], v[16:19], v[48:51], a[0:3]
    ds_read_b128 v[80:83], v7 offset:32768
    v_mfma_f32_16x16x32_bf16 a[4:7], v[16:19], v[52:55], a[4:7]
    ds_read_b128 v[84:87], v7 offset:33792
    v_mfma_f32_16x16x32_bf16 a[8:11], v[16:19], v[56:59], a[8:11]
    v_mfma_f32_16x16x32_bf16 a[12:15], v[16:19], v[60:63], a[12:15]
    ds_read_b128 v[88:91], v7 offset:34816
    v_mfma_f32_16x16x32_bf16 a[16:19], v[16:19], v[64:67], a[16:19]
    v_mfma_f32_16x16x32_bf16 a[20:23], v[16:19], v[68:71], a[20:23]
    ds_read_b128 v[92:95], v7 offset:35840
    v_mfma_f32_16x16x32_bf16 a[24:27], v[16:19], v[72:75], a[24:27]
    ds_read_b128 v[96:99], v7 offset:36864
    v_mfma_f32_16x16x32_bf16 a[28:31], v[16:19], v[76:79], a[28:31]
    v_mfma_f32_16x16x32_bf16 a[32:35], v[20:23], v[48:51], a[32:35]
    ds_read_b128 v[100:103], v7 offset:37888
    v_mfma_f32_16x16x32_bf16 a[36:39], v[20:23], v[52:55], a[36:39]
    v_mfma_f32_16x16x32_bf16 a[40:43], v[20:23], v[56:59], a[40:43]
    ds_read_b128 v[104:107], v7 offset:38912
    v_mfma_f32_16x16x32_bf16 a[44:47], v[20:23], v[60:63], a[44:47]
    ds_read_b128 v[108:111], v7 offset:39936
    v_mfma_f32_16x16x32_bf16 a[48:51], v[20:23], v[64:67], a[48:51]
    v_mfma_f32_16x16x32_bf16 a[52:55], v[20:23], v[68:71], a[52:55]
    ds_read_b128 v[112:115], v8 offset:32768
    v_mfma_f32_16x16x32_bf16 a[56:59], v[20:23], v[72:75], a[56:59]
    v_mfma_f32_16x16x32_bf16 a[60:63], v[20:23], v[76:79], a[60:63]
    ds_read_b128 v[116:119], v8 offset:33792
    v_mfma_f32_16x16x32_bf16 a[64:67], v[24:27], v[48:51], a[64:67]
    v_mfma_f32_16x16x32_bf16 a[68:71], v[24:27], v[52:55], a[68:71]
    ds_read_b128 v[120:123], v8 offset:34816
    v_mfma_f32_16x16x32_bf16 a[72:75], v[24:27], v[56:59], a[72:75]
    ds_read_b128 v[124:127], v8 offset:35840
    v_mfma_f32_16x16x32_bf16 a[76:79], v[24:27], v[60:63], a[76:79]
    v_mfma_f32_16x16x32_bf16 a[80:83], v[24:27], v[64:67], a[80:83]
    ds_read_b128 v[128:131], v8 offset:36864
    v_mfma_f32_16x16x32_bf16 a[84:87], v[24:27], v[68:71], a[84:87]
    v_mfma_f32_16x16x32_bf16 a[88:91], v[24:27], v[72:75], a[88:91]
    ds_read_b128 v[132:135], v8 offset:37888
    v_mfma_f32_16x16x32_bf16 a[92:95], v[24:27], v[76:79], a[92:95]
    ds_read_b128 v[136:139], v8 offset:38912
    v_mfma_f32_16x16x32_bf16 a[96:99], v[28:31], v[48:51], a[96:99]
    v_mfma_f32_16x16x32_bf16 a[100:103], v[28:31], v[52:55], a[100:103]
    ds_read_b128 v[140:143], v8 offset:39936
    v_mfma_f32_16x16x32_bf16 a[104:107], v[28:31], v[56:59], a[104:107]
    v_mfma_f32_16x16x32_bf16 a[108:111], v[28:31], v[60:63], a[108:111]
    s_add_u32 m0, s38, 65536
    s_nop 0
    buffer_load_dwordx4 v4, s[4:7], s40 offen  lds
    v_mfma_f32_16x16x32_bf16 a[112:115], v[28:31], v[64:67], a[112:115]
    v_mfma_f32_16x16x32_bf16 a[116:119], v[28:31], v[68:71], a[116:119]
    s_add_u32 m0, s38, 66560
    s_nop 0
    buffer_load_dwordx4 v4, s[4:7], s41 offen  lds
    v_mfma_f32_16x16x32_bf16 a[120:123], v[28:31], v[72:75], a[120:123]
    s_add_u32 m0, s38, 67584
    s_nop 0
    buffer_load_dwordx4 v4, s[4:7], s42 offen  lds
    v_mfma_f32_16x16x32_bf16 a[124:127], v[28:31], v[76:79], a[124:127]
    v_mfma_f32_16x16x32_bf16 a[128:131], v[32:35], v[48:51], a[128:131]
    s_add_u32 m0, s38, 68608
    s_nop 0
    buffer_load_dwordx4 v4, s[4:7], s43 offen  lds
    v_mfma_f32_16x16x32_bf16 a[132:135], v[32:35], v[52:55], a[132:135]
    v_mfma_f32_16x16x32_bf16 a[136:139], v[32:35], v[56:59], a[136:139]
    s_add_u32 m0, s38, 69632
    s_nop 0
    buffer_load_dwordx4 v4, s[4:7], s44 offen  lds
    v_mfma_f32_16x16x32_bf16 a[140:143], v[32:35], v[60:63], a[140:143]
    s_add_u32 m0, s38, 70656
    s_nop 0
    buffer_load_dwordx4 v4, s[4:7], s45 offen  lds
    v_mfma_f32_16x16x32_bf16 a[144:147], v[32:35], v[64:67], a[144:147]
    v_mfma_f32_16x16x32_bf16 a[148:151], v[32:35], v[68:71], a[148:151]
    s_add_u32 m0, s38, 71680
    s_nop 0
    buffer_load_dwordx4 v4, s[4:7], s46 offen  lds
    v_mfma_f32_16x16x32_bf16 a[152:155], v[32:35], v[72:75], a[152:155]
    v_mfma_f32_16x16x32_bf16 a[156:159], v[32:35], v[76:79], a[156:159]
    s_add_u32 m0, s38, 72704
    s_nop 0
    buffer_load_dwordx4 v4, s[4:7], s47 offen  lds
    v_mfma_f32_16x16x32_bf16 a[160:163], v[36:39], v[48:51], a[160:163]
    v_add_u32 v4, 1024, v4
    v_mfma_f32_16x16x32_bf16 a[164:167], v[36:39], v[52:55], a[164:167]
    v_mfma_f32_16x16x32_bf16 a[168:171], v[36:39], v[56:59], a[168:171]
    v_mfma_f32_16x16x32_bf16 a[172:175], v[36:39], v[60:63], a[172:175]
    v_mfma_f32_16x16x32_bf16 a[176:179], v[36:39], v[64:67], a[176:179]
    v_mfma_f32_16x16x32_bf16 a[180:183], v[36:39], v[68:71], a[180:183]
    v_mfma_f32_16x16x32_bf16 a[184:187], v[36:39], v[72:75], a[184:187]
    v_mfma_f32_16x16x32_bf16 a[188:191], v[36:39], v[76:79], a[188:191]
    v_mfma_f32_16x16x32_bf16 a[192:195], v[40:43], v[48:51], a[192:195]
    v_mfma_f32_16x16x32_bf16 a[196:199], v[40:43], v[52:55], a[196:199]
    v_mfma_f32_16x16x32_bf16 a[200:203], v[40:43], v[56:59], a[200:203]
    v_mfma_f32_16x16x32_bf16 a[204:207], v[40:43], v[60:63], a[204:207]
    v_mfma_f32_16x16x32_bf16 a[208:211], v[40:43], v[64:67], a[208:211]
    v_mfma_f32_16x16x32_bf16 a[212:215], v[40:43], v[68:71], a[212:215]
    v_mfma_f32_16x16x32_bf16 a[216:219], v[40:43], v[72:75], a[216:219]
    v_mfma_f32_16x16x32_bf16 a[220:223], v[40:43], v[76:79], a[220:223]
    v_mfma_f32_16x16x32_bf16 a[224:227], v[44:47], v[48:51], a[224:227]
    v_mfma_f32_16x16x32_bf16 a[228:231], v[44:47], v[52:55], a[228:231]
    v_mfma_f32_16x16x32_bf16 a[232:235], v[44:47], v[56:59], a[232:235]
    v_mfma_f32_16x16x32_bf16 a[236:239], v[44:47], v[60:63], a[236:239]
    v_mfma_f32_16x16x32_bf16 a[240:243], v[44:47], v[64:67], a[240:243]
    v_mfma_f32_16x16x32_bf16 a[244:247], v[44:47], v[68:71], a[244:247]
    v_mfma_f32_16x16x32_bf16 a[248:251], v[44:47], v[72:75], a[248:251]
    v_mfma_f32_16x16x32_bf16 a[252:255], v[44:47], v[76:79], a[252:255]
    s_waitcnt vmcnt(16) lgkmcnt(0)
    s_barrier
    v_mfma_f32_16x16x32_bf16 a[0:3], v[80:83], v[112:115], a[0:3]
    ds_read_b128 v[16:19], v5 offset:0
    v_mfma_f32_16x16x32_bf16 a[4:7], v[80:83], v[116:119], a[4:7]
    ds_read_b128 v[20:23], v5 offset:1024
    v_mfma_f32_16x16x32_bf16 a[8:11], v[80:83], v[120:123], a[8:11]
    v_mfma_f32_16x16x32_bf16 a[12:15], v[80:83], v[124:127], a[12:15]
    ds_read_b128 v[24:27], v5 offset:2048
    v_mfma_f32_16x16x32_bf16 a[16:19], v[80:83], v[128:131], a[16:19]
    v_mfma_f32_16x16x32_bf16 a[20:23], v[80:83], v[132:135], a[20:23]
    ds_read_b128 v[28:31], v5 offset:3072
    v_mfma_f32_16x16x32_bf16 a[24:27], v[80:83], v[136:139], a[24:27]
    ds_read_b128 v[32:35], v5 offset:4096
    v_mfma_f32_16x16x32_bf16 a[28:31], v[80:83], v[140:143], a[28:31]
    v_mfma_f32_16x16x32_bf16 a[32:35], v[84:87], v[112:115], a[32:35]
    ds_read_b128 v[36:39], v5 offset:5120
    v_mfma_f32_16x16x32_bf16 a[36:39], v[84:87], v[116:119], a[36:39]
    v_mfma_f32_16x16x32_bf16 a[40:43], v[84:87], v[120:123], a[40:43]
    ds_read_b128 v[40:43], v5 offset:6144
    v_mfma_f32_16x16x32_bf16 a[44:47], v[84:87], v[124:127], a[44:47]
    ds_read_b128 v[44:47], v5 offset:7168
    v_mfma_f32_16x16x32_bf16 a[48:51], v[84:87], v[128:131], a[48:51]
    v_mfma_f32_16x16x32_bf16 a[52:55], v[84:87], v[132:135], a[52:55]
    ds_read_b128 v[48:51], v6 offset:0
    v_mfma_f32_16x16x32_bf16 a[56:59], v[84:87], v[136:139], a[56:59]
    v_mfma_f32_16x16x32_bf16 a[60:63], v[84:87], v[140:143], a[60:63]
    ds_read_b128 v[52:55], v6 offset:1024
    v_mfma_f32_16x16x32_bf16 a[64:67], v[88:91], v[112:115], a[64:67]
    v_mfma_f32_16x16x32_bf16 a[68:71], v[88:91], v[116:119], a[68:71]
    ds_read_b128 v[56:59], v6 offset:2048
    v_mfma_f32_16x16x32_bf16 a[72:75], v[88:91], v[120:123], a[72:75]
    ds_read_b128 v[60:63], v6 offset:3072
    v_mfma_f32_16x16x32_bf16 a[76:79], v[88:91], v[124:127], a[76:79]
    v_mfma_f32_16x16x32_bf16 a[80:83], v[88:91], v[128:131], a[80:83]
    ds_read_b128 v[64:67], v6 offset:4096
    v_mfma_f32_16x16x32_bf16 a[84:87], v[88:91], v[132:135], a[84:87]
    v_mfma_f32_16x16x32_bf16 a[88:91], v[88:91], v[136:139], a[88:91]
    ds_read_b128 v[68:71], v6 offset:5120
    v_mfma_f32_16x16x32_bf16 a[92:95], v[88:91], v[140:143], a[92:95]
    ds_read_b128 v[72:75], v6 offset:6144
    v_mfma_f32_16x16x32_bf16 a[96:99], v[92:95], v[112:115], a[96:99]
    v_mfma_f32_16x16x32_bf16 a[100:103], v[92:95], v[116:119], a[100:103]
    ds_read_b128 v[76:79], v6 offset:7168
    v_mfma_f32_16x16x32_bf16 a[104:107], v[92:95], v[120:123], a[104:107]
    v_mfma_f32_16x16x32_bf16 a[108:111], v[92:95], v[124:127], a[108:111]
    s_add_u32 m0, s38, 98304
    s_nop 0
    buffer_load_dwordx4 v4, s[4:7], s40 offen  lds
    v_mfma_f32_16x16x32_bf16 a[112:115], v[92:95], v[128:131], a[112:115]
    v_mfma_f32_16x16x32_bf16 a[116:119], v[92:95], v[132:135], a[116:119]
    s_add_u32 m0, s38, 99328
    s_nop 0
    buffer_load_dwordx4 v4, s[4:7], s41 offen  lds
    v_mfma_f32_16x16x32_bf16 a[120:123], v[92:95], v[136:139], a[120:123]
    s_add_u32 m0, s38, 100352
    s_nop 0
    buffer_load_dwordx4 v4, s[4:7], s42 offen  lds
    v_mfma_f32_16x16x32_bf16 a[124:127], v[92:95], v[140:143], a[124:127]
    v_mfma_f32_16x16x32_bf16 a[128:131], v[96:99], v[112:115], a[128:131]
    s_add_u32 m0, s38, 101376
    s_nop 0
    buffer_load_dwordx4 v4, s[4:7], s43 offen  lds
    v_mfma_f32_16x16x32_bf16 a[132:135], v[96:99], v[116:119], a[132:135]
    v_mfma_f32_16x16x32_bf16 a[136:139], v[96:99], v[120:123], a[136:139]
    s_add_u32 m0, s38, 102400
    s_nop 0
    buffer_load_dwordx4 v4, s[4:7], s44 offen  lds
    v_mfma_f32_16x16x32_bf16 a[140:143], v[96:99], v[124:127], a[140:143]
    s_add_u32 m0, s38, 103424
    s_nop 0
    buffer_load_dwordx4 v4, s[4:7], s45 offen  lds
    v_mfma_f32_16x16x32_bf16 a[144:147], v[96:99], v[128:131], a[144:147]
    v_mfma_f32_16x16x32_bf16 a[148:151], v[96:99], v[132:135], a[148:151]
    s_add_u32 m0, s38, 104448
    s_nop 0
    buffer_load_dwordx4 v4, s[4:7], s46 offen  lds
    v_mfma_f32_16x16x32_bf16 a[152:155], v[96:99], v[136:139], a[152:155]
    v_mfma_f32_16x16x32_bf16 a[156:159], v[96:99], v[140:143], a[156:159]
    s_add_u32 m0, s38, 105472
    s_nop 0
    buffer_load_dwordx4 v4, s[4:7], s47 offen  lds
    v_mfma_f32_16x16x32_bf16 a[160:163], v[100:103], v[112:115], a[160:163]
    v_add_u32 v4, 1024, v4
    v_mfma_f32_16x16x32_bf16 a[164:167], v[100:103], v[116:119], a[164:167]
    v_mfma_f32_16x16x32_bf16 a[168:171], v[100:103], v[120:123], a[168:171]
    v_mfma_f32_16x16x32_bf16 a[172:175], v[100:103], v[124:127], a[172:175]
    v_mfma_f32_16x16x32_bf16 a[176:179], v[100:103], v[128:131], a[176:179]
    v_mfma_f32_16x16x32_bf16 a[180:183], v[100:103], v[132:135], a[180:183]
    v_mfma_f32_16x16x32_bf16 a[184:187], v[100:103], v[136:139], a[184:187]
    v_mfma_f32_16x16x32_bf16 a[188:191], v[100:103], v[140:143], a[188:191]
    v_mfma_f32_16x16x32_bf16 a[192:195], v[104:107], v[112:115], a[192:195]
    v_mfma_f32_16x16x32_bf16 a[196:199], v[104:107], v[116:119], a[196:199]
    v_mfma_f32_16x16x32_bf16 a[200:203], v[104:107], v[120:123], a[200:203]
    v_mfma_f32_16x16x32_bf16 a[204:207], v[104:107], v[124:127], a[204:207]
    v_mfma_f32_16x16x32_bf16 a[208:211], v[104:107], v[128:131], a[208:211]
    v_mfma_f32_16x16x32_bf16 a[212:215], v[104:107], v[132:135], a[212:215]
    v_mfma_f32_16x16x32_bf16 a[216:219], v[104:107], v[136:139], a[216:219]
    v_mfma_f32_16x16x32_bf16 a[220:223], v[104:107], v[140:143], a[220:223]
    v_mfma_f32_16x16x32_bf16 a[224:227], v[108:111], v[112:115], a[224:227]
    v_mfma_f32_16x16x32_bf16 a[228:231], v[108:111], v[116:119], a[228:231]
    v_mfma_f32_16x16x32_bf16 a[232:235], v[108:111], v[120:123], a[232:235]
    v_mfma_f32_16x16x32_bf16 a[236:239], v[108:111], v[124:127], a[236:239]
    v_mfma_f32_16x16x32_bf16 a[240:243], v[108:111], v[128:131], a[240:243]
    v_mfma_f32_16x16x32_bf16 a[244:247], v[108:111], v[132:135], a[244:247]
    v_mfma_f32_16x16x32_bf16 a[248:251], v[108:111], v[136:139], a[248:251]
    v_mfma_f32_16x16x32_bf16 a[252:255], v[108:111], v[140:143], a[252:255]
    s_sub_u32 s35, s35, 2
    s_cmp_eq_u32 s35, 0
    s_cbranch_scc0 kv_vv_loop
kv_vv_end:
    s_waitcnt vmcnt(0) lgkmcnt(0)
    s_barrier
    s_nop 7
    s_lshl_b32 s31, s20, 13
    s_add_u32 s30, s30, s31
    s_add_u32 s30, s30, 67108864
    v_accvgpr_read_b32 v16, a0
    v_accvgpr_read_b32 v17, a1
    v_accvgpr_read_b32 v18, a2
    v_accvgpr_read_b32 v19, a3
    v_accvgpr_read_b32 v20, a32
    v_accvgpr_read_b32 v21, a33
    v_accvgpr_read_b32 v22, a34
    v_accvgpr_read_b32 v23, a35
    v_cvt_pk_bf16_f32 v24, v16, v17
    v_cvt_pk_bf16_f32 v25, v18, v19
    v_cvt_pk_bf16_f32 v26, v20, v21
    v_cvt_pk_bf16_f32 v27, v22, v23
    buffer_store_dwordx4 v[24:27], v1, s[4:7], s30 offen offset:0 sc1
    v_accvgpr_read_b32 v28, a4
    v_accvgpr_read_b32 v29, a5
    v_accvgpr_read_b32 v30, a6
    v_accvgpr_read_b32 v31, a7
    v_accvgpr_read_b32 v32, a36
    v_accvgpr_read_b32 v33, a37
    v_accvgpr_read_b32 v34, a38
    v_accvgpr_read_b32 v35, a39
    v_cvt_pk_bf16_f32 v36, v28, v29
    v_cvt_pk_bf16_f32 v37, v30, v31
    v_cvt_pk_bf16_f32 v38, v32, v33
    v_cvt_pk_bf16_f32 v39, v34, v35
    buffer_store_dwordx4 v[36:39], v1, s[4:7], s30 offen offset:1024 sc1
    v_accvgpr_read_b32 v40, a8
    v_accvgpr_read_b32 v41, a9
    v_accvgpr_read_b32 v42, a10
    v_accvgpr_read_b32 v43, a11
    v_accvgpr_read_b32 v44, a40
    v_accvgpr_read_b32 v45, a41
    v_accvgpr_read_b32 v46, a42
    v_accvgpr_read_b32 v47, a43
    v_cvt_pk_bf16_f32 v48, v40, v41
    v_cvt_pk_bf16_f32 v49, v42, v43
    v_cvt_pk_bf16_f32 v50, v44, v45
    v_cvt_pk_bf16_f32 v51, v46, v47
    buffer_store_dwordx4 v[48:51], v1, s[4:7], s30 offen offset:2048 sc1
    v_accvgpr_read_b32 v52, a12
    v_accvgpr_read_b32 v53, a13
    v_accvgpr_read_b32 v54, a14
    v_accvgpr_read_b32 v55, a15
    v_accvgpr_read_b32 v56, a44
    v_accvgpr_read_b32 v57, a45
    v_accvgpr_read_b32 v58, a46
    v_accvgpr_read_b32 v59, a47
    v_cvt_pk_bf16_f32 v60, v52, v53
    v_cvt_pk_bf16_f32 v61, v54, v55
    v_cvt_pk_bf16_f32 v62, v56, v57
    v_cvt_pk_bf16_f32 v63, v58, v59
    buffer_store_dwordx4 v[60:63], v1, s[4:7], s30 offen offset:3072 sc1
    s_add_u32 s30, s30, 4096
    v_accvgpr_read_b32 v16, a16
    v_accvgpr_read_b32 v17, a17
    v_accvgpr_read_b32 v18, a18
    v_accvgpr_read_b32 v19, a19
    v_accvgpr_read_b32 v20, a48
    v_accvgpr_read_b32 v21, a49
    v_accvgpr_read_b32 v22, a50
    v_accvgpr_read_b32 v23, a51
    v_cvt_pk_bf16_f32 v24, v16, v17
    v_cvt_pk_bf16_f32 v25, v18, v19
    v_cvt_pk_bf16_f32 v26, v20, v21
    v_cvt_pk_bf16_f32 v27, v22, v23
    buffer_store_dwordx4 v[24:27], v1, s[4:7], s30 offen offset:0 sc1
    v_accvgpr_read_b32 v28, a20
    v_accvgpr_read_b32 v29, a21
    v_accvgpr_read_b32 v30, a22
    v_accvgpr_read_b32 v31, a23
    v_accvgpr_read_b32 v32, a52
    v_accvgpr_read_b32 v33, a53
    v_accvgpr_read_b32 v34, a54
    v_accvgpr_read_b32 v35, a55
    v_cvt_pk_bf16_f32 v36, v28, v29
    v_cvt_pk_bf16_f32 v37, v30, v31
    v_cvt_pk_bf16_f32 v38, v32, v33
    v_cvt_pk_bf16_f32 v39, v34, v35
    buffer_store_dwordx4 v[36:39], v1, s[4:7], s30 offen offset:1024 sc1
    v_accvgpr_read_b32 v40, a24
    v_accvgpr_read_b32 v41, a25
    v_accvgpr_read_b32 v42, a26
    v_accvgpr_read_b32 v43, a27
    v_accvgpr_read_b32 v44, a56
    v_accvgpr_read_b32 v45, a57
    v_accvgpr_read_b32 v46, a58
    v_accvgpr_read_b32 v47, a59
    v_cvt_pk_bf16_f32 v48, v40, v41
    v_cvt_pk_bf16_f32 v49, v42, v43
    v_cvt_pk_bf16_f32 v50, v44, v45
    v_cvt_pk_bf16_f32 v51, v46, v47
    buffer_store_dwordx4 v[48:51], v1, s[4:7], s30 offen offset:2048 sc1
    v_accvgpr_read_b32 v52, a28
    v_accvgpr_read_b32 v53, a29
    v_accvgpr_read_b32 v54, a30
    v_accvgpr_read_b32 v55, a31
    v_accvgpr_read_b32 v56, a60
    v_accvgpr_read_b32 v57, a61
    v_accvgpr_read_b32 v58, a62
    v_accvgpr_read_b32 v59, a63
    v_cvt_pk_bf16_f32 v60, v52, v53
    v_cvt_pk_bf16_f32 v61, v54, v55
    v_cvt_pk_bf16_f32 v62, v56, v57
    v_cvt_pk_bf16_f32 v63, v58, v59
    buffer_store_dwordx4 v[60:63], v1, s[4:7], s30 offen offset:3072 sc1
    s_add_u32 s30, s30, 258048
    v_accvgpr_read_b32 v16, a64
    v_accvgpr_read_b32 v17, a65
    v_accvgpr_read_b32 v18, a66
    v_accvgpr_read_b32 v19, a67
    v_accvgpr_read_b32 v20, a96
    v_accvgpr_read_b32 v21, a97
    v_accvgpr_read_b32 v22, a98
    v_accvgpr_read_b32 v23, a99
    v_cvt_pk_bf16_f32 v24, v16, v17
    v_cvt_pk_bf16_f32 v25, v18, v19
    v_cvt_pk_bf16_f32 v26, v20, v21
    v_cvt_pk_bf16_f32 v27, v22, v23
    buffer_store_dwordx4 v[24:27], v1, s[4:7], s30 offen offset:0 sc1
    v_accvgpr_read_b32 v28, a68
    v_accvgpr_read_b32 v29, a69
    v_accvgpr_read_b32 v30, a70
    v_accvgpr_read_b32 v31, a71
    v_accvgpr_read_b32 v32, a100
    v_accvgpr_read_b32 v33, a101
    v_accvgpr_read_b32 v34, a102
    v_accvgpr_read_b32 v35, a103
    v_cvt_pk_bf16_f32 v36, v28, v29
    v_cvt_pk_bf16_f32 v37, v30, v31
    v_cvt_pk_bf16_f32 v38, v32, v33
    v_cvt_pk_bf16_f32 v39, v34, v35
    buffer_store_dwordx4 v[36:39], v1, s[4:7], s30 offen offset:1024 sc1
    v_accvgpr_read_b32 v40, a72
    v_accvgpr_read_b32 v41, a73
    v_accvgpr_read_b32 v42, a74
    v_accvgpr_read_b32 v43, a75
    v_accvgpr_read_b32 v44, a104
    v_accvgpr_read_b32 v45, a105
    v_accvgpr_read_b32 v46, a106
    v_accvgpr_read_b32 v47, a107
    v_cvt_pk_bf16_f32 v48, v40, v41
    v_cvt_pk_bf16_f32 v49, v42, v43
    v_cvt_pk_bf16_f32 v50, v44, v45
    v_cvt_pk_bf16_f32 v51, v46, v47
    buffer_store_dwordx4 v[48:51], v1, s[4:7], s30 offen offset:2048 sc1
    v_accvgpr_read_b32 v52, a76
    v_accvgpr_read_b32 v53, a77
    v_accvgpr_read_b32 v54, a78
    v_accvgpr_read_b32 v55, a79
    v_accvgpr_read_b32 v56, a108
    v_accvgpr_read_b32 v57, a109
    v_accvgpr_read_b32 v58, a110
    v_accvgpr_read_b32 v59, a111
    v_cvt_pk_bf16_f32 v60, v52, v53
    v_cvt_pk_bf16_f32 v61, v54, v55
    v_cvt_pk_bf16_f32 v62, v56, v57
    v_cvt_pk_bf16_f32 v63, v58, v59
    buffer_store_dwordx4 v[60:63], v1, s[4:7], s30 offen offset:3072 sc1
    s_add_u32 s30, s30, 4096
    v_accvgpr_read_b32 v16, a80
    v_accvgpr_read_b32 v17, a81
    v_accvgpr_read_b32 v18, a82
    v_accvgpr_read_b32 v19, a83
    v_accvgpr_read_b32 v20, a112
    v_accvgpr_read_b32 v21, a113
    v_accvgpr_read_b32 v22, a114
    v_accvgpr_read_b32 v23, a115
    v_cvt_pk_bf16_f32 v24, v16, v17
    v_cvt_pk_bf16_f32 v25, v18, v19
    v_cvt_pk_bf16_f32 v26, v20, v21
    v_cvt_pk_bf16_f32 v27, v22, v23
    buffer_store_dwordx4 v[24:27], v1, s[4:7], s30 offen offset:0 sc1
    v_accvgpr_read_b32 v28, a84
    v_accvgpr_read_b32 v29, a85
    v_accvgpr_read_b32 v30, a86
    v_accvgpr_read_b32 v31, a87
    v_accvgpr_read_b32 v32, a116
    v_accvgpr_read_b32 v33, a117
    v_accvgpr_read_b32 v34, a118
    v_accvgpr_read_b32 v35, a119
    v_cvt_pk_bf16_f32 v36, v28, v29
    v_cvt_pk_bf16_f32 v37, v30, v31
    v_cvt_pk_bf16_f32 v38, v32, v33
    v_cvt_pk_bf16_f32 v39, v34, v35
    buffer_store_dwordx4 v[36:39], v1, s[4:7], s30 offen offset:1024 sc1
    v_accvgpr_read_b32 v40, a88
    v_accvgpr_read_b32 v41, a89
    v_accvgpr_read_b32 v42, a90
    v_accvgpr_read_b32 v43, a91
    v_accvgpr_read_b32 v44, a120
    v_accvgpr_read_b32 v45, a121
    v_accvgpr_read_b32 v46, a122
    v_accvgpr_read_b32 v47, a123
    v_cvt_pk_bf16_f32 v48, v40, v41
    v_cvt_pk_bf16_f32 v49, v42, v43
    v_cvt_pk_bf16_f32 v50, v44, v45
    v_cvt_pk_bf16_f32 v51, v46, v47
    buffer_store_dwordx4 v[48:51], v1, s[4:7], s30 offen offset:2048 sc1
    v_accvgpr_read_b32 v52, a92
    v_accvgpr_read_b32 v53, a93
    v_accvgpr_read_b32 v54, a94
    v_accvgpr_read_b32 v55, a95
    v_accvgpr_read_b32 v56, a124
    v_accvgpr_read_b32 v57, a125
    v_accvgpr_read_b32 v58, a126
    v_accvgpr_read_b32 v59, a127
    v_cvt_pk_bf16_f32 v60, v52, v53
    v_cvt_pk_bf16_f32 v61, v54, v55
    v_cvt_pk_bf16_f32 v62, v56, v57
    v_cvt_pk_bf16_f32 v63, v58, v59
    buffer_store_dwordx4 v[60:63], v1, s[4:7], s30 offen offset:3072 sc1
    s_add_u32 s30, s30, 258048
    v_accvgpr_read_b32 v16, a128
    v_accvgpr_read_b32 v17, a129
    v_accvgpr_read_b32 v18, a130
    v_accvgpr_read_b32 v19, a131
    v_accvgpr_read_b32 v20, a160
    v_accvgpr_read_b32 v21, a161
    v_accvgpr_read_b32 v22, a162
    v_accvgpr_read_b32 v23, a163
    v_cvt_pk_bf16_f32 v24, v16, v17
    v_cvt_pk_bf16_f32 v25, v18, v19
    v_cvt_pk_bf16_f32 v26, v20, v21
    v_cvt_pk_bf16_f32 v27, v22, v23
    buffer_store_dwordx4 v[24:27], v1, s[4:7], s30 offen offset:0 sc1
    v_accvgpr_read_b32 v28, a132
    v_accvgpr_read_b32 v29, a133
    v_accvgpr_read_b32 v30, a134
    v_accvgpr_read_b32 v31, a135
    v_accvgpr_read_b32 v32, a164
    v_accvgpr_read_b32 v33, a165
    v_accvgpr_read_b32 v34, a166
    v_accvgpr_read_b32 v35, a167
    v_cvt_pk_bf16_f32 v36, v28, v29
    v_cvt_pk_bf16_f32 v37, v30, v31
    v_cvt_pk_bf16_f32 v38, v32, v33
    v_cvt_pk_bf16_f32 v39, v34, v35
    buffer_store_dwordx4 v[36:39], v1, s[4:7], s30 offen offset:1024 sc1
    v_accvgpr_read_b32 v40, a136
    v_accvgpr_read_b32 v41, a137
    v_accvgpr_read_b32 v42, a138
    v_accvgpr_read_b32 v43, a139
    v_accvgpr_read_b32 v44, a168
    v_accvgpr_read_b32 v45, a169
    v_accvgpr_read_b32 v46, a170
    v_accvgpr_read_b32 v47, a171
    v_cvt_pk_bf16_f32 v48, v40, v41
    v_cvt_pk_bf16_f32 v49, v42, v43
    v_cvt_pk_bf16_f32 v50, v44, v45
    v_cvt_pk_bf16_f32 v51, v46, v47
    buffer_store_dwordx4 v[48:51], v1, s[4:7], s30 offen offset:2048 sc1
    v_accvgpr_read_b32 v52, a140
    v_accvgpr_read_b32 v53, a141
    v_accvgpr_read_b32 v54, a142
    v_accvgpr_read_b32 v55, a143
    v_accvgpr_read_b32 v56, a172
    v_accvgpr_read_b32 v57, a173
    v_accvgpr_read_b32 v58, a174
    v_accvgpr_read_b32 v59, a175
    v_cvt_pk_bf16_f32 v60, v52, v53
    v_cvt_pk_bf16_f32 v61, v54, v55
    v_cvt_pk_bf16_f32 v62, v56, v57
    v_cvt_pk_bf16_f32 v63, v58, v59
    buffer_store_dwordx4 v[60:63], v1, s[4:7], s30 offen offset:3072 sc1
    s_add_u32 s30, s30, 4096
    v_accvgpr_read_b32 v16, a144
    v_accvgpr_read_b32 v17, a145
    v_accvgpr_read_b32 v18, a146
    v_accvgpr_read_b32 v19, a147
    v_accvgpr_read_b32 v20, a176
    v_accvgpr_read_b32 v21, a177
    v_accvgpr_read_b32 v22, a178
    v_accvgpr_read_b32 v23, a179
    v_cvt_pk_bf16_f32 v24, v16, v17
    v_cvt_pk_bf16_f32 v25, v18, v19
    v_cvt_pk_bf16_f32 v26, v20, v21
    v_cvt_pk_bf16_f32 v27, v22, v23
    buffer_store_dwordx4 v[24:27], v1, s[4:7], s30 offen offset:0 sc1
    v_accvgpr_read_b32 v28, a148
    v_accvgpr_read_b32 v29, a149
    v_accvgpr_read_b32 v30, a150
    v_accvgpr_read_b32 v31, a151
    v_accvgpr_read_b32 v32, a180
    v_accvgpr_read_b32 v33, a181
    v_accvgpr_read_b32 v34, a182
    v_accvgpr_read_b32 v35, a183
    v_cvt_pk_bf16_f32 v36, v28, v29
    v_cvt_pk_bf16_f32 v37, v30, v31
    v_cvt_pk_bf16_f32 v38, v32, v33
    v_cvt_pk_bf16_f32 v39, v34, v35
    buffer_store_dwordx4 v[36:39], v1, s[4:7], s30 offen offset:1024 sc1
    v_accvgpr_read_b32 v40, a152
    v_accvgpr_read_b32 v41, a153
    v_accvgpr_read_b32 v42, a154
    v_accvgpr_read_b32 v43, a155
    v_accvgpr_read_b32 v44, a184
    v_accvgpr_read_b32 v45, a185
    v_accvgpr_read_b32 v46, a186
    v_accvgpr_read_b32 v47, a187
    v_cvt_pk_bf16_f32 v48, v40, v41
    v_cvt_pk_bf16_f32 v49, v42, v43
    v_cvt_pk_bf16_f32 v50, v44, v45
    v_cvt_pk_bf16_f32 v51, v46, v47
    buffer_store_dwordx4 v[48:51], v1, s[4:7], s30 offen offset:2048 sc1
    v_accvgpr_read_b32 v52, a156
    v_accvgpr_read_b32 v53, a157
    v_accvgpr_read_b32 v54, a158
    v_accvgpr_read_b32 v55, a159
    v_accvgpr_read_b32 v56, a188
    v_accvgpr_read_b32 v57, a189
    v_accvgpr_read_b32 v58, a190
    v_accvgpr_read_b32 v59, a191
    v_cvt_pk_bf16_f32 v60, v52, v53
    v_cvt_pk_bf16_f32 v61, v54, v55
    v_cvt_pk_bf16_f32 v62, v56, v57
    v_cvt_pk_bf16_f32 v63, v58, v59
    buffer_store_dwordx4 v[60:63], v1, s[4:7], s30 offen offset:3072 sc1
    s_add_u32 s30, s30, 258048
    v_accvgpr_read_b32 v16, a192
    v_accvgpr_read_b32 v17, a193
    v_accvgpr_read_b32 v18, a194
    v_accvgpr_read_b32 v19, a195
    v_accvgpr_read_b32 v20, a224
    v_accvgpr_read_b32 v21, a225
    v_accvgpr_read_b32 v22, a226
    v_accvgpr_read_b32 v23, a227
    v_cvt_pk_bf16_f32 v24, v16, v17
    v_cvt_pk_bf16_f32 v25, v18, v19
    v_cvt_pk_bf16_f32 v26, v20, v21
    v_cvt_pk_bf16_f32 v27, v22, v23
    buffer_store_dwordx4 v[24:27], v1, s[4:7], s30 offen offset:0 sc1
    v_accvgpr_read_b32 v28, a196
    v_accvgpr_read_b32 v29, a197
    v_accvgpr_read_b32 v30, a198
    v_accvgpr_read_b32 v31, a199
    v_accvgpr_read_b32 v32, a228
    v_accvgpr_read_b32 v33, a229
    v_accvgpr_read_b32 v34, a230
    v_accvgpr_read_b32 v35, a231
    v_cvt_pk_bf16_f32 v36, v28, v29
    v_cvt_pk_bf16_f32 v37, v30, v31
    v_cvt_pk_bf16_f32 v38, v32, v33
    v_cvt_pk_bf16_f32 v39, v34, v35
    buffer_store_dwordx4 v[36:39], v1, s[4:7], s30 offen offset:1024 sc1
    v_accvgpr_read_b32 v40, a200
    v_accvgpr_read_b32 v41, a201
    v_accvgpr_read_b32 v42, a202
    v_accvgpr_read_b32 v43, a203
    v_accvgpr_read_b32 v44, a232
    v_accvgpr_read_b32 v45, a233
    v_accvgpr_read_b32 v46, a234
    v_accvgpr_read_b32 v47, a235
    v_cvt_pk_bf16_f32 v48, v40, v41
    v_cvt_pk_bf16_f32 v49, v42, v43
    v_cvt_pk_bf16_f32 v50, v44, v45
    v_cvt_pk_bf16_f32 v51, v46, v47
    buffer_store_dwordx4 v[48:51], v1, s[4:7], s30 offen offset:2048 sc1
    v_accvgpr_read_b32 v52, a204
    v_accvgpr_read_b32 v53, a205
    v_accvgpr_read_b32 v54, a206
    v_accvgpr_read_b32 v55, a207
    v_accvgpr_read_b32 v56, a236
    v_accvgpr_read_b32 v57, a237
    v_accvgpr_read_b32 v58, a238
    v_accvgpr_read_b32 v59, a239
    v_cvt_pk_bf16_f32 v60, v52, v53
    v_cvt_pk_bf16_f32 v61, v54, v55
    v_cvt_pk_bf16_f32 v62, v56, v57
    v_cvt_pk_bf16_f32 v63, v58, v59
    buffer_store_dwordx4 v[60:63], v1, s[4:7], s30 offen offset:3072 sc1
    s_add_u32 s30, s30, 4096
    v_accvgpr_read_b32 v16, a208
    v_accvgpr_read_b32 v17, a209
    v_accvgpr_read_b32 v18, a210
    v_accvgpr_read_b32 v19, a211
    v_accvgpr_read_b32 v20, a240
    v_accvgpr_read_b32 v21, a241
    v_accvgpr_read_b32 v22, a242
    v_accvgpr_read_b32 v23, a243
    v_cvt_pk_bf16_f32 v24, v16, v17
    v_cvt_pk_bf16_f32 v25, v18, v19
    v_cvt_pk_bf16_f32 v26, v20, v21
    v_cvt_pk_bf16_f32 v27, v22, v23
    buffer_store_dwordx4 v[24:27], v1, s[4:7], s30 offen offset:0 sc1
    v_accvgpr_read_b32 v28, a212
    v_accvgpr_read_b32 v29, a213
    v_accvgpr_read_b32 v30, a214
    v_accvgpr_read_b32 v31, a215
    v_accvgpr_read_b32 v32, a244
    v_accvgpr_read_b32 v33, a245
    v_accvgpr_read_b32 v34, a246
    v_accvgpr_read_b32 v35, a247
    v_cvt_pk_bf16_f32 v36, v28, v29
    v_cvt_pk_bf16_f32 v37, v30, v31
    v_cvt_pk_bf16_f32 v38, v32, v33
    v_cvt_pk_bf16_f32 v39, v34, v35
    buffer_store_dwordx4 v[36:39], v1, s[4:7], s30 offen offset:1024 sc1
    v_accvgpr_read_b32 v40, a216
    v_accvgpr_read_b32 v41, a217
    v_accvgpr_read_b32 v42, a218
    v_accvgpr_read_b32 v43, a219
    v_accvgpr_read_b32 v44, a248
    v_accvgpr_read_b32 v45, a249
    v_accvgpr_read_b32 v46, a250
    v_accvgpr_read_b32 v47, a251
    v_cvt_pk_bf16_f32 v48, v40, v41
    v_cvt_pk_bf16_f32 v49, v42, v43
    v_cvt_pk_bf16_f32 v50, v44, v45
    v_cvt_pk_bf16_f32 v51, v46, v47
    buffer_store_dwordx4 v[48:51], v1, s[4:7], s30 offen offset:2048 sc1
    v_accvgpr_read_b32 v52, a220
    v_accvgpr_read_b32 v53, a221
    v_accvgpr_read_b32 v54, a222
    v_accvgpr_read_b32 v55, a223
    v_accvgpr_read_b32 v56, a252
    v_accvgpr_read_b32 v57, a253
    v_accvgpr_read_b32 v58, a254
    v_accvgpr_read_b32 v59, a255
    v_cvt_pk_bf16_f32 v60, v52, v53
    v_cvt_pk_bf16_f32 v61, v54, v55
    v_cvt_pk_bf16_f32 v62, v56, v57
    v_cvt_pk_bf16_f32 v63, v58, v59
    buffer_store_dwordx4 v[60:63], v1, s[4:7], s30 offen offset:3072 sc1
    s_add_u32 s30, s30, 258048
    s_branch wk_cnt
wk_p2:
    s_bfe_u32 s18, s17, 0x40001
    s_lshr_b32 s16, s17, 5
    s_lshl_b32 s16, s16, 1
    s_and_b32 s20, s17, 1
    s_add_u32 s16, s16, s20
    s_sub_u32 s16, 11, s16
    s_cmp_ge_u32 s16, 10
    s_cbranch_scc1 p2_end
    s_mov_b32 s34, 200000
p2_next:
    s_lshr_b32 s20, s18, 3
    s_lshl_b32 s20, s20, 2
    v_mov_b32 v4, 0
    v_and_b32 v5, 1, v0
    v_mul_u32_u24 v5, 5120, v5
    s_mul_i32 s21, s18, 20480
    s_add_u32 s21, s21, 121686016
    s_mov_b32 s22, 1966112
    s_add_u32 s80, s80, 4
    s_cmp_lg_u32 s3, 0
    s_cbranch_scc1 p2_a_ok
p2_a:
    buffer_load_dword v6, v4, s[72:75], s20 offen sc1
    s_waitcnt vmcnt(0)
    v_cmp_ne_u32 vcc, s22, v6
    s_cbranch_vccz p2_a_ok
    s_sleep 6
    s_sub_u32 s34, s34, 1
    s_cbranch_scc0 p2_a
    s_endpgm
p2_a_ok:
    s_barrier
    s_mul_i32 s50, s18, 372736
    s_add_u32 s50, s50, 83886080
    s_add_u32 s51, s50, 186368
    s_mul_i32 s52, s16, 745472
    s_add_u32 s52, s52, 24117248
    s_add_u32 s53, s52, 186368
    s_add_u32 s54, s52, 372736
    s_add_u32 s55, s52, 559104
    s_lshl_b32 s20, s3, 10
    s_add_u32 s20, s20, 0x20000
    v_add_u32 v12, s20, v1
    s_lshl_b32 s20, s3, 15
    v_add_u32 v13, s20, v1
    s_mul_i32 s56, s3, 40960
    v_add_u32 v15, s56, v1
    s_cmp_ge_u32 s3, 2
    s_cselect_b32 s20, 0x70000000, 0
    v_accvgpr_write_b32 a0, 0
    v_accvgpr_write_b32 a1, 0
    v_accvgpr_write_b32 a2, 0
    v_accvgpr_write_b32 a3, 0
    v_accvgpr_write_b32 a4, 0
    v_accvgpr_write_b32 a5, 0
    v_accvgpr_write_b32 a6, 0
    v_accvgpr_write_b32 a7, 0
    v_accvgpr_write_b32 a8, 0
    v_accvgpr_write_b32 a9, 0
    v_accvgpr_write_b32 a10, 0
    v_accvgpr_write_b32 a11, 0
    v_accvgpr_write_b32 a12, 0
    v_accvgpr_write_b32 a13, 0
    v_accvgpr_write_b32 a14, 0
    v_accvgpr_write_b32 a15, 0
    v_accvgpr_write_b32 a16, 0
    v_accvgpr_write_b32 a17, 0
    v_accvgpr_write_b32 a18, 0
    v_accvgpr_write_b32 a19, 0
    v_accvgpr_write_b32 a20, 0
    v_accvgpr_write_b32 a21, 0
    v_accvgpr_write_b32 a22, 0
    v_accvgpr_write_b32 a23, 0
    v_accvgpr_write_b32 a24, 0
    v_accvgpr_write_b32 a25, 0
    v_accvgpr_write_b32 a26, 0
    v_accvgpr_write_b32 a27, 0
    v_accvgpr_write_b32 a28, 0
    v_accvgpr_write_b32 a29, 0
    v_accvgpr_write_b32 a30, 0
    v_accvgpr_write_b32 a31, 0
    buffer_load_dwordx4 v[16:19], v12, s[4:7], s50 offen offset:0
    buffer_load_dwordx4 v[20:23], v12, s[4:7], s51 offen offset:0
    buffer_load_dwordx4 v[24:27], v12, s[4:7], s52 offen offset:0
    buffer_load_dwordx4 v[28:31], v12, s[4:7], s53 offen offset:0
    buffer_load_dwordx4 v[32:35], v12, s[4:7], s54 offen offset:0
    buffer_load_dwordx4 v[36:39], v12, s[4:7], s55 offen offset:0
    v_add_u32 v12, 4096, v12
    buffer_load_dwordx4 v[40:43], v12, s[4:7], s50 offen offset:0
    buffer_load_dwordx4 v[44:47], v12, s[4:7], s51 offen offset:0
    buffer_load_dwordx4 v[48:51], v12, s[4:7], s52 offen offset:0
    buffer_load_dwordx4 v[52:55], v12, s[4:7], s53 offen offset:0
    buffer_load_dwordx4 v[56:59], v12, s[4:7], s54 offen offset:0
    buffer_load_dwordx4 v[60:63], v12, s[4:7], s55 offen offset:0
    v_add_u32 v12, 4096, v12
    buffer_load_dwordx4 v[64:67], v12, s[4:7], s50 offen offset:0
    buffer_load_dwordx4 v[68:71], v12, s[4:7], s51 offen offset:0
    buffer_load_dwordx4 v[72:75], v12, s[4:7], s52 offen offset:0
    buffer_load_dwordx4 v[76:79], v12, s[4:7], s53 offen offset:0
    buffer_load_dwordx4 v[80:83], v12, s[4:7], s54 offen offset:0
    buffer_load_dwordx4 v[84:87], v12, s[4:7], s55 offen offset:0
    v_add_u32 v12, 4096, v12
    buffer_load_dwordx4 v[88:91], v12, s[4:7], s50 offen offset:0
    buffer_load_dwordx4 v[92:95], v12, s[4:7], s51 offen offset:0
    buffer_load_dwordx4 v[96:99], v12, s[4:7], s52 offen offset:0
    buffer_load_dwordx4 v[100:103], v12, s[4:7], s53 offen offset:0
    buffer_load_dwordx4 v[104:107], v12, s[4:7], s54 offen offset:0
    buffer_load_dwordx4 v[108:111], v12, s[4:7], s55 offen offset:0
    v_add_u32 v12, 4096, v12
    buffer_load_dwordx4 v[112:115], v12, s[4:7], s50 offen offset:0
    buffer_load_dwordx4 v[116:119], v12, s[4:7], s51 offen offset:0
    buffer_load_dwordx4 v[120:123], v12, s[4:7], s52 offen offset:0
    buffer_load_dwordx4 v[124:127], v12, s[4:7], s53 offen offset:0
    buffer_load_dwordx4 v[128:131], v12, s[4:7], s54 offen offset:0
    buffer_load_dwordx4 v[132:135], v12, s[4:7], s55 offen offset:0
    v_add_u32 v12, 4096, v12
    buffer_load_dwordx4 v[136:139], v12, s[4:7], s50 offen offset:0
    buffer_load_dwordx4 v[140:143], v12, s[4:7], s51 offen offset:0
    buffer_load_dwordx4 v[144:147], v12, s[4:7], s52 offen offset:0
    buffer_load_dwordx4 v[148:151], v12, s[4:7], s53 offen offset:0
    buffer_load_dwordx4 v[152:155], v12, s[4:7], s54 offen offset:0
    buffer_load_dwordx4 v[156:159], v12, s[4:7], s55 offen offset:0
    v_add_u32 v12, 4096, v12
    buffer_load_dwordx4 v[160:163], v12, s[4:7], s50 offen offset:0
    buffer_load_dwordx4 v[164:167], v12, s[4:7], s51 offen offset:0
    buffer_load_dwordx4 v[168:171], v12, s[4:7], s52 offen offset:0
    buffer_load_dwordx4 v[172:175], v12, s[4:7], s53 offen offset:0
    buffer_load_dwordx4 v[176:179], v12, s[4:7], s54 offen offset:0
    buffer_load_dwordx4 v[180:183], v12, s[4:7], s55 offen offset:0
    v_add_u32 v12, 4096, v12
    s_waitcnt vmcnt(36)
    v_mfma_f32_16x16x32_bf16 a[0:3], v[24:27], v[16:19], a[0:3]
    v_mfma_f32_16x16x32_bf16 a[4:7], v[28:31], v[16:19], a[4:7]
    v_mfma_f32_16x16x32_bf16 a[8:11], v[32:35], v[16:19], a[8:11]
    v_mfma_f32_16x16x32_bf16 a[12:15], v[36:39], v[16:19], a[12:15]
    v_mfma_f32_16x16x32_bf16 a[16:19], v[24:27], v[20:23], a[16:19]
    v_mfma_f32_16x16x32_bf16 a[20:23], v[28:31], v[20:23], a[20:23]
    v_mfma_f32_16x16x32_bf16 a[24:27], v[32:35], v[20:23], a[24:27]
    v_mfma_f32_16x16x32_bf16 a[28:31], v[36:39], v[20:23], a[28:31]
    s_waitcnt vmcnt(30)
    v_mfma_f32_16x16x32_bf16 a[0:3], v[48:51], v[40:43], a[0:3]
    v_mfma_f32_16x16x32_bf16 a[4:7], v[52:55], v[40:43], a[4:7]
    v_mfma_f32_16x16x32_bf16 a[8:11], v[56:59], v[40:43], a[8:11]
    v_mfma_f32_16x16x32_bf16 a[12:15], v[60:63], v[40:43], a[12:15]
    v_mfma_f32_16x16x32_bf16 a[16:19], v[48:51], v[44:47], a[16:19]
    v_mfma_f32_16x16x32_bf16 a[20:23], v[52:55], v[44:47], a[20:23]
    v_mfma_f32_16x16x32_bf16 a[24:27], v[56:59], v[44:47], a[24:27]
    v_mfma_f32_16x16x32_bf16 a[28:31], v[60:63], v[44:47], a[28:31]
    s_waitcnt vmcnt(24)
    v_mfma_f32_16x16x32_bf16 a[0:3], v[72:75], v[64:67], a[0:3]
    v_mfma_f32_16x16x32_bf16 a[4:7], v[76:79], v[64:67], a[4:7]
    v_mfma_f32_16x16x32_bf16 a[8:11], v[80:83], v[64:67], a[8:11]
    v_mfma_f32_16x16x32_bf16 a[12:15], v[84:87], v[64:67], a[12:15]
    v_mfma_f32_16x16x32_bf16 a[16:19], v[72:75], v[68:71], a[16:19]
    v_mfma_f32_16x16x32_bf16 a[20:23], v[76:79], v[68:71], a[20:23]
    v_mfma_f32_16x16x32_bf16 a[24:27], v[80:83], v[68:71], a[24:27]
    v_mfma_f32_16x16x32_bf16 a[28:31], v[84:87], v[68:71], a[28:31]
    s_waitcnt vmcnt(18)
    v_mfma_f32_16x16x32_bf16 a[0:3], v[96:99], v[88:91], a[0:3]
    v_mfma_f32_16x16x32_bf16 a[4:7], v[100:103], v[88:91], a[4:7]
    v_mfma_f32_16x16x32_bf16 a[8:11], v[104:107], v[88:91], a[8:11]
    v_mfma_f32_16x16x32_bf16 a[12:15], v[108:111], v[88:91], a[12:15]
    v_mfma_f32_16x16x32_bf16 a[16:19], v[96:99], v[92:95], a[16:19]
    v_mfma_f32_16x16x32_bf16 a[20:23], v[100:103], v[92:95], a[20:23]
    v_mfma_f32_16x16x32_bf16 a[24:27], v[104:107], v[92:95], a[24:27]
    v_mfma_f32_16x16x32_bf16 a[28:31], v[108:111], v[92:95], a[28:31]
    s_waitcnt vmcnt(12)
    v_mfma_f32_16x16x32_bf16 a[0:3], v[120:123], v[112:115], a[0:3]
    v_mfma_f32_16x16x32_bf16 a[4:7], v[124:127], v[112:115], a[4:7]
    v_mfma_f32_16x16x32_bf16 a[8:11], v[128:131], v[112:115], a[8:11]
    v_mfma_f32_16x16x32_bf16 a[12:15], v[132:135], v[112:115], a[12:15]
    v_mfma_f32_16x16x32_bf16 a[16:19], v[120:123], v[116:119], a[16:19]
    v_mfma_f32_16x16x32_bf16 a[20:23], v[124:127], v[116:119], a[20:23]
    v_mfma_f32_16x16x32_bf16 a[24:27], v[128:131], v[116:119], a[24:27]
    v_mfma_f32_16x16x32_bf16 a[28:31], v[132:135], v[116:119], a[28:31]
    s_waitcnt vmcnt(6)
    v_mfma_f32_16x16x32_bf16 a[0:3], v[144:147], v[136:139], a[0:3]
    v_mfma_f32_16x16x32_bf16 a[4:7], v[148:151], v[136:139], a[4:7]
    v_mfma_f32_16x16x32_bf16 a[8:11], v[152:155], v[136:139], a[8:11]
    v_mfma_f32_16x16x32_bf16 a[12:15], v[156:159], v[136:139], a[12:15]
    v_mfma_f32_16x16x32_bf16 a[16:19], v[144:147], v[140:143], a[16:19]
    v_mfma_f32_16x16x32_bf16 a[20:23], v[148:151], v[140:143], a[20:23]
    v_mfma_f32_16x16x32_bf16 a[24:27], v[152:155], v[140:143], a[24:27]
    v_mfma_f32_16x16x32_bf16 a[28:31], v[156:159], v[140:143], a[28:31]
    s_waitcnt vmcnt(0)
    v_mfma_f32_16x16x32_bf16 a[0:3], v[168:171], v[160:163], a[0:3]
    v_mfma_f32_16x16x32_bf16 a[4:7], v[172:175], v[160:163], a[4:7]
    v_mfma_f32_16x16x32_bf16 a[8:11], v[176:179], v[160:163], a[8:11]
    v_mfma_f32_16x16x32_bf16 a[12:15], v[180:183], v[160:163], a[12:15]
    v_mfma_f32_16x16x32_bf16 a[16:19], v[168:171], v[164:167], a[16:19]
    v_mfma_f32_16x16x32_bf16 a[20:23], v[172:175], v[164:167], a[20:23]
    v_mfma_f32_16x16x32_bf16 a[24:27], v[176:179], v[164:167], a[24:27]
    v_mfma_f32_16x16x32_bf16 a[28:31], v[180:183], v[164:167], a[28:31]
    buffer_load_dwordx4 v[16:19], v12, s[4:7], s50 offen offset:0
    buffer_load_dwordx4 v[20:23], v12, s[4:7], s51 offen offset:0
    buffer_load_dwordx4 v[24:27], v12, s[4:7], s52 offen offset:0
    buffer_load_dwordx4 v[28:31], v12, s[4:7], s53 offen offset:0
    buffer_load_dwordx4 v[32:35], v12, s[4:7], s54 offen offset:0
    buffer_load_dwordx4 v[36:39], v12, s[4:7], s55 offen offset:0
    v_add_u32 v12, 4096, v12
    buffer_load_dwordx4 v[40:43], v12, s[4:7], s50 offen offset:0
    buffer_load_dwordx4 v[44:47], v12, s[4:7], s51 offen offset:0
    buffer_load_dwordx4 v[48:51], v12, s[4:7], s52 offen offset:0
    buffer_load_dwordx4 v[52:55], v12, s[4:7], s53 offen offset:0
    buffer_load_dwordx4 v[56:59], v12, s[4:7], s54 offen offset:0
    buffer_load_dwordx4 v[60:63], v12, s[4:7], s55 offen offset:0
    v_add_u32 v12, 4096, v12
    buffer_load_dwordx4 v[64:67], v12, s[4:7], s50 offen offset:0
    buffer_load_dwordx4 v[68:71], v12, s[4:7], s51 offen offset:0
    buffer_load_dwordx4 v[72:75], v12, s[4:7], s52 offen offset:0
    buffer_load_dwordx4 v[76:79], v12, s[4:7], s53 offen offset:0
    buffer_load_dwordx4 v[80:83], v12, s[4:7], s54 offen offset:0
    buffer_load_dwordx4 v[84:87], v12, s[4:7], s55 offen offset:0
    v_add_u32 v12, 4096, v12
    buffer_load_dwordx4 v[88:91], v12, s[4:7], s50 offen offset:0
    buffer_load_dwordx4 v[92:95], v12, s[4:7], s51 offen offset:0
    buffer_load_dwordx4 v[96:99], v12, s[4:7], s52 offen offset:0
    buffer_load_dwordx4 v[100:103], v12, s[4:7], s53 offen offset:0
    buffer_load_dwordx4 v[104:107], v12, s[4:7], s54 offen offset:0
    buffer_load_dwordx4 v[108:111], v12, s[4:7], s55 offen offset:0
    v_add_u32 v12, 4096, v12
    buffer_load_dwordx4 v[112:115], v12, s[4:7], s50 offen offset:0
    buffer_load_dwordx4 v[116:119], v12, s[4:7], s51 offen offset:0
    buffer_load_dwordx4 v[120:123], v12, s[4:7], s52 offen offset:0
    buffer_load_dwordx4 v[124:127], v12, s[4:7], s53 offen offset:0
    buffer_load_dwordx4 v[128:131], v12, s[4:7], s54 offen offset:0
    buffer_load_dwordx4 v[132:135], v12, s[4:7], s55 offen offset:0
    v_add_u32 v12, 4096, v12
    buffer_load_dwordx4 v[136:139], v12, s[4:7], s50 offen offset:0
    buffer_load_dwordx4 v[140:143], v12, s[4:7], s51 offen offset:0
    buffer_load_dwordx4 v[144:147], v12, s[4:7], s52 offen offset:0
    buffer_load_dwordx4 v[148:151], v12, s[4:7], s53 offen offset:0
    buffer_load_dwordx4 v[152:155], v12, s[4:7], s54 offen offset:0
    buffer_load_dwordx4 v[156:159], v12, s[4:7], s55 offen offset:0
    v_add_u32 v12, 4096, v12
    v_add_u32 v12, s20, v12
    buffer_load_dwordx4 v[160:163], v12, s[4:7], s50 offen offset:0
    buffer_load_dwordx4 v[164:167], v12, s[4:7], s51 offen offset:0
    buffer_load_dwordx4 v[168:171], v12, s[4:7], s52 offen offset:0
    buffer_load_dwordx4 v[172:175], v12, s[4:7], s53 offen offset:0
    buffer_load_dwordx4 v[176:179], v12, s[4:7], s54 offen offset:0
    buffer_load_dwordx4 v[180:183], v12, s[4:7], s55 offen offset:0
    v_add_u32 v12, 4096, v12
    s_waitcnt vmcnt(36)
    v_mfma_f32_16x16x32_bf16 a[0:3], v[24:27], v[16:19], a[0:3]
    v_mfma_f32_16x16x32_bf16 a[4:7], v[28:31], v[16:19], a[4:7]
    v_mfma_f32_16x16x32_bf16 a[8:11], v[32:35], v[16:19], a[8:11]
    v_mfma_f32_16x16x32_bf16 a[12:15], v[36:39], v[16:19], a[12:15]
    v_mfma_f32_16x16x32_bf16 a[16:19], v[24:27], v[20:23], a[16:19]
    v_mfma_f32_16x16x32_bf16 a[20:23], v[28:31], v[20:23], a[20:23]
    v_mfma_f32_16x16x32_bf16 a[24:27], v[32:35], v[20:23], a[24:27]
    v_mfma_f32_16x16x32_bf16 a[28:31], v[36:39], v[20:23], a[28:31]
    s_waitcnt vmcnt(30)
    v_mfma_f32_16x16x32_bf16 a[0:3], v[48:51], v[40:43], a[0:3]
    v_mfma_f32_16x16x32_bf16 a[4:7], v[52:55], v[40:43], a[4:7]
    v_mfma_f32_16x16x32_bf16 a[8:11], v[56:59], v[40:43], a[8:11]
    v_mfma_f32_16x16x32_bf16 a[12:15], v[60:63], v[40:43], a[12:15]
    v_mfma_f32_16x16x32_bf16 a[16:19], v[48:51], v[44:47], a[16:19]
    v_mfma_f32_16x16x32_bf16 a[20:23], v[52:55], v[44:47], a[20:23]
    v_mfma_f32_16x16x32_bf16 a[24:27], v[56:59], v[44:47], a[24:27]
    v_mfma_f32_16x16x32_bf16 a[28:31], v[60:63], v[44:47], a[28:31]
    s_waitcnt vmcnt(24)
    v_mfma_f32_16x16x32_bf16 a[0:3], v[72:75], v[64:67], a[0:3]
    v_mfma_f32_16x16x32_bf16 a[4:7], v[76:79], v[64:67], a[4:7]
    v_mfma_f32_16x16x32_bf16 a[8:11], v[80:83], v[64:67], a[8:11]
    v_mfma_f32_16x16x32_bf16 a[12:15], v[84:87], v[64:67], a[12:15]
    v_mfma_f32_16x16x32_bf16 a[16:19], v[72:75], v[68:71], a[16:19]
    v_mfma_f32_16x16x32_bf16 a[20:23], v[76:79], v[68:71], a[20:23]
    v_mfma_f32_16x16x32_bf16 a[24:27], v[80:83], v[68:71], a[24:27]
    v_mfma_f32_16x16x32_bf16 a[28:31], v[84:87], v[68:71], a[28:31]
    s_waitcnt vmcnt(18)
    v_mfma_f32_16x16x32_bf16 a[0:3], v[96:99], v[88:91], a[0:3]
    v_mfma_f32_16x16x32_bf16 a[4:7], v[100:103], v[88:91], a[4:7]
    v_mfma_f32_16x16x32_bf16 a[8:11], v[104:107], v[88:91], a[8:11]
    v_mfma_f32_16x16x32_bf16 a[12:15], v[108:111], v[88:91], a[12:15]
    v_mfma_f32_16x16x32_bf16 a[16:19], v[96:99], v[92:95], a[16:19]
    v_mfma_f32_16x16x32_bf16 a[20:23], v[100:103], v[92:95], a[20:23]
    v_mfma_f32_16x16x32_bf16 a[24:27], v[104:107], v[92:95], a[24:27]
    v_mfma_f32_16x16x32_bf16 a[28:31], v[108:111], v[92:95], a[28:31]
    s_waitcnt vmcnt(12)
    v_mfma_f32_16x16x32_bf16 a[0:3], v[120:123], v[112:115], a[0:3]
    v_mfma_f32_16x16x32_bf16 a[4:7], v[124:127], v[112:115], a[4:7]
    v_mfma_f32_16x16x32_bf16 a[8:11], v[128:131], v[112:115], a[8:11]
    v_mfma_f32_16x16x32_bf16 a[12:15], v[132:135], v[112:115], a[12:15]
    v_mfma_f32_16x16x32_bf16 a[16:19], v[120:123], v[116:119], a[16:19]
    v_mfma_f32_16x16x32_bf16 a[20:23], v[124:127], v[116:119], a[20:23]
    v_mfma_f32_16x16x32_bf16 a[24:27], v[128:131], v[116:119], a[24:27]
    v_mfma_f32_16x16x32_bf16 a[28:31], v[132:135], v[116:119], a[28:31]
    s_waitcnt vmcnt(6)
    v_mfma_f32_16x16x32_bf16 a[0:3], v[144:147], v[136:139], a[0:3]
    v_mfma_f32_16x16x32_bf16 a[4:7], v[148:151], v[136:139], a[4:7]
    v_mfma_f32_16x16x32_bf16 a[8:11], v[152:155], v[136:139], a[8:11]
    v_mfma_f32_16x16x32_bf16 a[12:15], v[156:159], v[136:139], a[12:15]
    v_mfma_f32_16x16x32_bf16 a[16:19], v[144:147], v[140:143], a[16:19]
    v_mfma_f32_16x16x32_bf16 a[20:23], v[148:151], v[140:143], a[20:23]
    v_mfma_f32_16x16x32_bf16 a[24:27], v[152:155], v[140:143], a[24:27]
    v_mfma_f32_16x16x32_bf16 a[28:31], v[156:159], v[140:143], a[28:31]
    s_waitcnt vmcnt(0)
    v_mfma_f32_16x16x32_bf16 a[0:3], v[168:171], v[160:163], a[0:3]
    v_mfma_f32_16x16x32_bf16 a[4:7], v[172:175], v[160:163], a[4:7]
    v_mfma_f32_16x16x32_bf16 a[8:11], v[176:179], v[160:163], a[8:11]
    v_mfma_f32_16x16x32_bf16 a[12:15], v[180:183], v[160:163], a[12:15]
    v_mfma_f32_16x16x32_bf16 a[16:19], v[168:171], v[164:167], a[16:19]
    v_mfma_f32_16x16x32_bf16 a[20:23], v[172:175], v[164:167], a[20:23]
    v_mfma_f32_16x16x32_bf16 a[24:27], v[176:179], v[164:167], a[24:27]
    v_mfma_f32_16x16x32_bf16 a[28:31], v[180:183], v[164:167], a[28:31]
    v_add_u32 v14, 8192, v13
    buffer_load_dwordx4 a[32:35], v14, s[4:7], s52 offen offset:0
    buffer_load_dwordx4 a[36:39], v14, s[4:7], s53 offen offset:0
    buffer_load_dwordx4 a[40:43], v14, s[4:7], s54 offen offset:0
    buffer_load_dwordx4 a[44:47], v14, s[4:7], s55 offen offset:0
    buffer_load_dwordx4 a[48:51], v14, s[4:7], s52 offen offset:1024
    buffer_load_dwordx4 a[52:55], v14, s[4:7], s53 offen offset:1024
    buffer_load_dwordx4 a[56:59], v14, s[4:7], s54 offen offset:1024
    buffer_load_dwordx4 a[60:63], v14, s[4:7], s55 offen offset:1024
    buffer_load_dwordx4 a[64:67], v14, s[4:7], s52 offen offset:2048
    buffer_load_dwordx4 a[68:71], v14, s[4:7], s53 offen offset:2048
    buffer_load_dwordx4 a[72:75], v14, s[4:7], s54 offen offset:2048
    buffer_load_dwordx4 a[76:79], v14, s[4:7], s55 offen offset:2048
    buffer_load_dwordx4 a[80:83], v14, s[4:7], s52 offen offset:3072
    buffer_load_dwordx4 a[84:87], v14, s[4:7], s53 offen offset:3072
    buffer_load_dwordx4 a[88:91], v14, s[4:7], s54 offen offset:3072
    buffer_load_dwordx4 a[92:95], v14, s[4:7], s55 offen offset:3072
    v_add_u32 v14, 4096, v14
    s_waitcnt vmcnt(40)
    buffer_load_dwordx4 a[96:99], v14, s[4:7], s52 offen offset:0
    buffer_load_dwordx4 a[100:103], v14, s[4:7], s53 offen offset:0
    buffer_load_dwordx4 a[104:107], v14, s[4:7], s54 offen offset:0
    buffer_load_dwordx4 a[108:111], v14, s[4:7], s55 offen offset:0
    buffer_load_dwordx4 a[112:115], v14, s[4:7], s52 offen offset:1024
    buffer_load_dwordx4 a[116:119], v14, s[4:7], s53 offen offset:1024
    buffer_load_dwordx4 a[120:123], v14, s[4:7], s54 offen offset:1024
    buffer_load_dwordx4 a[124:127], v14, s[4:7], s55 offen offset:1024
    buffer_load_dwordx4 a[128:131], v14, s[4:7], s52 offen offset:2048
    buffer_load_dwordx4 a[132:135], v14, s[4:7], s53 offen offset:2048
    buffer_load_dwordx4 a[136:139], v14, s[4:7], s54 offen offset:2048
    buffer_load_dwordx4 a[140:143], v14, s[4:7], s55 offen offset:2048
    buffer_load_dwordx4 a[144:147], v14, s[4:7], s52 offen offset:3072
    buffer_load_dwordx4 a[148:151], v14, s[4:7], s53 offen offset:3072
    buffer_load_dwordx4 a[152:155], v14, s[4:7], s54 offen offset:3072
    buffer_load_dwordx4 a[156:159], v14, s[4:7], s55 offen offset:3072
    v_add_u32 v14, 4096, v14
    s_waitcnt vmcnt(40)
    buffer_load_dwordx4 a[160:163], v14, s[4:7], s52 offen offset:0
    buffer_load_dwordx4 a[164:167], v14, s[4:7], s53 offen offset:0
    buffer_load_dwordx4 a[168:171], v14, s[4:7], s54 offen offset:0
    buffer_load_dwordx4 a[172:175], v14, s[4:7], s55 offen offset:0
    buffer_load_dwordx4 a[176:179], v14, s[4:7], s52 offen offset:1024
    buffer_load_dwordx4 a[180:183], v14, s[4:7], s53 offen offset:1024
    buffer_load_dwordx4 a[184:187], v14, s[4:7], s54 offen offset:1024
    buffer_load_dwordx4 a[188:191], v14, s[4:7], s55 offen offset:1024
    buffer_load_dwordx4 a[192:195], v14, s[4:7], s52 offen offset:2048
    buffer_load_dwordx4 a[196:199], v14, s[4:7], s53 offen offset:2048
    buffer_load_dwordx4 a[200:203], v14, s[4:7], s54 offen offset:2048
    buffer_load_dwordx4 a[204:207], v14, s[4:7], s55 offen offset:2048
    buffer_load_dwordx4 a[208:211], v14, s[4:7], s52 offen offset:3072
    buffer_load_dwordx4 a[212:215], v14, s[4:7], s53 offen offset:3072
    buffer_load_dwordx4 a[216:219], v14, s[4:7], s54 offen offset:3072
    buffer_load_dwordx4 a[220:223], v14, s[4:7], s55 offen offset:3072
    v_add_u32 v14, 4096, v14
    s_waitcnt vmcnt(40)
    buffer_load_dwordx4 a[224:227], v14, s[4:7], s52 offen offset:0
    buffer_load_dwordx4 a[228:231], v14, s[4:7], s53 offen offset:0
    buffer_load_dwordx4 a[232:235], v14, s[4:7], s54 offen offset:0
    buffer_load_dwordx4 a[236:239], v14, s[4:7], s55 offen offset:0
    buffer_load_dwordx4 a[240:243], v14, s[4:7], s52 offen offset:1024
    buffer_load_dwordx4 a[244:247], v14, s[4:7], s53 offen offset:1024
    buffer_load_dwordx4 a[248:251], v14, s[4:7], s54 offen offset:1024
    buffer_load_dwordx4 a[252:255], v14, s[4:7], s55 offen offset:1024
    s_add_u32 m0, s56, 0
    s_add_u32 s20, s52, 2048
    buffer_load_dwordx4 v14, s[4:7], s20 offen lds
    s_add_u32 m0, s56, 1024
    s_add_u32 s20, s53, 2048
    buffer_load_dwordx4 v14, s[4:7], s20 offen lds
    s_add_u32 m0, s56, 0
    s_nop 0
    buffer_load_dwordx4 v14, s[4:7], s54 offen offset:2048 lds
    s_add_u32 m0, s56, 1024
    s_nop 0
    buffer_load_dwordx4 v14, s[4:7], s55 offen offset:2048 lds
    s_add_u32 m0, s56, 1024
    s_nop 0
    buffer_load_dwordx4 v14, s[4:7], s52 offen offset:3072 lds
    s_add_u32 m0, s56, 2048
    s_nop 0
    buffer_load_dwordx4 v14, s[4:7], s53 offen offset:3072 lds
    s_add_u32 m0, s56, 3072
    s_nop 0
    buffer_load_dwordx4 v14, s[4:7], s54 offen offset:3072 lds
    s_add_u32 m0, s56, 4096
    s_nop 0
    buffer_load_dwordx4 v14, s[4:7], s55 offen offset:3072 lds
    v_add_u32 v14, 4096, v14
    s_waitcnt vmcnt(40)
    s_add_u32 m0, s56, 8192
    s_nop 0
    buffer_load_dwordx4 v14, s[4:7], s52 offen offset:0 lds
    s_add_u32 m0, s56, 9216
    s_nop 0
    buffer_load_dwordx4 v14, s[4:7], s53 offen offset:0 lds
    s_add_u32 m0, s56, 10240
    s_nop 0
    buffer_load_dwordx4 v14, s[4:7], s54 offen offset:0 lds
    s_add_u32 m0, s56, 11264
    s_nop 0
    buffer_load_dwordx4 v14, s[4:7], s55 offen offset:0 lds
    s_add_u32 m0, s56, 11264
    s_nop 0
    buffer_load_dwordx4 v14, s[4:7], s52 offen offset:1024 lds
    s_add_u32 m0, s56, 12288
    s_nop 0
    buffer_load_dwordx4 v14, s[4:7], s53 offen offset:1024 lds
    s_add_u32 m0, s56, 13312
    s_nop 0
    buffer_load_dwordx4 v14, s[4:7], s54 offen offset:1024 lds
    s_add_u32 m0, s56, 14336
    s_nop 0
    buffer_load_dwordx4 v14, s[4:7], s55 offen offset:1024 lds
    s_add_u32 m0, s56, 14336
    s_nop 0
    buffer_load_dwordx4 v14, s[4:7], s52 offen offset:2048 lds
    s_add_u32 m0, s56, 15360
    s_nop 0
    buffer_load_dwordx4 v14, s[4:7], s53 offen offset:2048 lds
    s_add_u32 m0, s56, 16384
    s_nop 0
    buffer_load_dwordx4 v14, s[4:7], s54 offen offset:2048 lds
    s_add_u32 m0, s56, 17408
    s_nop 0
    buffer_load_dwordx4 v14, s[4:7], s55 offen offset:2048 lds
    s_add_u32 m0, s56, 17408
    s_nop 0
    buffer_load_dwordx4 v14, s[4:7], s52 offen offset:3072 lds
    s_add_u32 m0, s56, 18432
    s_nop 0
    buffer_load_dwordx4 v14, s[4:7], s53 offen offset:3072 lds
    s_add_u32 m0, s56, 19456
    s_nop 0
    buffer_load_dwordx4 v14, s[4:7], s54 offen offset:3072 lds
    s_add_u32 m0, s56, 20480
    s_nop 0
    buffer_load_dwordx4 v14, s[4:7], s55 offen offset:3072 lds
    v_add_u32 v14, 4096, v14
    s_waitcnt vmcnt(40)
    s_add_u32 m0, s56, 24576
    s_nop 0
    buffer_load_dwordx4 v14, s[4:7], s52 offen offset:0 lds
    s_add_u32 m0, s56, 25600
    s_nop 0
    buffer_load_dwordx4 v14, s[4:7], s53 offen offset:0 lds
    s_add_u32 m0, s56, 26624
    s_nop 0
    buffer_load_dwordx4 v14, s[4:7], s54 offen offset:0 lds
    s_add_u32 m0, s56, 27648
    s_nop 0
    buffer_load_dwordx4 v14, s[4:7], s55 offen offset:0 lds
    s_add_u32 m0, s56, 27648
    s_nop 0
    buffer_load_dwordx4 v14, s[4:7], s52 offen offset:1024 lds
    s_add_u32 m0, s56, 28672
    s_nop 0
    buffer_load_dwordx4 v14, s[4:7], s53 offen offset:1024 lds
    s_add_u32 m0, s56, 29696
    s_nop 0
    buffer_load_dwordx4 v14, s[4:7], s54 offen offset:1024 lds
    s_add_u32 m0, s56, 30720
    s_nop 0
    buffer_load_dwordx4 v14, s[4:7], s55 offen offset:1024 lds
    s_add_u32 m0, s56, 30720
    s_nop 0
    buffer_load_dwordx4 v14, s[4:7], s52 offen offset:2048 lds
    s_add_u32 m0, s56, 31744
    s_nop 0
    buffer_load_dwordx4 v14, s[4:7], s53 offen offset:2048 lds
    s_add_u32 m0, s56, 32768
    s_nop 0
    buffer_load_dwordx4 v14, s[4:7], s54 offen offset:2048 lds
    s_add_u32 m0, s56, 33792
    s_nop 0
    buffer_load_dwordx4 v14, s[4:7], s55 offen offset:2048 lds
    s_add_u32 m0, s56, 33792
    s_nop 0
    buffer_load_dwordx4 v14, s[4:7], s52 offen offset:3072 lds
    s_add_u32 m0, s56, 34816
    s_nop 0
    buffer_load_dwordx4 v14, s[4:7], s53 offen offset:3072 lds
    s_add_u32 m0, s56, 35840
    s_nop 0
    buffer_load_dwordx4 v14, s[4:7], s54 offen offset:3072 lds
    s_add_u32 m0, s56, 36864
    s_nop 0
    buffer_load_dwordx4 v14, s[4:7], s55 offen offset:3072 lds
    v_add_u32 v14, 4096, v14
    s_waitcnt vmcnt(40)
    s_mov_b32 s57, s21
    s_cmp_ge_u32 s16, 8
    s_cbranch_scc1 p2_na
    s_waitcnt vmcnt(24)
    s_lshl_b32 s20, s16, 2
    s_lshl_b32 s21, s18, 5
    s_add_u32 s20, s20, s21
    s_add_u32 s20, s20, s3
    s_and_b32 s21, s20, 31
    s_lshr_b32 s22, s20, 5
    s_lshl_b32 s23, s22, 18
    s_lshl_b32 s24, s21, 12
    s_add_u32 s23, s23, s24
    s_add_u32 s40, s23, 33554432
    s_add_u32 s41, s23, 33685504
    s_add_u32 s42, s23, 50331648
    s_add_u32 s43, s23, 50462720
    s_lshl_b32 s44, s20, 12
    s_add_u32 s44, s44, 109051904
    s_lshl_b32 s45, s20, 13
    s_add_u32 s45, s45, 67108864
    s_add_u32 s46, s45, 4096
    s_lshl_b32 s47, s20, 11
    s_add_u32 s47, s47, 117440512
    s_mul_i32 s48, s22, 372736
    s_add_u32 s48, s48, s24
    s_add_u32 s48, s48, 83886080
    s_add_u32 s49, s48, 186368
    s_mov_b32 s59, 0x3e0293ee
    v_lshlrev_b32 v4, 2, v0
    v_lshlrev_b32 v5, 2, v2
    v_mov_b32 v6, 0xf149f2ca
    s_waitcnt lgkmcnt(0)
    buffer_load_dwordx4 v[16:19], v1, s[4:7], s40 offen offset:0
    buffer_load_dwordx4 v[20:23], v1, s[4:7], s40 offen offset:1024
    buffer_load_dwordx4 v[24:27], v1, s[4:7], s40 offen offset:2048
    buffer_load_dwordx4 v[28:31], v1, s[4:7], s40 offen offset:3072
    buffer_load_dwordx4 v[32:35], v1, s[4:7], s41 offen offset:0
    buffer_load_dwordx4 v[36:39], v1, s[4:7], s41 offen offset:1024
    buffer_load_dwordx4 v[40:43], v1, s[4:7], s41 offen offset:2048
    buffer_load_dwordx4 v[44:47], v1, s[4:7], s41 offen offset:3072
    buffer_load_dwordx4 v[48:51], v1, s[4:7], s42 offen offset:0
    buffer_load_dwordx4 v[52:55], v1, s[4:7], s42 offen offset:1024
    buffer_load_dwordx4 v[56:59], v1, s[4:7], s42 offen offset:2048
    buffer_load_dwordx4 v[60:63], v1, s[4:7], s42 offen offset:3072
    buffer_load_dwordx4 v[64:67], v1, s[4:7], s43 offen offset:0
    buffer_load_dwordx4 v[68:71], v1, s[4:7], s43 offen offset:1024
    buffer_load_dwordx4 v[72:75], v1, s[4:7], s43 offen offset:2048
    buffer_load_dwordx4 v[76:79], v1, s[4:7], s43 offen offset:3072
    buffer_load_dwordx4 v[96:99], v1, s[4:7], s45 offen offset:0
    buffer_load_dwordx4 v[100:103], v1, s[4:7], s45 offen offset:1024
    buffer_load_dwordx4 v[104:107], v1, s[4:7], s45 offen offset:2048
    buffer_load_dwordx4 v[108:111], v1, s[4:7], s45 offen offset:3072
    buffer_load_dwordx4 v[112:115], v1, s[4:7], s46 offen offset:0
    buffer_load_dwordx4 v[116:119], v1, s[4:7], s46 offen offset:1024
    buffer_load_dwordx4 v[120:123], v1, s[4:7], s46 offen offset:2048
    buffer_load_dwordx4 v[124:127], v1, s[4:7], s46 offen offset:3072
    v_and_b32 v8, 1, v0
    v_mul_u32_u24 v8, 5120, v8
    s_cmp_lt_u32 s18, 62
    s_cbranch_scc1 p2_b0
    v_and_b32 v8, 31, v0
    v_lshlrev_b32 v8, 6, v8
    s_lshl_b32 s57, s16, 11
    s_add_u32 s57, s57, 143589376
p2_b0:
    s_cmp_lg_u32 s3, 0
    s_cbranch_scc1 p2_b_ok
p2_b:
    buffer_load_dword v9, v8, s[4:7], s57 offen sc1
    s_waitcnt vmcnt(0)
    v_cmp_eq_u32 vcc, -1, v9
    s_cbranch_vccz p2_b_ok
    s_sleep 6
    s_sub_u32 s34, s34, 1
    s_cbranch_scc0 p2_b
    s_endpgm
p2_b_ok:
    s_barrier
    buffer_load_dwordx4 v[80:83], v1, s[4:7], s44 offen offset:0
    buffer_load_dwordx4 v[84:87], v1, s[4:7], s44 offen offset:1024
    buffer_load_dwordx4 v[88:91], v1, s[4:7], s44 offen offset:2048
    buffer_load_dwordx4 v[92:95], v1, s[4:7], s44 offen offset:3072
    buffer_load_dword v128, v4, s[4:7], s47 offen offset:0
    v_mov_b32 v129, 0
    buffer_load_dword v130, v4, s[4:7], s47 offen offset:256
    v_mov_b32 v131, 0
    buffer_load_dword v132, v4, s[4:7], s47 offen offset:512
    v_mov_b32 v133, 0
    buffer_load_dword v134, v4, s[4:7], s47 offen offset:768
    v_mov_b32 v135, 0
    buffer_load_dword v136, v4, s[4:7], s47 offen offset:1024
    v_mov_b32 v137, 0
    buffer_load_dword v138, v4, s[4:7], s47 offen offset:1280
    v_mov_b32 v139, 0
    buffer_load_dword v140, v4, s[4:7], s47 offen offset:1536
    v_mov_b32 v141, 0
    buffer_load_dword v142, v4, s[4:7], s47 offen offset:1792
    v_mov_b32 v143, 0
    v_add_u32 v7, 0, v5
    v_cmp_le_u32 s[60:61], v7, v3
    v_add_u32 v7, 1, v5
    v_cmp_le_u32 s[62:63], v7, v3
    v_add_u32 v7, 2, v5
    v_cmp_le_u32 s[64:65], v7, v3
    v_add_u32 v7, 3, v5
    v_cmp_le_u32 s[66:67], v7, v3
    s_waitcnt vmcnt(8)
    v_mfma_f32_16x16x32_bf16 v[144:147], v[80:83], v[16:19], 0
    v_mfma_f32_16x16x32_bf16 v[148:151], v[48:51], v[16:19], 0
    v_mfma_f32_16x16x32_bf16 v[152:155], v[80:83], v[32:35], 0
    v_mfma_f32_16x16x32_bf16 v[156:159], v[48:51], v[32:35], 0
    v_mfma_f32_16x16x32_bf16 v[160:163], v[64:67], v[32:35], 0
    v_mfma_f32_16x16x32_bf16 v[144:147], v[84:87], v[20:23], v[144:147]
    v_mfma_f32_16x16x32_bf16 v[148:151], v[52:55], v[20:23], v[148:151]
    v_mfma_f32_16x16x32_bf16 v[152:155], v[84:87], v[36:39], v[152:155]
    v_mfma_f32_16x16x32_bf16 v[156:159], v[52:55], v[36:39], v[156:159]
    v_mfma_f32_16x16x32_bf16 v[160:163], v[68:71], v[36:39], v[160:163]
    v_mfma_f32_16x16x32_bf16 v[144:147], v[88:91], v[24:27], v[144:147]
    v_mfma_f32_16x16x32_bf16 v[148:151], v[56:59], v[24:27], v[148:151]
    v_mfma_f32_16x16x32_bf16 v[152:155], v[88:91], v[40:43], v[152:155]
    v_mfma_f32_16x16x32_bf16 v[156:159], v[56:59], v[40:43], v[156:159]
    v_mfma_f32_16x16x32_bf16 v[160:163], v[72:75], v[40:43], v[160:163]
    v_mfma_f32_16x16x32_bf16 v[144:147], v[92:95], v[28:31], v[144:147]
    v_mfma_f32_16x16x32_bf16 v[148:151], v[60:63], v[28:31], v[148:151]
    v_mfma_f32_16x16x32_bf16 v[152:155], v[92:95], v[44:47], v[152:155]
    v_mfma_f32_16x16x32_bf16 v[156:159], v[60:63], v[44:47], v[156:159]
    v_mfma_f32_16x16x32_bf16 v[160:163], v[76:79], v[44:47], v[160:163]
    s_nop 7
    v_cndmask_b32 v148, v6, v148, s[60:61]
    v_cndmask_b32 v149, v6, v149, s[62:63]
    v_cndmask_b32 v150, v6, v150, s[64:65]
    v_cndmask_b32 v151, v6, v151, s[66:67]
    v_max_f32 v8, v144, v145
    v_max3_f32 v8, v8, v148, v149
    v_max3_f32 v8, v8, v150, v151
    v_mov_b32 v9, v8
    s_nop 1
    v_permlane32_swap_b32 v9, v8
    s_nop 1
    v_max_f32 v8, v8, v9
    v_mov_b32 v9, v8
    s_nop 1
    v_permlane16_swap_b32 v9, v8
    s_nop 1
    v_max_f32 v8, v8, v9
    v_mul_f32 v8, s59, v8
    v_fma_f32 v144, v144, s59, -v8
    v_fma_f32 v145, v145, s59, -v8
    v_fma_f32 v148, v148, s59, -v8
    v_fma_f32 v149, v149, s59, -v8
    v_fma_f32 v150, v150, s59, -v8
    v_fma_f32 v151, v151, s59, -v8
    v_exp_f32 v144, v144
    v_exp_f32 v145, v145
    v_exp_f32 v148, v148
    v_exp_f32 v149, v149
    v_exp_f32 v150, v150
    v_exp_f32 v151, v151
    v_cvt_pk_bf16_f32 v20, v144, v145
    v_mov_b32 v21, 0
    v_cvt_pk_bf16_f32 v16, v148, v149
    v_cvt_pk_bf16_f32 v17, v150, v151
    v_mov_b32 v18, 0
    v_mov_b32 v19, 0
    v_add_f32 v10, v144, v145
    v_add_f32 v10, v10, v148
    v_add_f32 v10, v10, v149
    v_add_f32 v10, v10, v150
    v_add_f32 v10, v10, v151
    v_mov_b32 v9, v10
    s_nop 1
    v_permlane32_swap_b32 v9, v10
    s_nop 1
    v_add_f32 v10, v10, v9
    v_mov_b32 v9, v10
    s_nop 1
    v_permlane16_swap_b32 v9, v10
    s_nop 1
    v_add_f32 v10, v10, v9
    v_rcp_f32 v10, v10
    v_cndmask_b32 v160, v6, v160, s[60:61]
    v_cndmask_b32 v161, v6, v161, s[62:63]
    v_cndmask_b32 v162, v6, v162, s[64:65]
    v_cndmask_b32 v163, v6, v163, s[66:67]
    v_max_f32 v8, v152, v153
    v_max3_f32 v8, v8, v156, v157
    v_max3_f32 v8, v8, v158, v159
    v_max3_f32 v8, v8, v160, v161
    v_max3_f32 v8, v8, v162, v163
    v_mov_b32 v9, v8
    s_nop 1
    v_permlane32_swap_b32 v9, v8
    s_nop 1
    v_max_f32 v8, v8, v9
    v_mov_b32 v9, v8
    s_nop 1
    v_permlane16_swap_b32 v9, v8
    s_nop 1
    v_max_f32 v8, v8, v9
    v_mul_f32 v8, s59, v8
    v_fma_f32 v152, v152, s59, -v8
    v_fma_f32 v153, v153, s59, -v8
    v_fma_f32 v156, v156, s59, -v8
    v_fma_f32 v157, v157, s59, -v8
    v_fma_f32 v158, v158, s59, -v8
    v_fma_f32 v159, v159, s59, -v8
    v_fma_f32 v160, v160, s59, -v8
    v_fma_f32 v161, v161, s59, -v8
    v_fma_f32 v162, v162, s59, -v8
    v_fma_f32 v163, v163, s59, -v8
    v_exp_f32 v152, v152
    v_exp_f32 v153, v153
    v_exp_f32 v156, v156
    v_exp_f32 v157, v157
    v_exp_f32 v158, v158
    v_exp_f32 v159, v159
    v_exp_f32 v160, v160
    v_exp_f32 v161, v161
    v_exp_f32 v162, v162
    v_exp_f32 v163, v163
    v_cvt_pk_bf16_f32 v36, v152, v153
    v_mov_b32 v37, 0
    v_cvt_pk_bf16_f32 v32, v156, v157
    v_cvt_pk_bf16_f32 v33, v158, v159
    v_cvt_pk_bf16_f32 v34, v160, v161
    v_cvt_pk_bf16_f32 v35, v162, v163
    v_add_f32 v11, v152, v153
    v_add_f32 v11, v11, v156
    v_add_f32 v11, v11, v157
    v_add_f32 v11, v11, v158
    v_add_f32 v11, v11, v159
    v_add_f32 v11, v11, v160
    v_add_f32 v11, v11, v161
    v_add_f32 v11, v11, v162
    v_add_f32 v11, v11, v163
    v_mov_b32 v9, v11
    s_nop 1
    v_permlane32_swap_b32 v9, v11
    s_nop 1
    v_add_f32 v11, v11, v9
    v_mov_b32 v9, v11
    s_nop 1
    v_permlane16_swap_b32 v9, v11
    s_nop 1
    v_add_f32 v11, v11, v9
    v_rcp_f32 v11, v11
    s_waitcnt vmcnt(0)
    v_mfma_f32_16x16x32_bf16 v[48:51], v[96:99], v[16:19], 0
    v_mfma_f32_16x16x32_bf16 v[52:55], v[100:103], v[16:19], 0
    v_mfma_f32_16x16x32_bf16 v[56:59], v[104:107], v[16:19], 0
    v_mfma_f32_16x16x32_bf16 v[60:63], v[108:111], v[16:19], 0
    v_mfma_f32_16x16x32_bf16 v[64:67], v[112:115], v[16:19], 0
    v_mfma_f32_16x16x32_bf16 v[68:71], v[116:119], v[16:19], 0
    v_mfma_f32_16x16x32_bf16 v[72:75], v[120:123], v[16:19], 0
    v_mfma_f32_16x16x32_bf16 v[76:79], v[124:127], v[16:19], 0
    v_mfma_f32_16x16x16_bf16 v[48:51], v[128:129], v[20:21], v[48:51]
    v_mfma_f32_16x16x16_bf16 v[52:55], v[130:131], v[20:21], v[52:55]
    v_mfma_f32_16x16x16_bf16 v[56:59], v[132:133], v[20:21], v[56:59]
    v_mfma_f32_16x16x16_bf16 v[60:63], v[134:135], v[20:21], v[60:63]
    v_mfma_f32_16x16x16_bf16 v[64:67], v[136:137], v[20:21], v[64:67]
    v_mfma_f32_16x16x16_bf16 v[68:71], v[138:139], v[20:21], v[68:71]
    v_mfma_f32_16x16x16_bf16 v[72:75], v[140:141], v[20:21], v[72:75]
    v_mfma_f32_16x16x16_bf16 v[76:79], v[142:143], v[20:21], v[76:79]
    s_nop 1
    v_mul_f32 v48, v48, v10
    v_mul_f32 v49, v49, v10
    v_mul_f32 v50, v50, v10
    v_mul_f32 v51, v51, v10
    v_mul_f32 v52, v52, v10
    v_mul_f32 v53, v53, v10
    v_mul_f32 v54, v54, v10
    v_mul_f32 v55, v55, v10
    v_cvt_pk_bf16_f32 v80, v48, v49
    v_cvt_pk_bf16_f32 v81, v50, v51
    v_cvt_pk_bf16_f32 v82, v52, v53
    v_cvt_pk_bf16_f32 v83, v54, v55
    buffer_store_dwordx4 v[80:83], v1, s[4:7], s48 offen offset:0 sc1
    v_mul_f32 v56, v56, v10
    v_mul_f32 v57, v57, v10
    v_mul_f32 v58, v58, v10
    v_mul_f32 v59, v59, v10
    v_mul_f32 v60, v60, v10
    v_mul_f32 v61, v61, v10
    v_mul_f32 v62, v62, v10
    v_mul_f32 v63, v63, v10
    v_cvt_pk_bf16_f32 v84, v56, v57
    v_cvt_pk_bf16_f32 v85, v58, v59
    v_cvt_pk_bf16_f32 v86, v60, v61
    v_cvt_pk_bf16_f32 v87, v62, v63
    buffer_store_dwordx4 v[84:87], v1, s[4:7], s48 offen offset:1024 sc1
    v_mul_f32 v64, v64, v10
    v_mul_f32 v65, v65, v10
    v_mul_f32 v66, v66, v10
    v_mul_f32 v67, v67, v10
    v_mul_f32 v68, v68, v10
    v_mul_f32 v69, v69, v10
    v_mul_f32 v70, v70, v10
    v_mul_f32 v71, v71, v10
    v_cvt_pk_bf16_f32 v88, v64, v65
    v_cvt_pk_bf16_f32 v89, v66, v67
    v_cvt_pk_bf16_f32 v90, v68, v69
    v_cvt_pk_bf16_f32 v91, v70, v71
    buffer_store_dwordx4 v[88:91], v1, s[4:7], s48 offen offset:2048 sc1
    v_mul_f32 v72, v72, v10
    v_mul_f32 v73, v73, v10
    v_mul_f32 v74, v74, v10
    v_mul_f32 v75, v75, v10
    v_mul_f32 v76, v76, v10
    v_mul_f32 v77, v77, v10
    v_mul_f32 v78, v78, v10
    v_mul_f32 v79, v79, v10
    v_cvt_pk_bf16_f32 v92, v72, v73
    v_cvt_pk_bf16_f32 v93, v74, v75
    v_cvt_pk_bf16_f32 v94, v76, v77
    v_cvt_pk_bf16_f32 v95, v78, v79
    buffer_store_dwordx4 v[92:95], v1, s[4:7], s48 offen offset:3072 sc1
    v_mfma_f32_16x16x32_bf16 v[48:51], v[96:99], v[32:35], 0
    v_mfma_f32_16x16x32_bf16 v[52:55], v[100:103], v[32:35], 0
    v_mfma_f32_16x16x32_bf16 v[56:59], v[104:107], v[32:35], 0
    v_mfma_f32_16x16x32_bf16 v[60:63], v[108:111], v[32:35], 0
    v_mfma_f32_16x16x32_bf16 v[64:67], v[112:115], v[32:35], 0
    v_mfma_f32_16x16x32_bf16 v[68:71], v[116:119], v[32:35], 0
    v_mfma_f32_16x16x32_bf16 v[72:75], v[120:123], v[32:35], 0
    v_mfma_f32_16x16x32_bf16 v[76:79], v[124:127], v[32:35], 0
    v_mfma_f32_16x16x16_bf16 v[48:51], v[128:129], v[36:37], v[48:51]
    v_mfma_f32_16x16x16_bf16 v[52:55], v[130:131], v[36:37], v[52:55]
    v_mfma_f32_16x16x16_bf16 v[56:59], v[132:133], v[36:37], v[56:59]
    v_mfma_f32_16x16x16_bf16 v[60:63], v[134:135], v[36:37], v[60:63]
    v_mfma_f32_16x16x16_bf16 v[64:67], v[136:137], v[36:37], v[64:67]
    v_mfma_f32_16x16x16_bf16 v[68:71], v[138:139], v[36:37], v[68:71]
    v_mfma_f32_16x16x16_bf16 v[72:75], v[140:141], v[36:37], v[72:75]
    v_mfma_f32_16x16x16_bf16 v[76:79], v[142:143], v[36:37], v[76:79]
    s_nop 1
    v_mul_f32 v48, v48, v11
    v_mul_f32 v49, v49, v11
    v_mul_f32 v50, v50, v11
    v_mul_f32 v51, v51, v11
    v_mul_f32 v52, v52, v11
    v_mul_f32 v53, v53, v11
    v_mul_f32 v54, v54, v11
    v_mul_f32 v55, v55, v11
    v_cvt_pk_bf16_f32 v144, v48, v49
    v_cvt_pk_bf16_f32 v145, v50, v51
    v_cvt_pk_bf16_f32 v146, v52, v53
    v_cvt_pk_bf16_f32 v147, v54, v55
    buffer_store_dwordx4 v[144:147], v1, s[4:7], s49 offen offset:0 sc1
    v_mul_f32 v56, v56, v11
    v_mul_f32 v57, v57, v11
    v_mul_f32 v58, v58, v11
    v_mul_f32 v59, v59, v11
    v_mul_f32 v60, v60, v11
    v_mul_f32 v61, v61, v11
    v_mul_f32 v62, v62, v11
    v_mul_f32 v63, v63, v11
    v_cvt_pk_bf16_f32 v148, v56, v57
    v_cvt_pk_bf16_f32 v149, v58, v59
    v_cvt_pk_bf16_f32 v150, v60, v61
    v_cvt_pk_bf16_f32 v151, v62, v63
    buffer_store_dwordx4 v[148:151], v1, s[4:7], s49 offen offset:1024 sc1
    v_mul_f32 v64, v64, v11
    v_mul_f32 v65, v65, v11
    v_mul_f32 v66, v66, v11
    v_mul_f32 v67, v67, v11
    v_mul_f32 v68, v68, v11
    v_mul_f32 v69, v69, v11
    v_mul_f32 v70, v70, v11
    v_mul_f32 v71, v71, v11
    v_cvt_pk_bf16_f32 v152, v64, v65
    v_cvt_pk_bf16_f32 v153, v66, v67
    v_cvt_pk_bf16_f32 v154, v68, v69
    v_cvt_pk_bf16_f32 v155, v70, v71
    buffer_store_dwordx4 v[152:155], v1, s[4:7], s49 offen offset:2048 sc1
    v_mul_f32 v72, v72, v11
    v_mul_f32 v73, v73, v11
    v_mul_f32 v74, v74, v11
    v_mul_f32 v75, v75, v11
    v_mul_f32 v76, v76, v11
    v_mul_f32 v77, v77, v11
    v_mul_f32 v78, v78, v11
    v_mul_f32 v79, v79, v11
    v_cvt_pk_bf16_f32 v156, v72, v73
    v_cvt_pk_bf16_f32 v157, v74, v75
    v_cvt_pk_bf16_f32 v158, v76, v77
    v_cvt_pk_bf16_f32 v159, v78, v79
    buffer_store_dwordx4 v[156:159], v1, s[4:7], s49 offen offset:3072 sc1
    s_lshl_b32 s20, s20, 6
    s_add_u32 s20, s20, 143671296
    v_lshlrev_b32 v10, 2, v3
    s_waitcnt vmcnt(0)
    buffer_store_dword v3, v10, s[4:7], s20 offen sc1
p2_na:
    s_lshl_b32 s20, s18, 11
    s_add_u32 s20, s20, 143671296
    v_and_b32 v4, 31, v0
    v_lshlrev_b32 v4, 6, v4
    s_waitcnt vmcnt(24)
    v_add_u32 v14, 4096, v13
    buffer_load_dwordx4 v[128:131], v13, s[4:7], s52 offen offset:0
    buffer_load_dwordx4 v[132:135], v13, s[4:7], s53 offen offset:0
    buffer_load_dwordx4 v[136:139], v13, s[4:7], s54 offen offset:0
    buffer_load_dwordx4 v[140:143], v13, s[4:7], s55 offen offset:0
    buffer_load_dwordx4 v[144:147], v13, s[4:7], s52 offen offset:1024
    buffer_load_dwordx4 v[148:151], v13, s[4:7], s53 offen offset:1024
    buffer_load_dwordx4 v[152:155], v13, s[4:7], s54 offen offset:1024
    buffer_load_dwordx4 v[156:159], v13, s[4:7], s55 offen offset:1024
    buffer_load_dwordx4 v[160:163], v13, s[4:7], s52 offen offset:2048
    buffer_load_dwordx4 v[164:167], v13, s[4:7], s53 offen offset:2048
    buffer_load_dwordx4 v[168:171], v13, s[4:7], s54 offen offset:2048
    buffer_load_dwordx4 v[172:175], v13, s[4:7], s55 offen offset:2048
    buffer_load_dwordx4 v[176:179], v13, s[4:7], s52 offen offset:3072
    buffer_load_dwordx4 v[180:183], v13, s[4:7], s53 offen offset:3072
    buffer_load_dwordx4 v[184:187], v13, s[4:7], s54 offen offset:3072
    buffer_load_dwordx4 v[188:191], v13, s[4:7], s55 offen offset:3072
    buffer_load_dwordx4 v[192:195], v14, s[4:7], s52 offen offset:0
    buffer_load_dwordx4 v[196:199], v14, s[4:7], s53 offen offset:0
    buffer_load_dwordx4 v[200:203], v14, s[4:7], s54 offen offset:0
    buffer_load_dwordx4 v[204:207], v14, s[4:7], s55 offen offset:0
    buffer_load_dwordx4 v[208:211], v14, s[4:7], s52 offen offset:1024
    buffer_load_dwordx4 v[212:215], v14, s[4:7], s53 offen offset:1024
    buffer_load_dwordx4 v[216:219], v14, s[4:7], s54 offen offset:1024
    buffer_load_dwordx4 v[220:223], v14, s[4:7], s55 offen offset:1024
    buffer_load_dwordx4 v[224:227], v14, s[4:7], s52 offen offset:2048
    buffer_load_dwordx4 v[228:231], v14, s[4:7], s53 offen offset:2048
    buffer_load_dwordx4 v[232:235], v14, s[4:7], s54 offen offset:2048
    buffer_load_dwordx4 v[236:239], v14, s[4:7], s55 offen offset:2048
    buffer_load_dwordx4 v[240:243], v14, s[4:7], s52 offen offset:3072
    buffer_load_dwordx4 v[244:247], v14, s[4:7], s53 offen offset:3072
    buffer_load_dwordx4 v[248:251], v14, s[4:7], s54 offen offset:3072
    buffer_load_dwordx4 v[252:255], v14, s[4:7], s55 offen offset:3072
    s_cmp_lg_u32 s3, 0
    s_cbranch_scc1 p2_d_ok
p2_d:
    buffer_load_dword v6, v4, s[4:7], s20 offen sc1
    s_waitcnt vmcnt(0)
    v_cmp_eq_u32 vcc, -1, v6
    s_cbranch_vccz p2_d_ok
    s_sleep 6
    s_sub_u32 s34, s34, 1
    s_cbranch_scc0 p2_d
    s_endpgm
p2_d_ok:
    s_waitcnt vmcnt(0)
    s_barrier
    s_lshl_b32 s30, s18, 1
    s_add_u32 s30, s30, s3
    s_mul_i32 s30, s30, 20480
    s_lshl_b32 s31, s16, 7
    s_add_u32 s30, s30, s31
    s_mov_b32 s22, 0xffff0000
    v_mov_b32 v14, v13
    buffer_load_dwordx4 v[16:19], v14, s[4:7], s50 offen offset:0
    buffer_load_dwordx4 v[20:23], v14, s[4:7], s51 offen offset:0
    buffer_load_dwordx4 v[24:27], v14, s[4:7], s50 offen offset:1024
    buffer_load_dwordx4 v[28:31], v14, s[4:7], s51 offen offset:1024
    buffer_load_dwordx4 v[32:35], v14, s[4:7], s50 offen offset:2048
    buffer_load_dwordx4 v[36:39], v14, s[4:7], s51 offen offset:2048
    buffer_load_dwordx4 v[40:43], v14, s[4:7], s50 offen offset:3072
    buffer_load_dwordx4 v[44:47], v14, s[4:7], s51 offen offset:3072
    v_add_u32 v14, 4096, v14
    buffer_load_dwordx4 v[48:51], v14, s[4:7], s50 offen offset:0
    buffer_load_dwordx4 v[52:55], v14, s[4:7], s51 offen offset:0
    buffer_load_dwordx4 v[56:59], v14, s[4:7], s50 offen offset:1024
    buffer_load_dwordx4 v[60:63], v14, s[4:7], s51 offen offset:1024
    buffer_load_dwordx4 v[64:67], v14, s[4:7], s50 offen offset:2048
    buffer_load_dwordx4 v[68:71], v14, s[4:7], s51 offen offset:2048
    buffer_load_dwordx4 v[72:75], v14, s[4:7], s50 offen offset:3072
    buffer_load_dwordx4 v[76:79], v14, s[4:7], s51 offen offset:3072
    v_add_u32 v14, 4096, v14
    buffer_load_dwordx4 v[80:83], v14, s[4:7], s50 offen offset:0
    buffer_load_dwordx4 v[84:87], v14, s[4:7], s51 offen offset:0
    buffer_load_dwordx4 v[88:91], v14, s[4:7], s50 offen offset:1024
    buffer_load_dwordx4 v[92:95], v14, s[4:7], s51 offen offset:1024
    ds_read_b128 v[96:99], v15 offset:0
    ds_read_b128 v[100:103], v15 offset:1024
    ds_read_b128 v[104:107], v15 offset:2048
    ds_read_b128 v[108:111], v15 offset:3072
    ds_read_b128 v[112:115], v15 offset:4096
    ds_read_b128 v[116:119], v15 offset:5120
    ds_read_b128 v[120:123], v15 offset:6144
    ds_read_b128 v[124:127], v15 offset:7168
    s_waitcnt vmcnt(18)
    v_mfma_f32_16x16x32_bf16 a[0:3], v[128:131], v[16:19], a[0:3]
    v_mfma_f32_16x16x32_bf16 a[4:7], v[132:135], v[16:19], a[4:7]
    v_mfma_f32_16x16x32_bf16 a[8:11], v[136:139], v[16:19], a[8:11]
    v_mfma_f32_16x16x32_bf16 a[12:15], v[140:143], v[16:19], a[12:15]
    v_mfma_f32_16x16x32_bf16 a[16:19], v[128:131], v[20:23], a[16:19]
    v_mfma_f32_16x16x32_bf16 a[20:23], v[132:135], v[20:23], a[20:23]
    v_mfma_f32_16x16x32_bf16 a[24:27], v[136:139], v[20:23], a[24:27]
    v_mfma_f32_16x16x32_bf16 a[28:31], v[140:143], v[20:23], a[28:31]
    buffer_load_dwordx4 v[16:19], v14, s[4:7], s50 offen offset:2048
    buffer_load_dwordx4 v[20:23], v14, s[4:7], s51 offen offset:2048
    buffer_load_dwordx4 v[128:131], v14, s[4:7], s50 offen offset:3072
    buffer_load_dwordx4 v[132:135], v14, s[4:7], s51 offen offset:3072
    v_add_u32 v14, 4096, v14
    buffer_load_dwordx4 v[136:139], v14, s[4:7], s50 offen offset:0
    buffer_load_dwordx4 v[140:143], v14, s[4:7], s51 offen offset:0
    s_waitcnt vmcnt(22)
    v_mfma_f32_16x16x32_bf16 a[0:3], v[144:147], v[24:27], a[0:3]
    v_mfma_f32_16x16x32_bf16 a[4:7], v[148:151], v[24:27], a[4:7]
    v_mfma_f32_16x16x32_bf16 a[8:11], v[152:155], v[24:27], a[8:11]
    v_mfma_f32_16x16x32_bf16 a[12:15], v[156:159], v[24:27], a[12:15]
    v_mfma_f32_16x16x32_bf16 a[16:19], v[144:147], v[28:31], a[16:19]
    v_mfma_f32_16x16x32_bf16 a[20:23], v[148:151], v[28:31], a[20:23]
    v_mfma_f32_16x16x32_bf16 a[24:27], v[152:155], v[28:31], a[24:27]
    v_mfma_f32_16x16x32_bf16 a[28:31], v[156:159], v[28:31], a[28:31]
    buffer_load_dwordx4 v[24:27], v14, s[4:7], s50 offen offset:1024
    buffer_load_dwordx4 v[28:31], v14, s[4:7], s51 offen offset:1024
    buffer_load_dwordx4 v[144:147], v14, s[4:7], s50 offen offset:2048
    buffer_load_dwordx4 v[148:151], v14, s[4:7], s51 offen offset:2048
    buffer_load_dwordx4 v[152:155], v14, s[4:7], s50 offen offset:3072
    buffer_load_dwordx4 v[156:159], v14, s[4:7], s51 offen offset:3072
    v_add_u32 v14, 4096, v14
    s_waitcnt vmcnt(26)
    v_mfma_f32_16x16x32_bf16 a[0:3], v[160:163], v[32:35], a[0:3]
    v_mfma_f32_16x16x32_bf16 a[4:7], v[164:167], v[32:35], a[4:7]
    v_mfma_f32_16x16x32_bf16 a[8:11], v[168:171], v[32:35], a[8:11]
    v_mfma_f32_16x16x32_bf16 a[12:15], v[172:175], v[32:35], a[12:15]
    v_mfma_f32_16x16x32_bf16 a[16:19], v[160:163], v[36:39], a[16:19]
    v_mfma_f32_16x16x32_bf16 a[20:23], v[164:167], v[36:39], a[20:23]
    v_mfma_f32_16x16x32_bf16 a[24:27], v[168:171], v[36:39], a[24:27]
    v_mfma_f32_16x16x32_bf16 a[28:31], v[172:175], v[36:39], a[28:31]
    buffer_load_dwordx4 v[32:35], v14, s[4:7], s50 offen offset:0
    buffer_load_dwordx4 v[36:39], v14, s[4:7], s51 offen offset:0
    buffer_load_dwordx4 v[160:163], v14, s[4:7], s50 offen offset:1024
    buffer_load_dwordx4 v[164:167], v14, s[4:7], s51 offen offset:1024
    buffer_load_dwordx4 v[168:171], v14, s[4:7], s50 offen offset:2048
    buffer_load_dwordx4 v[172:175], v14, s[4:7], s51 offen offset:2048
    s_waitcnt vmcnt(30)
    v_mfma_f32_16x16x32_bf16 a[0:3], v[176:179], v[40:43], a[0:3]
    v_mfma_f32_16x16x32_bf16 a[4:7], v[180:183], v[40:43], a[4:7]
    v_mfma_f32_16x16x32_bf16 a[8:11], v[184:187], v[40:43], a[8:11]
    v_mfma_f32_16x16x32_bf16 a[12:15], v[188:191], v[40:43], a[12:15]
    v_mfma_f32_16x16x32_bf16 a[16:19], v[176:179], v[44:47], a[16:19]
    v_mfma_f32_16x16x32_bf16 a[20:23], v[180:183], v[44:47], a[20:23]
    v_mfma_f32_16x16x32_bf16 a[24:27], v[184:187], v[44:47], a[24:27]
    v_mfma_f32_16x16x32_bf16 a[28:31], v[188:191], v[44:47], a[28:31]
    buffer_load_dwordx4 v[40:43], v14, s[4:7], s50 offen offset:3072
    buffer_load_dwordx4 v[44:47], v14, s[4:7], s51 offen offset:3072
    v_add_u32 v14, 4096, v14
    buffer_load_dwordx4 v[176:179], v14, s[4:7], s50 offen offset:0
    buffer_load_dwordx4 v[180:183], v14, s[4:7], s51 offen offset:0
    buffer_load_dwordx4 v[184:187], v14, s[4:7], s50 offen offset:1024
    buffer_load_dwordx4 v[188:191], v14, s[4:7], s51 offen offset:1024
    s_waitcnt vmcnt(34)
    v_mfma_f32_16x16x32_bf16 a[0:3], v[192:195], v[48:51], a[0:3]
    v_mfma_f32_16x16x32_bf16 a[4:7], v[196:199], v[48:51], a[4:7]
    v_mfma_f32_16x16x32_bf16 a[8:11], v[200:203], v[48:51], a[8:11]
    v_mfma_f32_16x16x32_bf16 a[12:15], v[204:207], v[48:51], a[12:15]
    v_mfma_f32_16x16x32_bf16 a[16:19], v[192:195], v[52:55], a[16:19]
    v_mfma_f32_16x16x32_bf16 a[20:23], v[196:199], v[52:55], a[20:23]
    v_mfma_f32_16x16x32_bf16 a[24:27], v[200:203], v[52:55], a[24:27]
    v_mfma_f32_16x16x32_bf16 a[28:31], v[204:207], v[52:55], a[28:31]
    buffer_load_dwordx4 v[48:51], v14, s[4:7], s50 offen offset:2048
    buffer_load_dwordx4 v[52:55], v14, s[4:7], s51 offen offset:2048
    buffer_load_dwordx4 v[192:195], v14, s[4:7], s50 offen offset:3072
    buffer_load_dwordx4 v[196:199], v14, s[4:7], s51 offen offset:3072
    v_add_u32 v14, 4096, v14
    buffer_load_dwordx4 v[200:203], v14, s[4:7], s50 offen offset:0
    buffer_load_dwordx4 v[204:207], v14, s[4:7], s51 offen offset:0
    s_waitcnt vmcnt(38)
    v_mfma_f32_16x16x32_bf16 a[0:3], v[208:211], v[56:59], a[0:3]
    v_mfma_f32_16x16x32_bf16 a[4:7], v[212:215], v[56:59], a[4:7]
    v_mfma_f32_16x16x32_bf16 a[8:11], v[216:219], v[56:59], a[8:11]
    v_mfma_f32_16x16x32_bf16 a[12:15], v[220:223], v[56:59], a[12:15]
    v_mfma_f32_16x16x32_bf16 a[16:19], v[208:211], v[60:63], a[16:19]
    v_mfma_f32_16x16x32_bf16 a[20:23], v[212:215], v[60:63], a[20:23]
    v_mfma_f32_16x16x32_bf16 a[24:27], v[216:219], v[60:63], a[24:27]
    v_mfma_f32_16x16x32_bf16 a[28:31], v[220:223], v[60:63], a[28:31]
    buffer_load_dwordx4 v[56:59], v14, s[4:7], s50 offen offset:1024
    buffer_load_dwordx4 v[60:63], v14, s[4:7], s51 offen offset:1024
    buffer_load_dwordx4 v[208:211], v14, s[4:7], s50 offen offset:2048
    buffer_load_dwordx4 v[212:215], v14, s[4:7], s51 offen offset:2048
    buffer_load_dwordx4 v[216:219], v14, s[4:7], s50 offen offset:3072
    buffer_load_dwordx4 v[220:223], v14, s[4:7], s51 offen offset:3072
    v_add_u32 v14, 4096, v14
    s_waitcnt vmcnt(42)
    v_mfma_f32_16x16x32_bf16 a[0:3], v[224:227], v[64:67], a[0:3]
    v_mfma_f32_16x16x32_bf16 a[4:7], v[228:231], v[64:67], a[4:7]
    v_mfma_f32_16x16x32_bf16 a[8:11], v[232:235], v[64:67], a[8:11]
    v_mfma_f32_16x16x32_bf16 a[12:15], v[236:239], v[64:67], a[12:15]
    v_mfma_f32_16x16x32_bf16 a[16:19], v[224:227], v[68:71], a[16:19]
    v_mfma_f32_16x16x32_bf16 a[20:23], v[228:231], v[68:71], a[20:23]
    v_mfma_f32_16x16x32_bf16 a[24:27], v[232:235], v[68:71], a[24:27]
    v_mfma_f32_16x16x32_bf16 a[28:31], v[236:239], v[68:71], a[28:31]
    buffer_load_dwordx4 v[64:67], v14, s[4:7], s50 offen offset:0
    buffer_load_dwordx4 v[68:71], v14, s[4:7], s51 offen offset:0
    buffer_load_dwordx4 v[224:227], v14, s[4:7], s50 offen offset:1024
    buffer_load_dwordx4 v[228:231], v14, s[4:7], s51 offen offset:1024
    buffer_load_dwordx4 v[232:235], v14, s[4:7], s50 offen offset:2048
    buffer_load_dwordx4 v[236:239], v14, s[4:7], s51 offen offset:2048
    s_waitcnt vmcnt(46)
    v_mfma_f32_16x16x32_bf16 a[0:3], v[240:243], v[72:75], a[0:3]
    v_mfma_f32_16x16x32_bf16 a[4:7], v[244:247], v[72:75], a[4:7]
    v_mfma_f32_16x16x32_bf16 a[8:11], v[248:251], v[72:75], a[8:11]
    v_mfma_f32_16x16x32_bf16 a[12:15], v[252:255], v[72:75], a[12:15]
    v_mfma_f32_16x16x32_bf16 a[16:19], v[240:243], v[76:79], a[16:19]
    v_mfma_f32_16x16x32_bf16 a[20:23], v[244:247], v[76:79], a[20:23]
    v_mfma_f32_16x16x32_bf16 a[24:27], v[248:251], v[76:79], a[24:27]
    v_mfma_f32_16x16x32_bf16 a[28:31], v[252:255], v[76:79], a[28:31]
    buffer_load_dwordx4 v[72:75], v14, s[4:7], s50 offen offset:3072
    buffer_load_dwordx4 v[76:79], v14, s[4:7], s51 offen offset:3072
    v_add_u32 v14, 4096, v14
    s_waitcnt vmcnt(46)
    v_mfma_f32_16x16x32_bf16 a[0:3], a[32:35], v[80:83], a[0:3]
    v_mfma_f32_16x16x32_bf16 a[4:7], a[36:39], v[80:83], a[4:7]
    v_mfma_f32_16x16x32_bf16 a[8:11], a[40:43], v[80:83], a[8:11]
    v_mfma_f32_16x16x32_bf16 a[12:15], a[44:47], v[80:83], a[12:15]
    v_mfma_f32_16x16x32_bf16 a[16:19], a[32:35], v[84:87], a[16:19]
    v_mfma_f32_16x16x32_bf16 a[20:23], a[36:39], v[84:87], a[20:23]
    v_mfma_f32_16x16x32_bf16 a[24:27], a[40:43], v[84:87], a[24:27]
    v_mfma_f32_16x16x32_bf16 a[28:31], a[44:47], v[84:87], a[28:31]
    s_waitcnt vmcnt(44)
    v_mfma_f32_16x16x32_bf16 a[0:3], a[48:51], v[88:91], a[0:3]
    v_mfma_f32_16x16x32_bf16 a[4:7], a[52:55], v[88:91], a[4:7]
    v_mfma_f32_16x16x32_bf16 a[8:11], a[56:59], v[88:91], a[8:11]
    v_mfma_f32_16x16x32_bf16 a[12:15], a[60:63], v[88:91], a[12:15]
    v_mfma_f32_16x16x32_bf16 a[16:19], a[48:51], v[92:95], a[16:19]
    v_mfma_f32_16x16x32_bf16 a[20:23], a[52:55], v[92:95], a[20:23]
    v_mfma_f32_16x16x32_bf16 a[24:27], a[56:59], v[92:95], a[24:27]
    v_mfma_f32_16x16x32_bf16 a[28:31], a[60:63], v[92:95], a[28:31]
    s_waitcnt vmcnt(42)
    v_mfma_f32_16x16x32_bf16 a[0:3], a[64:67], v[16:19], a[0:3]
    v_mfma_f32_16x16x32_bf16 a[4:7], a[68:71], v[16:19], a[4:7]
    v_mfma_f32_16x16x32_bf16 a[8:11], a[72:75], v[16:19], a[8:11]
    v_mfma_f32_16x16x32_bf16 a[12:15], a[76:79], v[16:19], a[12:15]
    v_mfma_f32_16x16x32_bf16 a[16:19], a[64:67], v[20:23], a[16:19]
    v_mfma_f32_16x16x32_bf16 a[20:23], a[68:71], v[20:23], a[20:23]
    v_mfma_f32_16x16x32_bf16 a[24:27], a[72:75], v[20:23], a[24:27]
    v_mfma_f32_16x16x32_bf16 a[28:31], a[76:79], v[20:23], a[28:31]
    s_waitcnt vmcnt(40)
    v_mfma_f32_16x16x32_bf16 a[0:3], a[80:83], v[128:131], a[0:3]
    v_mfma_f32_16x16x32_bf16 a[4:7], a[84:87], v[128:131], a[4:7]
    v_mfma_f32_16x16x32_bf16 a[8:11], a[88:91], v[128:131], a[8:11]
    v_mfma_f32_16x16x32_bf16 a[12:15], a[92:95], v[128:131], a[12:15]
    v_mfma_f32_16x16x32_bf16 a[16:19], a[80:83], v[132:135], a[16:19]
    v_mfma_f32_16x16x32_bf16 a[20:23], a[84:87], v[132:135], a[20:23]
    v_mfma_f32_16x16x32_bf16 a[24:27], a[88:91], v[132:135], a[24:27]
    v_mfma_f32_16x16x32_bf16 a[28:31], a[92:95], v[132:135], a[28:31]
    s_waitcnt vmcnt(38)
    v_mfma_f32_16x16x32_bf16 a[0:3], a[96:99], v[136:139], a[0:3]
    v_mfma_f32_16x16x32_bf16 a[4:7], a[100:103], v[136:139], a[4:7]
    v_mfma_f32_16x16x32_bf16 a[8:11], a[104:107], v[136:139], a[8:11]
    v_mfma_f32_16x16x32_bf16 a[12:15], a[108:111], v[136:139], a[12:15]
    v_mfma_f32_16x16x32_bf16 a[16:19], a[96:99], v[140:143], a[16:19]
    v_mfma_f32_16x16x32_bf16 a[20:23], a[100:103], v[140:143], a[20:23]
    v_mfma_f32_16x16x32_bf16 a[24:27], a[104:107], v[140:143], a[24:27]
    v_mfma_f32_16x16x32_bf16 a[28:31], a[108:111], v[140:143], a[28:31]
    s_waitcnt vmcnt(36)
    v_mfma_f32_16x16x32_bf16 a[0:3], a[112:115], v[24:27], a[0:3]
    v_mfma_f32_16x16x32_bf16 a[4:7], a[116:119], v[24:27], a[4:7]
    v_mfma_f32_16x16x32_bf16 a[8:11], a[120:123], v[24:27], a[8:11]
    v_mfma_f32_16x16x32_bf16 a[12:15], a[124:127], v[24:27], a[12:15]
    v_mfma_f32_16x16x32_bf16 a[16:19], a[112:115], v[28:31], a[16:19]
    v_mfma_f32_16x16x32_bf16 a[20:23], a[116:119], v[28:31], a[20:23]
    v_mfma_f32_16x16x32_bf16 a[24:27], a[120:123], v[28:31], a[24:27]
    v_mfma_f32_16x16x32_bf16 a[28:31], a[124:127], v[28:31], a[28:31]
    s_waitcnt vmcnt(34)
    v_mfma_f32_16x16x32_bf16 a[0:3], a[128:131], v[144:147], a[0:3]
    v_mfma_f32_16x16x32_bf16 a[4:7], a[132:135], v[144:147], a[4:7]
    v_mfma_f32_16x16x32_bf16 a[8:11], a[136:139], v[144:147], a[8:11]
    v_mfma_f32_16x16x32_bf16 a[12:15], a[140:143], v[144:147], a[12:15]
    v_mfma_f32_16x16x32_bf16 a[16:19], a[128:131], v[148:151], a[16:19]
    v_mfma_f32_16x16x32_bf16 a[20:23], a[132:135], v[148:151], a[20:23]
    v_mfma_f32_16x16x32_bf16 a[24:27], a[136:139], v[148:151], a[24:27]
    v_mfma_f32_16x16x32_bf16 a[28:31], a[140:143], v[148:151], a[28:31]
    s_waitcnt vmcnt(32)
    v_mfma_f32_16x16x32_bf16 a[0:3], a[144:147], v[152:155], a[0:3]
    v_mfma_f32_16x16x32_bf16 a[4:7], a[148:151], v[152:155], a[4:7]
    v_mfma_f32_16x16x32_bf16 a[8:11], a[152:155], v[152:155], a[8:11]
    v_mfma_f32_16x16x32_bf16 a[12:15], a[156:159], v[152:155], a[12:15]
    v_mfma_f32_16x16x32_bf16 a[16:19], a[144:147], v[156:159], a[16:19]
    v_mfma_f32_16x16x32_bf16 a[20:23], a[148:151], v[156:159], a[20:23]
    v_mfma_f32_16x16x32_bf16 a[24:27], a[152:155], v[156:159], a[24:27]
    v_mfma_f32_16x16x32_bf16 a[28:31], a[156:159], v[156:159], a[28:31]
    s_waitcnt vmcnt(30)
    v_mfma_f32_16x16x32_bf16 a[0:3], a[160:163], v[32:35], a[0:3]
    v_mfma_f32_16x16x32_bf16 a[4:7], a[164:167], v[32:35], a[4:7]
    v_mfma_f32_16x16x32_bf16 a[8:11], a[168:171], v[32:35], a[8:11]
    v_mfma_f32_16x16x32_bf16 a[12:15], a[172:175], v[32:35], a[12:15]
    v_mfma_f32_16x16x32_bf16 a[16:19], a[160:163], v[36:39], a[16:19]
    v_mfma_f32_16x16x32_bf16 a[20:23], a[164:167], v[36:39], a[20:23]
    v_mfma_f32_16x16x32_bf16 a[24:27], a[168:171], v[36:39], a[24:27]
    v_mfma_f32_16x16x32_bf16 a[28:31], a[172:175], v[36:39], a[28:31]
    s_waitcnt vmcnt(28)
    v_mfma_f32_16x16x32_bf16 a[0:3], a[176:179], v[160:163], a[0:3]
    v_mfma_f32_16x16x32_bf16 a[4:7], a[180:183], v[160:163], a[4:7]
    v_mfma_f32_16x16x32_bf16 a[8:11], a[184:187], v[160:163], a[8:11]
    v_mfma_f32_16x16x32_bf16 a[12:15], a[188:191], v[160:163], a[12:15]
    v_mfma_f32_16x16x32_bf16 a[16:19], a[176:179], v[164:167], a[16:19]
    v_mfma_f32_16x16x32_bf16 a[20:23], a[180:183], v[164:167], a[20:23]
    v_mfma_f32_16x16x32_bf16 a[24:27], a[184:187], v[164:167], a[24:27]
    v_mfma_f32_16x16x32_bf16 a[28:31], a[188:191], v[164:167], a[28:31]
    s_waitcnt vmcnt(26)
    v_mfma_f32_16x16x32_bf16 a[0:3], a[192:195], v[168:171], a[0:3]
    v_mfma_f32_16x16x32_bf16 a[4:7], a[196:199], v[168:171], a[4:7]
    v_mfma_f32_16x16x32_bf16 a[8:11], a[200:203], v[168:171], a[8:11]
    v_mfma_f32_16x16x32_bf16 a[12:15], a[204:207], v[168:171], a[12:15]
    v_mfma_f32_16x16x32_bf16 a[16:19], a[192:195], v[172:175], a[16:19]
    v_mfma_f32_16x16x32_bf16 a[20:23], a[196:199], v[172:175], a[20:23]
    v_mfma_f32_16x16x32_bf16 a[24:27], a[200:203], v[172:175], a[24:27]
    v_mfma_f32_16x16x32_bf16 a[28:31], a[204:207], v[172:175], a[28:31]
    s_waitcnt vmcnt(24)
    v_mfma_f32_16x16x32_bf16 a[0:3], a[208:211], v[40:43], a[0:3]
    v_mfma_f32_16x16x32_bf16 a[4:7], a[212:215], v[40:43], a[4:7]
    v_mfma_f32_16x16x32_bf16 a[8:11], a[216:219], v[40:43], a[8:11]
    v_mfma_f32_16x16x32_bf16 a[12:15], a[220:223], v[40:43], a[12:15]
    v_mfma_f32_16x16x32_bf16 a[16:19], a[208:211], v[44:47], a[16:19]
    v_mfma_f32_16x16x32_bf16 a[20:23], a[212:215], v[44:47], a[20:23]
    v_mfma_f32_16x16x32_bf16 a[24:27], a[216:219], v[44:47], a[24:27]
    v_mfma_f32_16x16x32_bf16 a[28:31], a[220:223], v[44:47], a[28:31]
    s_waitcnt vmcnt(22)
    v_mfma_f32_16x16x32_bf16 a[0:3], a[224:227], v[176:179], a[0:3]
    v_mfma_f32_16x16x32_bf16 a[4:7], a[228:231], v[176:179], a[4:7]
    v_mfma_f32_16x16x32_bf16 a[8:11], a[232:235], v[176:179], a[8:11]
    v_mfma_f32_16x16x32_bf16 a[12:15], a[236:239], v[176:179], a[12:15]
    v_mfma_f32_16x16x32_bf16 a[16:19], a[224:227], v[180:183], a[16:19]
    v_mfma_f32_16x16x32_bf16 a[20:23], a[228:231], v[180:183], a[20:23]
    v_mfma_f32_16x16x32_bf16 a[24:27], a[232:235], v[180:183], a[24:27]
    v_mfma_f32_16x16x32_bf16 a[28:31], a[236:239], v[180:183], a[28:31]
    s_waitcnt vmcnt(20)
    v_mfma_f32_16x16x32_bf16 a[0:3], a[240:243], v[184:187], a[0:3]
    v_mfma_f32_16x16x32_bf16 a[4:7], a[244:247], v[184:187], a[4:7]
    v_mfma_f32_16x16x32_bf16 a[8:11], a[248:251], v[184:187], a[8:11]
    v_mfma_f32_16x16x32_bf16 a[12:15], a[252:255], v[184:187], a[12:15]
    v_mfma_f32_16x16x32_bf16 a[16:19], a[240:243], v[188:191], a[16:19]
    v_mfma_f32_16x16x32_bf16 a[20:23], a[244:247], v[188:191], a[20:23]
    v_mfma_f32_16x16x32_bf16 a[24:27], a[248:251], v[188:191], a[24:27]
    v_mfma_f32_16x16x32_bf16 a[28:31], a[252:255], v[188:191], a[28:31]
    s_waitcnt vmcnt(18) lgkmcnt(4)
    v_mfma_f32_16x16x32_bf16 a[0:3], v[96:99], v[48:51], a[0:3]
    v_mfma_f32_16x16x32_bf16 a[4:7], v[100:103], v[48:51], a[4:7]
    v_mfma_f32_16x16x32_bf16 a[8:11], v[104:107], v[48:51], a[8:11]
    v_mfma_f32_16x16x32_bf16 a[12:15], v[108:111], v[48:51], a[12:15]
    v_mfma_f32_16x16x32_bf16 a[16:19], v[96:99], v[52:55], a[16:19]
    v_mfma_f32_16x16x32_bf16 a[20:23], v[100:103], v[52:55], a[20:23]
    v_mfma_f32_16x16x32_bf16 a[24:27], v[104:107], v[52:55], a[24:27]
    v_mfma_f32_16x16x32_bf16 a[28:31], v[108:111], v[52:55], a[28:31]
    ds_read_b128 v[96:99], v15 offset:8192
    ds_read_b128 v[100:103], v15 offset:9216
    ds_read_b128 v[104:107], v15 offset:10240
    ds_read_b128 v[108:111], v15 offset:11264
    s_waitcnt vmcnt(16) lgkmcnt(4)
    v_mfma_f32_16x16x32_bf16 a[0:3], v[112:115], v[192:195], a[0:3]
    v_mfma_f32_16x16x32_bf16 a[4:7], v[116:119], v[192:195], a[4:7]
    v_mfma_f32_16x16x32_bf16 a[8:11], v[120:123], v[192:195], a[8:11]
    v_mfma_f32_16x16x32_bf16 a[12:15], v[124:127], v[192:195], a[12:15]
    v_mfma_f32_16x16x32_bf16 a[16:19], v[112:115], v[196:199], a[16:19]
    v_mfma_f32_16x16x32_bf16 a[20:23], v[116:119], v[196:199], a[20:23]
    v_mfma_f32_16x16x32_bf16 a[24:27], v[120:123], v[196:199], a[24:27]
    v_mfma_f32_16x16x32_bf16 a[28:31], v[124:127], v[196:199], a[28:31]
    ds_read_b128 v[112:115], v15 offset:12288
    ds_read_b128 v[116:119], v15 offset:13312
    ds_read_b128 v[120:123], v15 offset:14336
    ds_read_b128 v[124:127], v15 offset:15360
    s_waitcnt vmcnt(14) lgkmcnt(4)
    v_mfma_f32_16x16x32_bf16 a[0:3], v[96:99], v[200:203], a[0:3]
    v_mfma_f32_16x16x32_bf16 a[4:7], v[100:103], v[200:203], a[4:7]
    v_mfma_f32_16x16x32_bf16 a[8:11], v[104:107], v[200:203], a[8:11]
    v_mfma_f32_16x16x32_bf16 a[12:15], v[108:111], v[200:203], a[12:15]
    v_mfma_f32_16x16x32_bf16 a[16:19], v[96:99], v[204:207], a[16:19]
    v_mfma_f32_16x16x32_bf16 a[20:23], v[100:103], v[204:207], a[20:23]
    v_mfma_f32_16x16x32_bf16 a[24:27], v[104:107], v[204:207], a[24:27]
    v_mfma_f32_16x16x32_bf16 a[28:31], v[108:111], v[204:207], a[28:31]
    ds_read_b128 v[96:99], v15 offset:16384
    ds_read_b128 v[100:103], v15 offset:17408
    ds_read_b128 v[104:107], v15 offset:18432
    ds_read_b128 v[108:111], v15 offset:19456
    s_waitcnt vmcnt(12) lgkmcnt(4)
    v_mfma_f32_16x16x32_bf16 a[0:3], v[112:115], v[56:59], a[0:3]
    v_mfma_f32_16x16x32_bf16 a[4:7], v[116:119], v[56:59], a[4:7]
    v_mfma_f32_16x16x32_bf16 a[8:11], v[120:123], v[56:59], a[8:11]
    v_mfma_f32_16x16x32_bf16 a[12:15], v[124:127], v[56:59], a[12:15]
    v_mfma_f32_16x16x32_bf16 a[16:19], v[112:115], v[60:63], a[16:19]
    v_mfma_f32_16x16x32_bf16 a[20:23], v[116:119], v[60:63], a[20:23]
    v_mfma_f32_16x16x32_bf16 a[24:27], v[120:123], v[60:63], a[24:27]
    v_mfma_f32_16x16x32_bf16 a[28:31], v[124:127], v[60:63], a[28:31]
    ds_read_b128 v[112:115], v15 offset:20480
    ds_read_b128 v[116:119], v15 offset:21504
    ds_read_b128 v[120:123], v15 offset:22528
    ds_read_b128 v[124:127], v15 offset:23552
    s_waitcnt vmcnt(10) lgkmcnt(4)
    v_mfma_f32_16x16x32_bf16 a[0:3], v[96:99], v[208:211], a[0:3]
    v_mfma_f32_16x16x32_bf16 a[4:7], v[100:103], v[208:211], a[4:7]
    v_mfma_f32_16x16x32_bf16 a[8:11], v[104:107], v[208:211], a[8:11]
    v_mfma_f32_16x16x32_bf16 a[12:15], v[108:111], v[208:211], a[12:15]
    v_mfma_f32_16x16x32_bf16 a[16:19], v[96:99], v[212:215], a[16:19]
    v_mfma_f32_16x16x32_bf16 a[20:23], v[100:103], v[212:215], a[20:23]
    v_mfma_f32_16x16x32_bf16 a[24:27], v[104:107], v[212:215], a[24:27]
    v_mfma_f32_16x16x32_bf16 a[28:31], v[108:111], v[212:215], a[28:31]
    ds_read_b128 v[96:99], v15 offset:24576
    ds_read_b128 v[100:103], v15 offset:25600
    ds_read_b128 v[104:107], v15 offset:26624
    ds_read_b128 v[108:111], v15 offset:27648
    s_waitcnt vmcnt(8) lgkmcnt(4)
    v_mfma_f32_16x16x32_bf16 a[0:3], v[112:115], v[216:219], a[0:3]
    v_mfma_f32_16x16x32_bf16 a[4:7], v[116:119], v[216:219], a[4:7]
    v_mfma_f32_16x16x32_bf16 a[8:11], v[120:123], v[216:219], a[8:11]
    v_mfma_f32_16x16x32_bf16 a[12:15], v[124:127], v[216:219], a[12:15]
    v_mfma_f32_16x16x32_bf16 a[16:19], v[112:115], v[220:223], a[16:19]
    v_mfma_f32_16x16x32_bf16 a[20:23], v[116:119], v[220:223], a[20:23]
    v_mfma_f32_16x16x32_bf16 a[24:27], v[120:123], v[220:223], a[24:27]
    v_mfma_f32_16x16x32_bf16 a[28:31], v[124:127], v[220:223], a[28:31]
    ds_read_b128 v[112:115], v15 offset:28672
    ds_read_b128 v[116:119], v15 offset:29696
    ds_read_b128 v[120:123], v15 offset:30720
    ds_read_b128 v[124:127], v15 offset:31744
    s_waitcnt vmcnt(6) lgkmcnt(4)
    v_mfma_f32_16x16x32_bf16 a[0:3], v[96:99], v[64:67], a[0:3]
    v_mfma_f32_16x16x32_bf16 a[4:7], v[100:103], v[64:67], a[4:7]
    v_mfma_f32_16x16x32_bf16 a[8:11], v[104:107], v[64:67], a[8:11]
    v_mfma_f32_16x16x32_bf16 a[12:15], v[108:111], v[64:67], a[12:15]
    v_mfma_f32_16x16x32_bf16 a[16:19], v[96:99], v[68:71], a[16:19]
    v_mfma_f32_16x16x32_bf16 a[20:23], v[100:103], v[68:71], a[20:23]
    v_mfma_f32_16x16x32_bf16 a[24:27], v[104:107], v[68:71], a[24:27]
    v_mfma_f32_16x16x32_bf16 a[28:31], v[108:111], v[68:71], a[28:31]
    ds_read_b128 v[96:99], v15 offset:32768
    ds_read_b128 v[100:103], v15 offset:33792
    ds_read_b128 v[104:107], v15 offset:34816
    ds_read_b128 v[108:111], v15 offset:35840
    s_waitcnt vmcnt(4) lgkmcnt(4)
    v_mfma_f32_16x16x32_bf16 a[0:3], v[112:115], v[224:227], a[0:3]
    v_mfma_f32_16x16x32_bf16 a[4:7], v[116:119], v[224:227], a[4:7]
    v_mfma_f32_16x16x32_bf16 a[8:11], v[120:123], v[224:227], a[8:11]
    v_mfma_f32_16x16x32_bf16 a[12:15], v[124:127], v[224:227], a[12:15]
    v_mfma_f32_16x16x32_bf16 a[16:19], v[112:115], v[228:231], a[16:19]
    v_mfma_f32_16x16x32_bf16 a[20:23], v[116:119], v[228:231], a[20:23]
    v_mfma_f32_16x16x32_bf16 a[24:27], v[120:123], v[228:231], a[24:27]
    v_mfma_f32_16x16x32_bf16 a[28:31], v[124:127], v[228:231], a[28:31]
    ds_read_b128 v[112:115], v15 offset:36864
    ds_read_b128 v[116:119], v15 offset:37888
    ds_read_b128 v[120:123], v15 offset:38912
    ds_read_b128 v[124:127], v15 offset:39936
    s_waitcnt vmcnt(2) lgkmcnt(4)
    v_mfma_f32_16x16x32_bf16 a[0:3], v[96:99], v[232:235], a[0:3]
    v_mfma_f32_16x16x32_bf16 a[4:7], v[100:103], v[232:235], a[4:7]
    v_mfma_f32_16x16x32_bf16 a[8:11], v[104:107], v[232:235], a[8:11]
    v_mfma_f32_16x16x32_bf16 a[12:15], v[108:111], v[232:235], a[12:15]
    v_mfma_f32_16x16x32_bf16 a[16:19], v[96:99], v[236:239], a[16:19]
    v_mfma_f32_16x16x32_bf16 a[20:23], v[100:103], v[236:239], a[20:23]
    v_mfma_f32_16x16x32_bf16 a[24:27], v[104:107], v[236:239], a[24:27]
    v_mfma_f32_16x16x32_bf16 a[28:31], v[108:111], v[236:239], a[28:31]
    s_waitcnt vmcnt(0) lgkmcnt(0)
    v_mfma_f32_16x16x32_bf16 a[0:3], v[112:115], v[72:75], a[0:3]
    v_mfma_f32_16x16x32_bf16 a[4:7], v[116:119], v[72:75], a[4:7]
    v_mfma_f32_16x16x32_bf16 a[8:11], v[120:123], v[72:75], a[8:11]
    v_mfma_f32_16x16x32_bf16 a[12:15], v[124:127], v[72:75], a[12:15]
    v_mfma_f32_16x16x32_bf16 a[16:19], v[112:115], v[76:79], a[16:19]
    v_mfma_f32_16x16x32_bf16 a[20:23], v[116:119], v[76:79], a[20:23]
    v_mfma_f32_16x16x32_bf16 a[24:27], v[120:123], v[76:79], a[24:27]
    v_mfma_f32_16x16x32_bf16 a[28:31], v[124:127], v[76:79], a[28:31]
    v_mul_u32_u24 v4, 1280, v3
    v_lshl_add_u32 v4, v2, 5, v4
    s_lshl_b32 s20, s3, 12
    v_add_u32 v5, s20, v1
    v_add_u32 v6, 81920, v5
    s_cmp_ge_u32 s3, 2
    s_cbranch_scc1 p2_w
    buffer_load_dwordx4 v[16:19], v4, s[8:11], s30 offen offset:0
    buffer_load_dwordx4 v[20:23], v4, s[8:11], s30 offen offset:16
p2_w:
    s_nop 7
    ds_write_b128 v15, a[0:3] offset:0
    ds_write_b128 v15, a[4:7] offset:1024
    ds_write_b128 v15, a[8:11] offset:2048
    ds_write_b128 v15, a[12:15] offset:3072
    ds_write_b128 v15, a[16:19] offset:4096
    ds_write_b128 v15, a[20:23] offset:5120
    ds_write_b128 v15, a[24:27] offset:6144
    ds_write_b128 v15, a[28:31] offset:7168
    s_waitcnt lgkmcnt(0)
    s_barrier
    s_cbranch_scc1 p2_done
    ds_read_b128 v[32:35], v5 offset:0
    ds_read_b128 v[36:39], v5 offset:1024
    ds_read_b128 v[40:43], v5 offset:2048
    ds_read_b128 v[44:47], v5 offset:3072
    ds_read_b128 v[48:51], v5 offset:40960
    ds_read_b128 v[52:55], v5 offset:41984
    ds_read_b128 v[56:59], v5 offset:43008
    ds_read_b128 v[60:63], v5 offset:44032
    ds_read_b128 v[64:67], v6 offset:0
    ds_read_b128 v[68:71], v6 offset:1024
    ds_read_b128 v[72:75], v6 offset:2048
    ds_read_b128 v[76:79], v6 offset:3072
    ds_read_b128 v[80:83], v6 offset:40960
    ds_read_b128 v[84:87], v6 offset:41984
    ds_read_b128 v[88:91], v6 offset:43008
    ds_read_b128 v[92:95], v6 offset:44032
    s_waitcnt lgkmcnt(8)
    v_add_f32 v32, v32, v48
    v_add_f32 v33, v33, v49
    v_add_f32 v34, v34, v50
    v_add_f32 v35, v35, v51
    v_add_f32 v36, v36, v52
    v_add_f32 v37, v37, v53
    v_add_f32 v38, v38, v54
    v_add_f32 v39, v39, v55
    v_add_f32 v40, v40, v56
    v_add_f32 v41, v41, v57
    v_add_f32 v42, v42, v58
    v_add_f32 v43, v43, v59
    v_add_f32 v44, v44, v60
    v_add_f32 v45, v45, v61
    v_add_f32 v46, v46, v62
    v_add_f32 v47, v47, v63
    s_waitcnt lgkmcnt(4)
    v_add_f32 v32, v32, v64
    v_add_f32 v33, v33, v65
    v_add_f32 v34, v34, v66
    v_add_f32 v35, v35, v67
    v_add_f32 v36, v36, v68
    v_add_f32 v37, v37, v69
    v_add_f32 v38, v38, v70
    v_add_f32 v39, v39, v71
    v_add_f32 v40, v40, v72
    v_add_f32 v41, v41, v73
    v_add_f32 v42, v42, v74
    v_add_f32 v43, v43, v75
    v_add_f32 v44, v44, v76
    v_add_f32 v45, v45, v77
    v_add_f32 v46, v46, v78
    v_add_f32 v47, v47, v79
    s_waitcnt lgkmcnt(0)
    v_add_f32 v32, v32, v80
    v_add_f32 v33, v33, v81
    v_add_f32 v34, v34, v82
    v_add_f32 v35, v35, v83
    v_add_f32 v36, v36, v84
    v_add_f32 v37, v37, v85
    v_add_f32 v38, v38, v86
    v_add_f32 v39, v39, v87
    v_add_f32 v40, v40, v88
    v_add_f32 v41, v41, v89
    v_add_f32 v42, v42, v90
    v_add_f32 v43, v43, v91
    v_add_f32 v44, v44, v92
    v_add_f32 v45, v45, v93
    v_add_f32 v46, v46, v94
    v_add_f32 v47, v47, v95
    s_waitcnt vmcnt(0)
    v_lshlrev_b32 v5, 16, v16
    v_and_b32 v6, s22, v16
    v_add_f32 v5, v5, v32
    v_add_f32 v6, v6, v36
    v_cvt_pk_bf16_f32 v16, v5, v6
    v_lshlrev_b32 v5, 16, v17
    v_and_b32 v6, s22, v17
    v_add_f32 v5, v5, v34
    v_add_f32 v6, v6, v38
    v_cvt_pk_bf16_f32 v17, v5, v6
    v_lshlrev_b32 v5, 16, v18
    v_and_b32 v6, s22, v18
    v_add_f32 v5, v5, v40
    v_add_f32 v6, v6, v44
    v_cvt_pk_bf16_f32 v18, v5, v6
    v_lshlrev_b32 v5, 16, v19
    v_and_b32 v6, s22, v19
    v_add_f32 v5, v5, v42
    v_add_f32 v6, v6, v46
    v_cvt_pk_bf16_f32 v19, v5, v6
    v_lshlrev_b32 v5, 16, v20
    v_and_b32 v6, s22, v20
    v_add_f32 v5, v5, v33
    v_add_f32 v6, v6, v37
    v_cvt_pk_bf16_f32 v20, v5, v6
    v_lshlrev_b32 v5, 16, v21
    v_and_b32 v6, s22, v21
    v_add_f32 v5, v5, v35
    v_add_f32 v6, v6, v39
    v_cvt_pk_bf16_f32 v21, v5, v6
    v_lshlrev_b32 v5, 16, v22
    v_and_b32 v6, s22, v22
    v_add_f32 v5, v5, v41
    v_add_f32 v6, v6, v45
    v_cvt_pk_bf16_f32 v22, v5, v6
    v_lshlrev_b32 v5, 16, v23
    v_and_b32 v6, s22, v23
    v_add_f32 v5, v5, v43
    v_add_f32 v6, v6, v47
    v_cvt_pk_bf16_f32 v23, v5, v6
    buffer_store_dwordx4 v[16:19], v4, s[12:15], s30 offen offset:0
    buffer_store_dwordx4 v[20:23], v4, s[12:15], s30 offen offset:16
    s_waitcnt vmcnt(0)
p2_done:
    s_add_u32 s18, s18, 16
    s_cmp_lt_u32 s18, 64
    s_cbranch_scc1 p2_next
p2_end:
    s_endpgm
ch_entry:
    s_lshr_b32 s20, s2, 3
    s_and_b32 s21, s2, 1
    s_mul_i32 s18, s21, 20
    s_add_u32 s18, s18, s20
    s_getreg_b32 s16, hwreg(HW_REG_XCC_ID)
    s_and_b32 s16, s16, 7
    s_and_b32 s23, s16, 3
    s_lshl_b32 s23, s23, 3
    s_lshl_b32 s23, 1, s23
    s_and_b32 s24, s16, 4
    s_lshl_b32 s17, s21, 6
    s_add_u32 s17, s17, 128
    s_add_u32 s24, s24, s17
    v_mov_b32 v16, s23
    v_lshlrev_b32 v17, 8, v0
    s_cmp_eq_u32 s3, 0
    s_cselect_b32 s24, s24, 256
    s_waitcnt lgkmcnt(0)
    buffer_atomic_add v16, v17, s[72:75], s24 offen
    s_lshl_b32 s22, s20, 3
    s_lshl_b32 s23, s3, 1
    s_add_u32 s22, s22, s23
    s_mul_i32 s22, s22, 20480
    s_mul_i32 s38, s3, 34816
    s_add_u32 s38, s38, 22784
    s_waitcnt lgkmcnt(0)
    s_lshl_b32 s23, s21, 13
    s_add_u32 s40, s22, s23
    s_sub_u32 s42, s22, s23
    s_add_u32 s42, s42, 8192
    s_lshl_b32 s23, s21, 11
    s_add_u32 s41, s22, s23
    s_add_u32 s41, s41, 16384
    s_sub_u32 s43, s22, s23
    s_add_u32 s43, s43, 18432
    s_lshl_b32 s24, s21, 2
    s_add_u32 s24, s24, s3
    s_lshl_b32 s25, s20, 12
    s_add_u32 s25, s25, 24117248
    s_mul_i32 s44, s24, 745472
    s_add_u32 s44, s44, s25
    s_mul_i32 s45, s24, 186368
    s_add_u32 s45, s45, s25
    s_add_u32 s23, s40, 3166208
    s_add_u32 m0, s38, 0
    s_nop 0
    buffer_load_dwordx4 v1, s[4:7], s23 offen offset:0 lds
    buffer_load_dwordx4 v1, s[4:7], s23 offen offset:1024 lds
    s_add_u32 s23, s40, 8409088
    s_add_u32 m0, s38, 2048
    s_nop 0
    buffer_load_dwordx4 v1, s[4:7], s23 offen offset:0 lds
    buffer_load_dwordx4 v1, s[4:7], s23 offen offset:1024 lds
    s_add_u32 s23, s40, 13651968
    s_add_u32 m0, s38, 4096
    s_nop 0
    buffer_load_dwordx4 v1, s[4:7], s23 offen offset:0 lds
    buffer_load_dwordx4 v1, s[4:7], s23 offen offset:1024 lds
    s_add_u32 s23, s40, 3168256
    s_add_u32 m0, s38, 6144
    s_nop 0
    buffer_load_dwordx4 v1, s[4:7], s23 offen offset:0 lds
    buffer_load_dwordx4 v1, s[4:7], s23 offen offset:1024 lds
    s_add_u32 s23, s40, 8411136
    s_add_u32 m0, s38, 8192
    s_nop 0
    buffer_load_dwordx4 v1, s[4:7], s23 offen offset:0 lds
    buffer_load_dwordx4 v1, s[4:7], s23 offen offset:1024 lds
    s_add_u32 s23, s40, 13633536
    s_add_u32 m0, s38, 10240
    s_nop 0
    buffer_load_dwordx4 v1, s[4:7], s23 offen offset:0 lds
    buffer_load_dwordx4 v1, s[4:7], s23 offen offset:1024 lds
    s_add_u32 s23, s40, 13654016
    s_add_u32 m0, s38, 12288
    s_nop 0
    buffer_load_dwordx4 v1, s[4:7], s23 offen offset:0 lds
    buffer_load_dwordx4 v1, s[4:7], s23 offen offset:1024 lds
    s_add_u32 s23, s40, 3170304
    s_add_u32 m0, s38, 14336
    s_nop 0
    buffer_load_dwordx4 v1, s[4:7], s23 offen offset:0 lds
    buffer_load_dwordx4 v1, s[4:7], s23 offen offset:1024 lds
    s_add_u32 s23, s40, 8413184
    s_add_u32 m0, s38, 16384
    s_nop 0
    buffer_load_dwordx4 v1, s[4:7], s23 offen offset:0 lds
    buffer_load_dwordx4 v1, s[4:7], s23 offen offset:1024 lds
    s_add_u32 s23, s40, 13656064
    s_add_u32 m0, s38, 18432
    s_nop 0
    buffer_load_dwordx4 v1, s[4:7], s23 offen offset:0 lds
    buffer_load_dwordx4 v1, s[4:7], s23 offen offset:1024 lds
    s_add_u32 s23, s40, 3172352
    s_add_u32 m0, s38, 20480
    s_nop 0
    buffer_load_dwordx4 v1, s[4:7], s23 offen offset:0 lds
    buffer_load_dwordx4 v1, s[4:7], s23 offen offset:1024 lds
    s_add_u32 s23, s40, 8394752
    s_add_u32 m0, s38, 22528
    s_nop 0
    buffer_load_dwordx4 v1, s[4:7], s23 offen offset:0 lds
    buffer_load_dwordx4 v1, s[4:7], s23 offen offset:1024 lds
    s_add_u32 s23, s40, 8415232
    s_add_u32 m0, s38, 24576
    s_nop 0
    buffer_load_dwordx4 v1, s[4:7], s23 offen offset:0 lds
    buffer_load_dwordx4 v1, s[4:7], s23 offen offset:1024 lds
    s_add_u32 s23, s40, 13658112
    s_add_u32 m0, s38, 26624
    s_nop 0
    buffer_load_dwordx4 v1, s[4:7], s23 offen offset:0 lds
    buffer_load_dwordx4 v1, s[4:7], s23 offen offset:1024 lds
    s_add_u32 s23, s41, 3166208
    s_add_u32 m0, s38, 28672
    s_nop 0
    buffer_load_dwordx4 v1, s[4:7], s23 offen offset:0 lds
    buffer_load_dwordx4 v1, s[4:7], s23 offen offset:1024 lds
    s_add_u32 s23, s41, 8409088
    s_add_u32 m0, s38, 30720
    s_nop 0
    buffer_load_dwordx4 v1, s[4:7], s23 offen offset:0 lds
    buffer_load_dwordx4 v1, s[4:7], s23 offen offset:1024 lds
    s_add_u32 s23, s41, 13651968
    s_add_u32 m0, s38, 32768
    s_nop 0
    buffer_load_dwordx4 v1, s[4:7], s23 offen offset:0 lds
    buffer_load_dwordx4 v1, s[4:7], s23 offen offset:1024 lds
    s_add_u32 s23, s40, 3145728
    buffer_load_dwordx4 a[0:3], v1, s[4:7], s23 offen offset:0
    buffer_load_dwordx4 a[4:7], v1, s[4:7], s23 offen offset:1024
    s_waitcnt vmcnt(40)
    s_add_u32 s23, s40, 8388608
    buffer_load_dwordx4 a[8:11], v1, s[4:7], s23 offen offset:0
    buffer_load_dwordx4 a[12:15], v1, s[4:7], s23 offen offset:1024
    s_waitcnt vmcnt(40)
    s_add_u32 s23, s40, 13631488
    buffer_load_dwordx4 a[16:19], v1, s[4:7], s23 offen offset:0
    buffer_load_dwordx4 a[20:23], v1, s[4:7], s23 offen offset:1024
    s_waitcnt vmcnt(40)
    s_add_u32 s23, s40, 3147776
    buffer_load_dwordx4 a[24:27], v1, s[4:7], s23 offen offset:0
    buffer_load_dwordx4 a[28:31], v1, s[4:7], s23 offen offset:1024
    s_waitcnt vmcnt(40)
    s_add_u32 s23, s40, 8390656
    buffer_load_dwordx4 a[32:35], v1, s[4:7], s23 offen offset:0
    buffer_load_dwordx4 a[36:39], v1, s[4:7], s23 offen offset:1024
    s_waitcnt vmcnt(40)
    s_add_u32 s23, s40, 3149824
    buffer_load_dwordx4 a[40:43], v1, s[4:7], s23 offen offset:0
    buffer_load_dwordx4 a[44:47], v1, s[4:7], s23 offen offset:1024
    s_waitcnt vmcnt(40)
    s_add_u32 s23, s40, 8392704
    buffer_load_dwordx4 a[48:51], v1, s[4:7], s23 offen offset:0
    buffer_load_dwordx4 a[52:55], v1, s[4:7], s23 offen offset:1024
    s_waitcnt vmcnt(40)
    s_add_u32 s23, s40, 13635584
    buffer_load_dwordx4 a[56:59], v1, s[4:7], s23 offen offset:0
    buffer_load_dwordx4 a[60:63], v1, s[4:7], s23 offen offset:1024
    s_waitcnt vmcnt(40)
    s_add_u32 s23, s40, 3151872
    buffer_load_dwordx4 a[64:67], v1, s[4:7], s23 offen offset:0
    buffer_load_dwordx4 a[68:71], v1, s[4:7], s23 offen offset:1024
    s_waitcnt vmcnt(40)
    s_add_u32 s23, s40, 13637632
    buffer_load_dwordx4 a[72:75], v1, s[4:7], s23 offen offset:0
    buffer_load_dwordx4 a[76:79], v1, s[4:7], s23 offen offset:1024
    s_waitcnt vmcnt(40)
    s_add_u32 s23, s41, 3145728
    buffer_load_dwordx4 a[80:83], v1, s[4:7], s23 offen offset:0
    buffer_load_dwordx4 a[84:87], v1, s[4:7], s23 offen offset:1024
    s_waitcnt vmcnt(40)
    s_add_u32 s23, s41, 8388608
    buffer_load_dwordx4 a[88:91], v1, s[4:7], s23 offen offset:0
    buffer_load_dwordx4 a[92:95], v1, s[4:7], s23 offen offset:1024
    s_waitcnt vmcnt(40)
    s_add_u32 s23, s41, 13631488
    buffer_load_dwordx4 a[96:99], v1, s[4:7], s23 offen offset:0
    buffer_load_dwordx4 a[100:103], v1, s[4:7], s23 offen offset:1024
    s_waitcnt vmcnt(40)
    s_add_u32 s23, s42, 3145728
    buffer_load_dwordx4 a[104:107], v1, s[4:7], s23 offen offset:0
    buffer_load_dwordx4 a[108:111], v1, s[4:7], s23 offen offset:1024
    s_waitcnt vmcnt(40)
    s_add_u32 s23, s42, 3166208
    buffer_load_dwordx4 a[112:115], v1, s[4:7], s23 offen offset:0
    buffer_load_dwordx4 a[116:119], v1, s[4:7], s23 offen offset:1024
    s_waitcnt vmcnt(40)
    s_add_u32 s23, s42, 8388608
    buffer_load_dwordx4 a[120:123], v1, s[4:7], s23 offen offset:0
    buffer_load_dwordx4 a[124:127], v1, s[4:7], s23 offen offset:1024
    s_waitcnt vmcnt(40)
    s_add_u32 s23, s42, 8409088
    buffer_load_dwordx4 a[128:131], v1, s[4:7], s23 offen offset:0
    buffer_load_dwordx4 a[132:135], v1, s[4:7], s23 offen offset:1024
    s_waitcnt vmcnt(40)
    s_add_u32 s23, s42, 13631488
    buffer_load_dwordx4 a[136:139], v1, s[4:7], s23 offen offset:0
    buffer_load_dwordx4 a[140:143], v1, s[4:7], s23 offen offset:1024
    s_waitcnt vmcnt(40)
    s_add_u32 s23, s42, 13651968
    buffer_load_dwordx4 a[144:147], v1, s[4:7], s23 offen offset:0
    buffer_load_dwordx4 a[148:151], v1, s[4:7], s23 offen offset:1024
    s_waitcnt vmcnt(40)
    s_add_u32 s23, s42, 3147776
    buffer_load_dwordx4 a[152:155], v1, s[4:7], s23 offen offset:0
    buffer_load_dwordx4 a[156:159], v1, s[4:7], s23 offen offset:1024
    s_waitcnt vmcnt(40)
    s_add_u32 s23, s42, 3168256
    buffer_load_dwordx4 a[160:163], v1, s[4:7], s23 offen offset:0
    buffer_load_dwordx4 a[164:167], v1, s[4:7], s23 offen offset:1024
    s_waitcnt vmcnt(40)
    s_add_u32 s23, s42, 8390656
    buffer_load_dwordx4 a[168:171], v1, s[4:7], s23 offen offset:0
    buffer_load_dwordx4 a[172:175], v1, s[4:7], s23 offen offset:1024
    s_waitcnt vmcnt(40)
    s_add_u32 s23, s42, 8411136
    buffer_load_dwordx4 a[176:179], v1, s[4:7], s23 offen offset:0
    buffer_load_dwordx4 a[180:183], v1, s[4:7], s23 offen offset:1024
    s_waitcnt vmcnt(40)
    s_add_u32 s23, s42, 13633536
    buffer_load_dwordx4 a[184:187], v1, s[4:7], s23 offen offset:0
    buffer_load_dwordx4 a[188:191], v1, s[4:7], s23 offen offset:1024
    s_waitcnt vmcnt(40)
    s_add_u32 s23, s42, 13654016
    buffer_load_dwordx4 a[192:195], v1, s[4:7], s23 offen offset:0
    buffer_load_dwordx4 a[196:199], v1, s[4:7], s23 offen offset:1024
    s_waitcnt vmcnt(40)
    s_add_u32 s23, s42, 3149824
    buffer_load_dwordx4 a[200:203], v1, s[4:7], s23 offen offset:0
    buffer_load_dwordx4 a[204:207], v1, s[4:7], s23 offen offset:1024
    s_waitcnt vmcnt(40)
    s_add_u32 s23, s42, 3170304
    buffer_load_dwordx4 a[208:211], v1, s[4:7], s23 offen offset:0
    buffer_load_dwordx4 a[212:215], v1, s[4:7], s23 offen offset:1024
    s_waitcnt vmcnt(40)
    s_add_u32 s23, s42, 8392704
    buffer_load_dwordx4 a[216:219], v1, s[4:7], s23 offen offset:0
    buffer_load_dwordx4 a[220:223], v1, s[4:7], s23 offen offset:1024
    s_waitcnt vmcnt(40)
    s_add_u32 s23, s42, 8413184
    buffer_load_dwordx4 a[224:227], v1, s[4:7], s23 offen offset:0
    buffer_load_dwordx4 a[228:231], v1, s[4:7], s23 offen offset:1024
    s_waitcnt vmcnt(40)
    s_add_u32 s23, s42, 13635584
    buffer_load_dwordx4 a[232:235], v1, s[4:7], s23 offen offset:0
    buffer_load_dwordx4 a[236:239], v1, s[4:7], s23 offen offset:1024
    s_waitcnt vmcnt(40)
    s_add_u32 s23, s42, 13656064
    buffer_load_dwordx4 a[240:243], v1, s[4:7], s23 offen offset:0
    buffer_load_dwordx4 a[244:247], v1, s[4:7], s23 offen offset:1024
    s_waitcnt vmcnt(40)
    s_add_u32 s23, s42, 3151872
    buffer_load_dwordx4 a[248:251], v1, s[4:7], s23 offen offset:0
    buffer_load_dwordx4 a[252:255], v1, s[4:7], s23 offen offset:1024
    s_waitcnt vmcnt(40)
    s_add_u32 s23, s42, 3172352
    buffer_load_dwordx4 v[88:91], v1, s[4:7], s23 offen offset:0
    buffer_load_dwordx4 v[92:95], v1, s[4:7], s23 offen offset:1024
    s_waitcnt vmcnt(40)
    s_add_u32 s23, s42, 8394752
    buffer_load_dwordx4 v[96:99], v1, s[4:7], s23 offen offset:0
    buffer_load_dwordx4 v[100:103], v1, s[4:7], s23 offen offset:1024
    s_waitcnt vmcnt(40)
    s_add_u32 s23, s42, 8415232
    buffer_load_dwordx4 v[104:107], v1, s[4:7], s23 offen offset:0
    buffer_load_dwordx4 v[108:111], v1, s[4:7], s23 offen offset:1024
    s_waitcnt vmcnt(40)
    s_add_u32 s23, s42, 13637632
    buffer_load_dwordx4 v[112:115], v1, s[4:7], s23 offen offset:0
    buffer_load_dwordx4 v[116:119], v1, s[4:7], s23 offen offset:1024
    s_waitcnt vmcnt(40)
    s_add_u32 s23, s42, 13658112
    buffer_load_dwordx4 v[120:123], v1, s[4:7], s23 offen offset:0
    buffer_load_dwordx4 v[124:127], v1, s[4:7], s23 offen offset:1024
    s_waitcnt vmcnt(40)
    s_add_u32 s23, s43, 3145728
    buffer_load_dwordx4 v[128:131], v1, s[4:7], s23 offen offset:0
    buffer_load_dwordx4 v[132:135], v1, s[4:7], s23 offen offset:1024
    s_waitcnt vmcnt(40)
    s_add_u32 s23, s43, 3166208
    buffer_load_dwordx4 v[136:139], v1, s[4:7], s23 offen offset:0
    buffer_load_dwordx4 v[140:143], v1, s[4:7], s23 offen offset:1024
    s_waitcnt vmcnt(40)
    s_add_u32 s23, s43, 8388608
    buffer_load_dwordx4 v[144:147], v1, s[4:7], s23 offen offset:0
    buffer_load_dwordx4 v[148:151], v1, s[4:7], s23 offen offset:1024
    s_waitcnt vmcnt(40)
    s_add_u32 s23, s43, 8409088
    buffer_load_dwordx4 v[152:155], v1, s[4:7], s23 offen offset:0
    buffer_load_dwordx4 v[156:159], v1, s[4:7], s23 offen offset:1024
    s_waitcnt vmcnt(40)
    s_add_u32 s23, s43, 13631488
    buffer_load_dwordx4 v[160:163], v1, s[4:7], s23 offen offset:0
    buffer_load_dwordx4 v[164:167], v1, s[4:7], s23 offen offset:1024
    s_waitcnt vmcnt(40)
    s_add_u32 s23, s43, 13651968
    buffer_load_dwordx4 v[168:171], v1, s[4:7], s23 offen offset:0
    buffer_load_dwordx4 v[172:175], v1, s[4:7], s23 offen offset:1024
    s_waitcnt vmcnt(40)
    s_add_u32 s23, s44, 0
    buffer_load_dwordx4 v[176:179], v1, s[4:7], s23 offen offset:0
    buffer_load_dwordx4 v[180:183], v1, s[4:7], s23 offen offset:1024
    s_waitcnt vmcnt(40)
    s_add_u32 s23, s44, 2048
    buffer_load_dwordx4 v[184:187], v1, s[4:7], s23 offen offset:0
    buffer_load_dwordx4 v[188:191], v1, s[4:7], s23 offen offset:1024
    s_waitcnt vmcnt(40)
    s_add_u32 s23, s44, 186368
    buffer_load_dwordx4 v[192:195], v1, s[4:7], s23 offen offset:0
    buffer_load_dwordx4 v[196:199], v1, s[4:7], s23 offen offset:1024
    s_waitcnt vmcnt(40)
    s_add_u32 s23, s44, 188416
    buffer_load_dwordx4 v[200:203], v1, s[4:7], s23 offen offset:0
    buffer_load_dwordx4 v[204:207], v1, s[4:7], s23 offen offset:1024
    s_waitcnt vmcnt(40)
    s_add_u32 s23, s44, 372736
    buffer_load_dwordx4 v[208:211], v1, s[4:7], s23 offen offset:0
    buffer_load_dwordx4 v[212:215], v1, s[4:7], s23 offen offset:1024
    s_waitcnt vmcnt(40)
    s_add_u32 s23, s44, 374784
    buffer_load_dwordx4 v[216:219], v1, s[4:7], s23 offen offset:0
    buffer_load_dwordx4 v[220:223], v1, s[4:7], s23 offen offset:1024
    s_waitcnt vmcnt(40)
    s_add_u32 s23, s44, 559104
    buffer_load_dwordx4 v[224:227], v1, s[4:7], s23 offen offset:0
    buffer_load_dwordx4 v[228:231], v1, s[4:7], s23 offen offset:1024
    s_waitcnt vmcnt(40)
    s_add_u32 s23, s44, 561152
    buffer_load_dwordx4 v[232:235], v1, s[4:7], s23 offen offset:0
    buffer_load_dwordx4 v[236:239], v1, s[4:7], s23 offen offset:1024
    s_waitcnt vmcnt(40)
    s_add_u32 s23, s45, 7454720
    buffer_load_dwordx4 v[240:243], v1, s[4:7], s23 offen offset:0
    buffer_load_dwordx4 v[244:247], v1, s[4:7], s23 offen offset:1024
    s_waitcnt vmcnt(40)
    s_add_u32 s23, s45, 7456768
    buffer_load_dwordx4 v[248:251], v1, s[4:7], s23 offen offset:0
    buffer_load_dwordx4 v[252:255], v1, s[4:7], s23 offen offset:1024
    s_waitcnt vmcnt(40)
    s_mov_b32 s26, s21
    s_mov_b32 s27, s20
    s_mov_b32 s29, 858993460
    s_mul_hi_u32 s28, s27, s29
    s_mul_i32 s29, s28, 5
    s_sub_u32 s29, s27, s29
    v_mov_b32 v80, v2
    v_mov_b32 v81, v3
    v_mov_b32 v82, v0
    s_mov_b32 s33, 0x7ffffff0
    v_mov_b32 v87, s33
    v_lshlrev_b32 v79, 2, v82
    v_add_u32 v10, s38, v1
    s_lshl_b32 s23, s3, 6
    s_add_u32 s23, s23, 18432
    v_mul_u32_u24 v0, 544, v80
    v_lshrrev_b32 v83, 2, v81
    v_lshl_add_u32 v0, v83, 4, v0
    v_and_b32 v84, 3, v81
    v_lshl_add_u32 v0, v84, 1, v0
    v_add_u32 v0, s23, v0
    v_and_b32 v86, 1, v81
    v_lshl_add_u32 v85, v83, 1, v86
    v_cmp_eq_u32 vcc, 1, v86
    v_mov_b32 v4, 0x44444444
    v_mov_b32 v5, 0xeeeeeeee
    v_cndmask_b32 v4, v4, v5, vcc
    v_cmp_le_u32 vcc, 2, v84
    v_mul_u32_u24 v2, 272, v85
    v_lshl_add_u32 v2, v80, 4, v2
    v_add_u32 v2, 18432, v2
    v_add_u32 v3, 2176, v2
    v_cndmask_b32 v2, v3, v2, vcc
    s_lshl_b32 s23, s3, 9
    v_lshrrev_b32 v3, 1, v80
    v_lshlrev_b32 v3, 8, v3
    v_lshl_add_u32 v3, v85, 5, v3
    v_and_b32 v6, 1, v80
    v_lshl_add_u32 v3, v6, 3, v3
    v_add_u32 v3, s23, v3
    v_mov_b32 v6, 162048
    v_lshl_add_u32 v6, v82, 3, v6
    v_cndmask_b32 v3, v6, v3, vcc
    s_lshl_b32 s23, s3, 8
    s_add_u32 s23, s23, 4096
    v_add_u32 v5, s23, v79
    s_lshl_b32 s23, s3, 10
    v_add_u32 v8, s23, v1
    s_mul_i32 s23, s21, 20
    s_mul_i32 s24, s3, 5
    s_add_u32 s23, s23, s24
    s_lshl_b32 s23, s23, 13
    s_lshl_b32 s24, s20, 8
    s_add_u32 s23, s23, s24
    v_lshlrev_b32 v6, 13, v80
    v_lshl_add_u32 v6, v81, 4, v6
    v_add_u32 v6, s23, v6
    s_add_u32 s23, s23, 0x8000
    v_add_u32 v7, s23, v79
    v_cmp_eq_u32 vcc, 0, v84
    s_lshl_b32 s18, s18, 13
    s_nop 0
    v_cndmask_b32 v7, v87, v7, vcc
    v_bfe_u32 v9, v81, 1, 1
    v_lshlrev_b32 v9, 4, v9
    v_lshl_add_u32 v9, v80, 5, v9
    s_cmp_eq_u32 s29, 4
    s_cselect_b32 s23, 6, 8
    v_lshlrev_b32 v12, s23, v83
    v_add_u32 v9, v9, v12
    s_lshl_b32 s23, s28, 10
    s_lshl_b32 s24, s29, 6
    s_add_u32 s23, s23, s24
    s_lshl_b32 s24, s28, 8
    s_add_u32 s24, s24, 4096
    s_cmp_eq_u32 s29, 4
    s_cselect_b32 s23, s24, s23
    v_add_u32 v9, s23, v9
    v_and_b32 v12, 33, v82
    v_cmp_eq_u32 vcc, 0, v12
    s_mul_i32 s23, s21, 5120
    s_add_u32 s50, s23, 121634816
    v_cndmask_b32 v9, v87, v9, vcc
    s_sub_u32 s51, 121650176, s23
    s_mov_b32 s52, 122945536
    v_mov_b32 v12, 0x3f803f80
    v_mov_b32 v13, v12
    v_mov_b32 v14, v12
    v_mov_b32 v15, v12
    s_lshr_b32 s23, s3, 1
    s_lshl_b32 s23, s23, 17
    s_and_b32 s24, s3, 1
    s_lshl_b32 s24, s24, 11
    s_add_u32 s23, s23, s24
    s_lshl_b32 s24, s20, 12
    s_add_u32 s54, s23, s24
    s_add_u32 s54, s54, 50331648
    s_add_u32 s56, s24, 109051904
    s_lshl_b32 s23, s20, 13
    s_lshl_b32 s24, s3, 11
    s_add_u32 s55, s23, s24
    s_lshr_b32 s57, s55, 2
    s_add_u32 s55, s55, 67108864
    s_add_u32 s57, s57, 117440512
    s_add_u32 s39, s24, 10240
    s_mul_i32 s32, s21, 3
    s_xor_b32 s32, s32, s3
    s_mov_b32 s58, 0
    s_mov_b32 s59, 0x3e0293ee
    s_mov_b32 s34, 400000
    v_lshlrev_b32 v16, 2, v1
    v_min_u32 v16, 960, v16
    s_lshl_b32 s23, s20, 11
    s_add_u32 s23, s23, 143605760
ch_k0:
    buffer_load_dword v17, v16, s[4:7], s23 offen sc1
    s_waitcnt vmcnt(0)
    v_cmp_eq_u32 vcc, -1, v17
    s_cbranch_vccz ch_k0_ok
    s_sleep 8
    s_sub_u32 s34, s34, 1
    s_cbranch_scc0 ch_k0
    s_endpgm
ch_k0_ok:
    s_mov_b32 m0, s39
    s_nop 0
    buffer_load_dwordx4 v1, s[4:7], s54 offen lds
    buffer_load_dwordx4 v1, s[4:7], s54 offen offset:1024 lds
    s_add_u32 s54, s54, 0x40000
    buffer_load_dwordx4 v[80:83], v1, s[4:7], s55 offen
    buffer_load_dwordx4 v[84:87], v1, s[4:7], s55 offen offset:1024
    s_add_u32 s55, s55, 0x40000
    v_mov_b32 v17, 0
ch_xp:
    buffer_load_dwordx2 v[18:19], v17, s[72:75], s17 offen sc1
    s_waitcnt vmcnt(0)
    v_sad_u8 v20, v18, 0, 0
    v_sad_u8 v20, v19, 0, v20
    v_cmp_eq_u32 vcc, 32, v20
    s_cbranch_vccnz ch_xok
    s_sleep 8
    s_sub_u32 s34, s34, 1
    s_cbranch_scc0 ch_xp
    s_endpgm
ch_xok:
    v_readfirstlane_b32 s24, v18
    v_readfirstlane_b32 s25, v19
    s_lshl_b32 s23, s16, 3
    s_lshr_b64 s[24:25], s[24:25], s23
    s_and_b32 s15, s24, 0xff
ch_loop:
    s_cmp_lg_u32 s32, 3
    s_cbranch_scc1 ch_nored
    s_cmp_eq_u32 s58, 0
    s_cbranch_scc1 ch_nored
    s_cmp_ge_u32 s20, 20
    s_cbranch_scc1 ch_nored
    s_add_u32 s46, s52, s18
    s_add_u32 s47, s46, 4096
    s_add_u32 s49, s50, 10240
    s_sleep 1
    buffer_load_dwordx4 v[16:19], v1, s[4:7], s46 offen offset:0 sc1
    buffer_load_dwordx4 v[20:23], v1, s[4:7], s46 offen offset:1024 sc1
    buffer_load_dwordx4 v[24:27], v1, s[4:7], s46 offen offset:2048 sc1
    buffer_load_dwordx4 v[28:31], v1, s[4:7], s46 offen offset:3072 sc1
    buffer_load_dwordx4 v[32:35], v1, s[4:7], s47 offen offset:0 sc1
    buffer_load_dwordx4 v[36:39], v1, s[4:7], s47 offen offset:1024 sc1
    buffer_load_dwordx4 v[40:43], v1, s[4:7], s47 offen offset:2048 sc1
    buffer_load_dwordx4 v[44:47], v1, s[4:7], s47 offen offset:3072 sc1
    v_bfe_u32 v52, v1, 4, 2
    v_bfe_u32 v53, v1, 6, 1
    v_lshlrev_b32 v53, 4, v53
    v_mov_b32 v54, 0x3f80
    v_lshlrev_b32 v53, v53, v54
    v_cmp_eq_u32 vcc, 0, v52
    s_nop 1
    v_cndmask_b32 v48, 0, v53, vcc
    v_cmp_eq_u32 vcc, 1, v52
    s_nop 1
    v_cndmask_b32 v49, 0, v53, vcc
    v_cmp_eq_u32 vcc, 2, v52
    s_nop 1
    v_cndmask_b32 v50, 0, v53, vcc
    v_cmp_eq_u32 vcc, 3, v52
    s_nop 1
    v_cndmask_b32 v51, 0, v53, vcc
    v_mov_b32 v56, 0
    v_mov_b32 v57, 0
    v_mov_b32 v58, 0
    v_mov_b32 v59, 0
    v_mov_b32 v60, 0
    v_mov_b32 v61, 0
    v_mov_b32 v62, 0
    v_mov_b32 v63, 0
    v_mov_b32 v64, 0
    v_mov_b32 v65, 0
    v_mov_b32 v66, 0
    v_mov_b32 v67, 0
    v_mov_b32 v68, 0
    v_mov_b32 v69, 0
    v_mov_b32 v70, 0
    v_mov_b32 v71, 0
    v_mov_b32 v72, 0
    v_mov_b32 v73, 0
    v_mov_b32 v74, 0
    v_mov_b32 v75, 0
    v_mov_b32 v76, 0
    v_mov_b32 v77, 0
    v_mov_b32 v78, 0
    v_mov_b32 v79, 0
ch_p1:
    s_waitcnt vmcnt(7)
    v_mfma_f32_16x16x32_bf16 v[52:55], v[48:51], v[16:19], 0
    v_max3_u32 v11, v16, v17, v17
    v_max3_u32 v11, v18, v19, v11
    s_waitcnt vmcnt(6)
    v_mfma_f32_16x16x32_bf16 v[52:55], v[48:51], v[20:23], v[52:55]
    v_max3_u32 v11, v20, v21, v11
    v_max3_u32 v11, v22, v23, v11
    s_waitcnt vmcnt(5)
    v_mfma_f32_16x16x32_bf16 v[52:55], v[48:51], v[24:27], v[52:55]
    v_max3_u32 v11, v24, v25, v11
    v_max3_u32 v11, v26, v27, v11
    s_waitcnt vmcnt(4)
    v_mfma_f32_16x16x32_bf16 v[52:55], v[48:51], v[28:31], v[52:55]
    v_max3_u32 v11, v28, v29, v11
    v_max3_u32 v11, v30, v31, v11
    s_waitcnt vmcnt(3)
    v_mfma_f32_16x16x32_bf16 v[52:55], v[48:51], v[32:35], v[52:55]
    v_max3_u32 v11, v32, v33, v11
    v_max3_u32 v11, v34, v35, v11
    s_waitcnt vmcnt(2)
    v_mfma_f32_16x16x32_bf16 v[52:55], v[48:51], v[36:39], v[52:55]
    v_max3_u32 v11, v36, v37, v11
    v_max3_u32 v11, v38, v39, v11
    s_waitcnt vmcnt(1)
    v_mfma_f32_16x16x32_bf16 v[52:55], v[48:51], v[40:43], v[52:55]
    v_max3_u32 v11, v40, v41, v11
    v_max3_u32 v11, v42, v43, v11
    s_waitcnt vmcnt(0)
    v_mfma_f32_16x16x32_bf16 v[52:55], v[48:51], v[44:47], v[52:55]
    v_max3_u32 v11, v44, v45, v11
    v_max3_u32 v11, v46, v47, v11
    v_cmp_eq_u32 vcc, -1, v11
    s_cbranch_vccz ch_p1_ok
    s_sub_u32 s34, s34, 1
    s_cbranch_scc1 ch_end
    buffer_load_dwordx4 v[16:19], v1, s[4:7], s46 offen offset:0 sc1
    buffer_load_dwordx4 v[20:23], v1, s[4:7], s46 offen offset:1024 sc1
    buffer_load_dwordx4 v[24:27], v1, s[4:7], s46 offen offset:2048 sc1
    buffer_load_dwordx4 v[28:31], v1, s[4:7], s46 offen offset:3072 sc1
    buffer_load_dwordx4 v[32:35], v1, s[4:7], s47 offen offset:0 sc1
    buffer_load_dwordx4 v[36:39], v1, s[4:7], s47 offen offset:1024 sc1
    buffer_load_dwordx4 v[40:43], v1, s[4:7], s47 offen offset:2048 sc1
    buffer_load_dwordx4 v[44:47], v1, s[4:7], s47 offen offset:3072 sc1
    s_branch ch_p1
ch_p1_ok:
    s_nop 3
    v_cvt_pk_bf16_f32 v52, v52, v53
    v_cvt_pk_bf16_f32 v53, v54, v55
    v_min_u32 v52, -2, v52
    v_min_u32 v53, -2, v53
    s_nop 1
    v_mov_b32_dpp v54, v52 quad_perm:[1,1,3,3] row_mask:0xf bank_mask:0xf
    v_mov_b32_dpp v55, v53 quad_perm:[1,1,3,3] row_mask:0xf bank_mask:0xf
    buffer_store_dwordx4 v[52:55], v9, s[4:7], s49 offen sc1
    s_cmp_eq_u32 s15, 32
    s_cbranch_scc1 ch_l2
    buffer_store_dwordx4 v[52:55], v9, s[4:7], s50 offen sc1
    s_branch ch_m2
ch_l2:
    buffer_store_dwordx4 v[52:55], v9, s[4:7], s50 offen
ch_m2:
    s_sleep 0
    s_branch ch_pl
ch_nored:
    v_mov_b32 v56, 0
    v_mov_b32 v57, 0
    v_mov_b32 v58, 0
    v_mov_b32 v59, 0
    v_mov_b32 v60, 0
    v_mov_b32 v61, 0
    v_mov_b32 v62, 0
    v_mov_b32 v63, 0
    v_mov_b32 v64, 0
    v_mov_b32 v65, 0
    v_mov_b32 v66, 0
    v_mov_b32 v67, 0
    v_mov_b32 v68, 0
    v_mov_b32 v69, 0
    v_mov_b32 v70, 0
    v_mov_b32 v71, 0
    v_mov_b32 v72, 0
    v_mov_b32 v73, 0
    v_mov_b32 v74, 0
    v_mov_b32 v75, 0
    v_mov_b32 v76, 0
    v_mov_b32 v77, 0
    v_mov_b32 v78, 0
    v_mov_b32 v79, 0
    s_cmp_lg_u32 s58, 24
    s_cbranch_scc1 ch_sl
    v_lshrrev_b32 v16, 2, v1
    v_min_u32 v16, 28, v16
ch_k1:
    buffer_load_dword v17, v16, s[72:75], 0 offen sc1
    s_waitcnt vmcnt(0)
    v_cmp_ne_u32 vcc, 0x1e0020, v17
    s_cbranch_vccz ch_k1_ok
    s_sleep 8
    s_sub_u32 s34, s34, 1
    s_cbranch_scc0 ch_k1
    s_endpgm
ch_k1_ok:
    s_branch ch_pl
ch_sl:
    s_sleep 12
ch_pl:
    buffer_load_dwordx4 v[52:55], v8, s[4:7], s50 offen sc1
    buffer_load_dword v11, v5, s[4:7], s50 offen sc1
ch_p2:
    s_waitcnt vmcnt(0)
    v_max3_u32 v36, v52, v53, v54
    v_max3_u32 v36, v36, v55, v11
    v_cmp_eq_u32 vcc, -1, v36
    s_cbranch_vccz ch_p2_ok
    s_sub_u32 s34, s34, 1
    s_cbranch_scc1 ch_end
    buffer_load_dwordx4 v[52:55], v8, s[4:7], s50 offen sc1
    buffer_load_dword v11, v5, s[4:7], s50 offen sc1
    s_branch ch_p2
ch_p2_ok:
    ds_write_b128 v8, v[52:55] offset:0
    ds_write_b32 v5, v11 offset:0
    ds_read_b128 v[36:39], v10 offset:0
    ds_read_b128 v[40:43], v10 offset:1024
    ds_read_b128 v[44:47], v10 offset:2048
    ds_read_b128 v[48:51], v10 offset:3072
    s_waitcnt lgkmcnt(4)
    s_barrier
    ds_read_b128 v[16:19], v1 offset:0
    ds_read_b128 v[20:23], v1 offset:1024
    ds_read_b128 v[24:27], v1 offset:2048
    ds_read_b128 v[28:31], v1 offset:3072
    ds_read_b128 v[32:35], v1 offset:4096
    s_cmp_lg_u32 s58, 0
    s_cselect_b32 s23, 0x50000, 0
    s_add_u32 s52, s52, s23
    s_add_u32 s50, s50, 20480
    s_waitcnt lgkmcnt(4)
    v_smfmac_f32_16x16x64_bf16 v[56:59], v[16:19], a[0:7], v4
    v_smfmac_f32_16x16x64_bf16 v[60:63], v[16:19], v[36:43], v4
    ds_read_b128 v[36:39], v10 offset:4096
    ds_read_b128 v[40:43], v10 offset:5120
    v_smfmac_f32_16x16x64_bf16 v[64:67], v[16:19], a[8:15], v4
    v_smfmac_f32_16x16x64_bf16 v[68:71], v[16:19], v[44:51], v4
    ds_read_b128 v[44:47], v10 offset:6144
    ds_read_b128 v[48:51], v10 offset:7168
    v_smfmac_f32_16x16x64_bf16 v[72:75], v[16:19], a[16:23], v4
    buffer_load_dwordx4 v[52:55], v8, s[4:7], s51 offen sc1
    buffer_load_dword v11, v5, s[4:7], s51 offen sc1
    s_waitcnt lgkmcnt(2)
    v_smfmac_f32_16x16x64_bf16 v[76:79], v[16:19], v[36:43], v4
    ds_read_b128 v[36:39], v10 offset:8192
    ds_read_b128 v[40:43], v10 offset:9216
    v_smfmac_f32_16x16x64_bf16 v[56:59], v[20:23], a[24:31], v4
    s_waitcnt lgkmcnt(2)
    v_smfmac_f32_16x16x64_bf16 v[60:63], v[20:23], v[44:51], v4
    ds_read_b128 v[44:47], v10 offset:10240
    ds_read_b128 v[48:51], v10 offset:11264
    v_smfmac_f32_16x16x64_bf16 v[64:67], v[20:23], a[32:39], v4
    s_waitcnt lgkmcnt(2)
    v_smfmac_f32_16x16x64_bf16 v[68:71], v[20:23], v[36:43], v4
    ds_read_b128 v[36:39], v10 offset:12288
    ds_read_b128 v[40:43], v10 offset:13312
    s_waitcnt lgkmcnt(2)
    v_smfmac_f32_16x16x64_bf16 v[72:75], v[20:23], v[44:51], v4
    ds_read_b128 v[44:47], v10 offset:14336
    ds_read_b128 v[48:51], v10 offset:15360
    s_waitcnt lgkmcnt(2)
    v_smfmac_f32_16x16x64_bf16 v[76:79], v[20:23], v[36:43], v4
    ds_read_b128 v[36:39], v10 offset:16384
    ds_read_b128 v[40:43], v10 offset:17408
    v_smfmac_f32_16x16x64_bf16 v[56:59], v[24:27], a[40:47], v4
    s_waitcnt lgkmcnt(2)
    v_smfmac_f32_16x16x64_bf16 v[60:63], v[24:27], v[44:51], v4
    ds_read_b128 v[44:47], v10 offset:18432
    ds_read_b128 v[48:51], v10 offset:19456
    v_smfmac_f32_16x16x64_bf16 v[64:67], v[24:27], a[48:55], v4
    s_waitcnt lgkmcnt(2)
    v_smfmac_f32_16x16x64_bf16 v[68:71], v[24:27], v[36:43], v4
    ds_read_b128 v[36:39], v10 offset:20480
    ds_read_b128 v[40:43], v10 offset:21504
    v_smfmac_f32_16x16x64_bf16 v[72:75], v[24:27], a[56:63], v4
    s_waitcnt lgkmcnt(2)
    v_smfmac_f32_16x16x64_bf16 v[76:79], v[24:27], v[44:51], v4
    ds_read_b128 v[44:47], v10 offset:22528
    ds_read_b128 v[48:51], v10 offset:23552
    v_smfmac_f32_16x16x64_bf16 v[56:59], v[28:31], a[64:71], v4
    s_waitcnt lgkmcnt(2)
    v_smfmac_f32_16x16x64_bf16 v[60:63], v[28:31], v[36:43], v4
    ds_read_b128 v[36:39], v10 offset:24576
    ds_read_b128 v[40:43], v10 offset:25600
    s_waitcnt lgkmcnt(2)
    v_smfmac_f32_16x16x64_bf16 v[64:67], v[28:31], v[44:51], v4
    ds_read_b128 v[44:47], v10 offset:26624
    ds_read_b128 v[48:51], v10 offset:27648
    s_waitcnt lgkmcnt(2)
    v_smfmac_f32_16x16x64_bf16 v[68:71], v[28:31], v[36:43], v4
    ds_read_b128 v[36:39], v10 offset:28672
    ds_read_b128 v[40:43], v10 offset:29696
    v_smfmac_f32_16x16x64_bf16 v[72:75], v[28:31], a[72:79], v4
    s_waitcnt lgkmcnt(2)
    v_smfmac_f32_16x16x64_bf16 v[76:79], v[28:31], v[44:51], v4
    ds_read_b128 v[44:47], v10 offset:30720
    ds_read_b128 v[48:51], v10 offset:31744
    v_smfmac_f32_16x16x64_bf16 v[56:59], v[32:35], a[80:87], v4
    s_waitcnt lgkmcnt(2)
    v_smfmac_f32_16x16x64_bf16 v[60:63], v[32:35], v[36:43], v4
    ds_read_b128 v[36:39], v10 offset:32768
    ds_read_b128 v[40:43], v10 offset:33792
    v_smfmac_f32_16x16x64_bf16 v[64:67], v[32:35], a[88:95], v4
    s_waitcnt lgkmcnt(2)
    v_smfmac_f32_16x16x64_bf16 v[68:71], v[32:35], v[44:51], v4
    v_smfmac_f32_16x16x64_bf16 v[72:75], v[32:35], a[96:103], v4
    s_waitcnt lgkmcnt(0)
    v_smfmac_f32_16x16x64_bf16 v[76:79], v[32:35], v[36:43], v4
ch_p3:
    s_waitcnt vmcnt(0)
    v_max3_u32 v36, v52, v53, v54
    v_max3_u32 v36, v36, v55, v11
    v_cmp_eq_u32 vcc, -1, v36
    s_cbranch_vccz ch_p3_ok
    s_sub_u32 s34, s34, 1
    s_cbranch_scc1 ch_end
    buffer_load_dwordx4 v[52:55], v8, s[4:7], s51 offen sc1
    buffer_load_dword v11, v5, s[4:7], s51 offen sc1
    s_branch ch_p3
ch_p3_ok:
    ds_write_b128 v8, v[52:55] offset:5120
    ds_write_b32 v5, v11 offset:5120
    s_waitcnt lgkmcnt(0)
    s_barrier
    ds_read_b128 v[16:19], v1 offset:5120
    ds_read_b128 v[20:23], v1 offset:6144
    ds_read_b128 v[24:27], v1 offset:7168
    ds_read_b128 v[28:31], v1 offset:8192
    ds_read_b128 v[32:35], v1 offset:9216
    s_add_u32 s51, s51, 20480
    s_waitcnt lgkmcnt(4)
    v_smfmac_f32_16x16x64_bf16 v[56:59], v[16:19], a[104:111], v4
    v_smfmac_f32_16x16x64_bf16 v[60:63], v[16:19], a[112:119], v4
    v_smfmac_f32_16x16x64_bf16 v[64:67], v[16:19], a[120:127], v4
    v_smfmac_f32_16x16x64_bf16 v[68:71], v[16:19], a[128:135], v4
    s_waitcnt lgkmcnt(3)
    v_smfmac_f32_16x16x64_bf16 v[56:59], v[20:23], a[152:159], v4
    v_smfmac_f32_16x16x64_bf16 v[60:63], v[20:23], a[160:167], v4
    v_smfmac_f32_16x16x64_bf16 v[64:67], v[20:23], a[168:175], v4
    v_smfmac_f32_16x16x64_bf16 v[68:71], v[20:23], a[176:183], v4
    s_mov_b32 m0, 162048
    v_and_b32 v11, 0xf0, v1
    v_lshlrev_b32 v11, 3, v11
    s_cmp_eq_u32 s58, 63
    s_cbranch_scc1 ch_nw
    buffer_load_dword v11, s[4:7], s54 offen lds
    buffer_load_dword v11, s[4:7], s55 offen lds
ch_nw:
    ds_read_b128 v[36:39], v1 offset:10240
    ds_read_b128 v[40:43], v1 offset:14336
    ds_read_b128 v[44:47], v1 offset:11264
    ds_read_b128 v[48:51], v1 offset:15360
    ds_read_b128 v[52:55], v1 offset:12288
    s_waitcnt lgkmcnt(7)
    v_smfmac_f32_16x16x64_bf16 v[56:59], v[24:27], a[200:207], v4
    v_smfmac_f32_16x16x64_bf16 v[60:63], v[24:27], a[208:215], v4
    v_smfmac_f32_16x16x64_bf16 v[64:67], v[24:27], a[216:223], v4
    v_smfmac_f32_16x16x64_bf16 v[68:71], v[24:27], a[224:231], v4
    s_waitcnt lgkmcnt(6)
    v_smfmac_f32_16x16x64_bf16 v[56:59], v[28:31], a[248:255], v4
    v_smfmac_f32_16x16x64_bf16 v[60:63], v[28:31], v[88:95], v4
    v_smfmac_f32_16x16x64_bf16 v[64:67], v[28:31], v[96:103], v4
    v_smfmac_f32_16x16x64_bf16 v[68:71], v[28:31], v[104:111], v4
    s_waitcnt lgkmcnt(5)
    v_smfmac_f32_16x16x64_bf16 v[56:59], v[32:35], v[128:135], v4
    v_smfmac_f32_16x16x64_bf16 v[60:63], v[32:35], v[136:143], v4
    v_smfmac_f32_16x16x64_bf16 v[64:67], v[32:35], v[144:151], v4
    v_smfmac_f32_16x16x64_bf16 v[68:71], v[32:35], v[152:159], v4
    v_smfmac_f32_16x16x64_bf16 v[72:75], v[32:35], v[160:167], v4
    v_smfmac_f32_16x16x64_bf16 v[76:79], v[32:35], v[168:175], v4
    ds_read_b128 v[32:35], v1 offset:16384
    v_smfmac_f32_16x16x64_bf16 v[72:75], v[16:19], a[136:143], v4
    v_smfmac_f32_16x16x64_bf16 v[76:79], v[16:19], a[144:151], v4
    v_add_f32 v56, v56, v57
    v_add_f32 v58, v58, v59
    v_cvt_pk_bf16_f32 v56, v56, v58
    ds_write_b16 v0, v56 offset:0
    ds_write_b16_d16_hi v0, v56 offset:272
    v_smfmac_f32_16x16x64_bf16 v[72:75], v[20:23], a[184:191], v4
    v_add_f32 v60, v60, v61
    v_add_f32 v62, v62, v63
    v_cvt_pk_bf16_f32 v60, v60, v62
    ds_write_b16 v0, v60 offset:8
    ds_write_b16_d16_hi v0, v60 offset:280
    v_smfmac_f32_16x16x64_bf16 v[76:79], v[20:23], a[192:199], v4
    v_add_f32 v64, v64, v65
    v_add_f32 v66, v66, v67
    v_cvt_pk_bf16_f32 v64, v64, v66
    ds_write_b16 v0, v64 offset:2176
    ds_write_b16_d16_hi v0, v64 offset:2448
    v_smfmac_f32_16x16x64_bf16 v[72:75], v[24:27], a[232:239], v4
    v_add_f32 v68, v68, v69
    v_add_f32 v70, v70, v71
    v_cvt_pk_bf16_f32 v68, v68, v70
    ds_write_b16 v0, v68 offset:2184
    ds_write_b16_d16_hi v0, v68 offset:2456
    v_smfmac_f32_16x16x64_bf16 v[76:79], v[24:27], a[240:247], v4
    v_smfmac_f32_16x16x64_bf16 v[72:75], v[28:31], v[112:119], v4
    v_smfmac_f32_16x16x64_bf16 v[76:79], v[28:31], v[120:127], v4
    s_waitcnt lgkmcnt(0)
    s_barrier
    ds_read_b128 v[16:19], v2 offset:0
    ds_read_b128 v[20:23], v2 offset:64
    ds_read_b128 v[24:27], v2 offset:128
    ds_read_b128 v[28:31], v2 offset:192
    s_waitcnt lgkmcnt(3)
    v_mfma_f32_16x16x32_bf16 v[56:59], v[16:19], v[16:19], 0
    v_mfma_f32_16x16x32_bf16 v[60:63], v[36:39], v[16:19], 0
    v_mfma_f32_16x16x32_bf16 v[64:67], v[40:43], v[16:19], 0
    ds_read_b128 v[36:39], v1 offset:13312
    ds_read_b128 v[40:43], v1 offset:17408
    s_waitcnt lgkmcnt(4)
    v_mfma_f32_16x16x32_bf16 v[56:59], v[20:23], v[20:23], v[56:59]
    v_mfma_f32_16x16x32_bf16 v[60:63], v[44:47], v[20:23], v[60:63]
    v_mfma_f32_16x16x32_bf16 v[64:67], v[48:51], v[20:23], v[64:67]
    s_waitcnt lgkmcnt(3)
    v_mfma_f32_16x16x32_bf16 v[56:59], v[24:27], v[24:27], v[56:59]
    v_mfma_f32_16x16x32_bf16 v[60:63], v[52:55], v[24:27], v[60:63]
    v_mfma_f32_16x16x32_bf16 v[64:67], v[32:35], v[24:27], v[64:67]
    s_waitcnt lgkmcnt(0)
    v_mfma_f32_16x16x32_bf16 v[56:59], v[28:31], v[28:31], v[56:59]
    v_mfma_f32_16x16x32_bf16 v[60:63], v[36:39], v[28:31], v[60:63]
    v_mfma_f32_16x16x32_bf16 v[64:67], v[40:43], v[28:31], v[64:67]
    v_add_f32 v72, v72, v73
    v_add_f32 v74, v74, v75
    v_cvt_pk_bf16_f32 v72, v72, v74
    v_add_f32 v76, v76, v77
    v_add_f32 v78, v78, v79
    v_cvt_pk_bf16_f32 v76, v76, v78
    v_mov_b32 v73, 0
    v_mov_b32 v77, 0
    v_max3_f32 v68, v56, v57, v60
    v_max3_f32 v69, v61, v62, v63
    v_max3_f32 v68, v68, v64, v65
    v_max3_f32 v69, v69, v66, v67
    v_max_f32 v68, v68, v69
    v_mov_b32 v69, v68
    v_mov_b32 v36, 0
    v_mov_b32 v37, 0
    v_permlane32_swap_b32 v69, v68
    v_mov_b32 v38, 0
    v_max_f32 v68, v68, v69
    v_mov_b32 v69, v68
    v_mov_b32 v39, 0
    v_mov_b32 v40, 0
    v_permlane16_swap_b32 v69, v68
    v_mov_b32 v41, 0
    v_max_f32 v68, v68, v69
    v_mul_f32 v68, s59, v68
    v_fma_f32 v60, v60, s59, -v68
    v_fma_f32 v61, v61, s59, -v68
    v_fma_f32 v62, v62, s59, -v68
    v_fma_f32 v63, v63, s59, -v68
    v_fma_f32 v64, v64, s59, -v68
    v_fma_f32 v65, v65, s59, -v68
    v_fma_f32 v66, v66, s59, -v68
    v_fma_f32 v67, v67, s59, -v68
    v_fma_f32 v56, v56, s59, -v68
    v_fma_f32 v57, v57, s59, -v68
    v_exp_f32 v60, v60
    v_exp_f32 v61, v61
    v_exp_f32 v62, v62
    v_exp_f32 v63, v63
    v_exp_f32 v64, v64
    v_exp_f32 v65, v65
    v_exp_f32 v66, v66
    v_exp_f32 v67, v67
    v_exp_f32 v56, v56
    v_exp_f32 v57, v57
    v_cvt_pk_bf16_f32 v68, v60, v61
    v_cvt_pk_bf16_f32 v69, v62, v63
    v_cvt_pk_bf16_f32 v70, v64, v65
    v_cvt_pk_bf16_f32 v71, v66, v67
    v_cvt_pk_bf16_f32 v58, v56, v57
    v_mov_b32 v59, 0
    v_mfma_f32_16x16x32_bf16 v[32:35], v[12:15], v[68:71], 0
    v_mfma_f32_16x16x32_bf16 v[60:63], v[80:83], v[68:71], 0
    v_mfma_f32_16x16x32_bf16 v[64:67], v[84:87], v[68:71], 0
    v_mfma_f32_16x16x16_bf16 v[32:35], v[12:13], v[58:59], v[32:35]
    v_mfma_f32_16x16x16_bf16 v[60:63], v[72:73], v[58:59], v[60:63]
    v_mfma_f32_16x16x16_bf16 v[64:67], v[76:77], v[58:59], v[64:67]
    v_mov_b32 v42, 0
    v_mov_b32 v43, 0
    v_mov_b32 v44, 0
    v_mov_b32 v45, 0
    v_mov_b32 v46, 0
    v_mov_b32 v47, 0
    v_rcp_f32 v32, v32
    v_mov_b32 v48, 0
    v_mov_b32 v49, 0
    v_mul_f32 v60, v60, v32
    v_mul_f32 v61, v61, v32
    v_mul_f32 v62, v62, v32
    v_mul_f32 v63, v63, v32
    v_mul_f32 v64, v64, v32
    v_mul_f32 v65, v65, v32
    v_mul_f32 v66, v66, v32
    v_mul_f32 v67, v67, v32
    v_cvt_pk_bf16_f32 v68, v60, v61
    v_cvt_pk_bf16_f32 v69, v64, v65
    v_cvt_pk_bf16_f32 v70, v62, v63
    v_cvt_pk_bf16_f32 v71, v66, v67
    ds_write2_b64 v3, v[68:69], v[70:71] offset0:0 offset1:2
    s_cmp_lt_u32 s32, 2
    s_cbranch_scc1 ch_nk
    s_cmp_eq_u32 s32, 3
    s_cbranch_scc1 ch_nv
    s_cmp_eq_u32 s21, 1
    s_cbranch_scc1 ch_k1x
    buffer_store_dwordx4 v[16:19], v1, s[4:7], s56 offen offset:0 sc1
    buffer_store_dwordx4 v[20:23], v1, s[4:7], s56 offen offset:1024 sc1
    s_branch ch_nv
ch_k1x:
    buffer_store_dwordx4 v[24:27], v1, s[4:7], s56 offen offset:2048 sc1
    buffer_store_dwordx4 v[28:31], v1, s[4:7], s56 offen offset:3072 sc1
    s_branch ch_nv
ch_k3x:
ch_nk:
    v_lshrrev_b32 v11, 2, v1
    buffer_store_dword v72, v11, s[4:7], s57 offen sc1
    buffer_store_dword v76, v11, s[4:7], s57 offen offset:256 sc1
ch_nv:
    s_cmp_eq_u32 s58, 63
    s_cbranch_scc1 ch_fin
    v_mov_b32 v50, 0
    v_mov_b32 v51, 0
    v_mov_b32 v52, 0
    v_mov_b32 v53, 0
    v_mov_b32 v54, 0
    v_mov_b32 v55, 0
    s_waitcnt lgkmcnt(0)
    s_barrier
    ds_read_b128 v[60:63], v1 offset:0
    ds_read_b128 v[64:67], v1 offset:1024
    buffer_load_dwordx4 v[80:83], v1, s[4:7], s55 offen
    buffer_load_dwordx4 v[84:87], v1, s[4:7], s55 offen offset:1024
    s_add_u32 s55, s55, 0x40000
    s_waitcnt lgkmcnt(1)
    v_smfmac_f32_16x16x64_bf16 v[36:39], v[60:63], v[176:183], v4
    v_smfmac_f32_16x16x64_bf16 v[40:43], v[60:63], v[192:199], v4
    v_smfmac_f32_16x16x64_bf16 v[44:47], v[60:63], v[208:215], v4
    v_smfmac_f32_16x16x64_bf16 v[48:51], v[60:63], v[224:231], v4
    v_smfmac_f32_16x16x64_bf16 v[52:55], v[60:63], v[240:247], v4
    s_waitcnt lgkmcnt(0)
    v_smfmac_f32_16x16x64_bf16 v[36:39], v[64:67], v[184:191], v4
    v_smfmac_f32_16x16x64_bf16 v[40:43], v[64:67], v[200:207], v4
    v_smfmac_f32_16x16x64_bf16 v[44:47], v[64:67], v[216:223], v4
    v_smfmac_f32_16x16x64_bf16 v[48:51], v[64:67], v[232:239], v4
    v_smfmac_f32_16x16x64_bf16 v[52:55], v[64:67], v[248:255], v4
    s_mov_b32 m0, s39
    s_nop 0
    buffer_load_dwordx4 v1, s[4:7], s54 offen lds
    buffer_load_dwordx4 v1, s[4:7], s54 offen offset:1024 lds
    s_add_u32 s54, s54, 0x40000
    v_add_f32 v36, v36, v37
    v_add_f32 v38, v38, v39
    v_cvt_pk_bf16_f32 v60, v36, v38
    v_min_u32 v60, -2, v60
    v_add_f32 v40, v40, v41
    v_add_f32 v42, v42, v43
    v_cvt_pk_bf16_f32 v61, v40, v42
    v_min_u32 v61, -2, v61
    v_add_f32 v44, v44, v45
    v_add_f32 v46, v46, v47
    v_cvt_pk_bf16_f32 v62, v44, v46
    v_min_u32 v62, -2, v62
    v_add_f32 v48, v48, v49
    v_add_f32 v50, v50, v51
    v_cvt_pk_bf16_f32 v63, v48, v50
    v_min_u32 v63, -2, v63
    s_cmp_eq_u32 s15, 32
    s_cbranch_scc1 ch_l0
    buffer_store_dwordx4 v[60:63], v6, s[4:7], s52 offen sc1
    s_branch ch_m0
ch_l0:
    buffer_store_dwordx4 v[60:63], v6, s[4:7], s52 offen
ch_m0:
    v_add_f32 v52, v52, v53
    v_add_f32 v54, v54, v55
    v_cvt_pk_bf16_f32 v64, v52, v54
    v_min_u32 v64, -2, v64
    s_nop 1
    v_mov_b32_dpp v65, v64 quad_perm:[1,1,1,1] row_mask:0xf bank_mask:0xf
    v_mov_b32_dpp v66, v64 quad_perm:[2,2,2,2] row_mask:0xf bank_mask:0xf
    v_mov_b32_dpp v67, v64 quad_perm:[3,3,3,3] row_mask:0xf bank_mask:0xf
    s_cmp_eq_u32 s15, 32
    s_cbranch_scc1 ch_l1
    buffer_store_dwordx4 v[64:67], v7, s[4:7], s52 offen sc1
    s_branch ch_m1
ch_l1:
    buffer_store_dwordx4 v[64:67], v7, s[4:7], s52 offen
ch_m1:
    s_add_u32 s56, s56, 0x20000
    s_add_u32 s57, s57, 0x10000
    s_add_u32 s58, s58, 1
    s_branch ch_loop
ch_fin:
    v_mov_b32 v16, 1
    v_bfe_u32 v17, v1, 2, 6
    s_lshl_b32 s23, s20, 1
    s_add_u32 s23, s23, s21
    s_lshl_b32 s23, s23, 2
    s_add_u32 s23, s23, s3
    s_lshl_b32 s23, s23, 6
    s_add_u32 s23, s23, 143589376
    s_waitcnt vmcnt(0)
    buffer_store_dword v16, v17, s[4:7], s23 offen sc1
ch_end:
    s_endpgm
.section .rodata,"a"
.p2align 6
.amdhsa_kernel prep_kernel
  .amdhsa_next_free_vgpr 64
  .amdhsa_next_free_sgpr 96
  .amdhsa_accum_offset 64
  .amdhsa_group_segment_fixed_size 0
  .amdhsa_kernarg_size 112
  .amdhsa_user_sgpr_count 2
  .amdhsa_user_sgpr_kernarg_segment_ptr 1
  .amdhsa_system_sgpr_workgroup_id_x 1
.end_amdhsa_kernel
.p2align 6
.amdhsa_kernel main_kernel
  .amdhsa_next_free_vgpr 512
  .amdhsa_next_free_sgpr 96
  .amdhsa_accum_offset 256
  .amdhsa_group_segment_fixed_size 0
  .amdhsa_kernarg_size 112
  .amdhsa_user_sgpr_count 2
  .amdhsa_user_sgpr_kernarg_segment_ptr 1
  .amdhsa_system_sgpr_workgroup_id_x 1
.end_amdhsa_kernel
```
